```python
import torch

def _softmax(x, axis=-1):
    return torch.softmax(x, dim=axis)
def _gelu(x):
    return torch.nn.functional.gelu(x, approximate="tanh")
def _silu(x):
    return torch.nn.functional.silu(x)
def _sigmoid(x):
    return torch.sigmoid(x)
def _layernorm(x, axis=-1, eps=1e-5):
    m = x.mean(dim=axis, keepdim=True)
    v = x.var(dim=axis, keepdim=True, unbiased=False)
    return (x - m) / torch.sqrt(v + eps)
def _scatter_add(tgt, idx, src, axis=0):
    return tgt.clone().index_add_(axis, idx, src)
def _segment_sum(src, seg, n):
    out = torch.zeros((n,) + src.shape[1:], dtype=src.dtype)
    return out.index_add_(0, seg, src)
def _pad(x, pw):
    flat = tuple(v for pair in reversed(pw) for v in pair)
    return torch.nn.functional.pad(x, flat)

kernel_name = 'parallel_sum__sliding_block__swiglu_ffn__prompt'

def setup_inputs():

    _w = (lambda a: (lambda t: t.to(torch.bfloat16) if t.is_floating_point() else t)(torch.as_tensor(a)))
    def _A_setup():
        B, S, D = 1, 2048, 640
        return {
            "x": _w((lambda *s: torch.randn(*s, dtype=torch.bfloat16) * 0.05)(B, S, D)),
            "wqkv": _w((lambda *s: torch.randn(*s, dtype=torch.bfloat16) * 0.05)(D, 3 * D)),
            "wo": _w((lambda *s: torch.randn(*s, dtype=torch.bfloat16) * 0.05)(D, D)),
        }
    _A_in = _A_setup()

    def _B_setup():
        B, S, D, F = 1, 2048, 640, 1536
        return {
            "x": _w((lambda *s: torch.randn(*s, dtype=torch.bfloat16) * 0.05)(B, S, D)),
            "w_gate": _w((lambda *s: torch.randn(*s, dtype=torch.bfloat16) * 0.05)(D, F)),
            "w_up": _w((lambda *s: torch.randn(*s, dtype=torch.bfloat16) * 0.05)(D, F)),
            "w_down": _w((lambda *s: torch.randn(*s, dtype=torch.bfloat16) * 0.05)(F, D)),
        }
    _B_in = _B_setup()

    return {
        "A_x": _A_in["x"],
        "A_wqkv": _A_in["wqkv"],
        "A_wo": _A_in["wo"],
        "B_x": _B_in["x"],
        "B_w_gate": _B_in["w_gate"],
        "B_w_up": _B_in["w_up"],
        "B_w_down": _B_in["w_down"],
    }

def reference(A_x, A_wqkv, A_wo, B_x, B_w_gate, B_w_up, B_w_down):
    def _A_ref(x, wqkv, wo):
        B, S, D = x.shape
        H = 32; Dh = D // H; W = 256
        qkv = (lambda x, *d: x.permute(*d))((x @ wqkv).reshape(B, S, 3, H, Dh), 2, 0, 3, 1, 4)
        q, k, v = qkv[0], qkv[1], qkv[2]
        scores = torch.einsum("bhqd,bhkd->bhqk", q, k) * (Dh ** -0.5)
        idx = torch.arange(S)
        mask = (idx[:, None] - idx[None, :] >= 0) & (idx[:, None] - idx[None, :] < W)
        scores = torch.where(mask[None, None], scores, -1e9)
        p = _softmax(scores, axis=-1)
        o = torch.einsum("bhqk,bhkd->bhqd", p, v)
        return (lambda x, *d: x.permute(*d))(o, 0, 2, 1, 3).reshape(B, S, D) @ wo

    def _B_ref(x, w_gate, w_up, w_down):
        g = _silu(x @ w_gate)
        u = x @ w_up
        return (g * u) @ w_down

    x = A_x
    xn = _layernorm(x, axis=-1)
    return x + _A_ref(xn, A_wqkv, A_wo) + _B_ref(xn, B_w_gate, B_w_up, B_w_down)
```

```asm
; @launch kernel=k1_kernel grid=(256,1,1) block=(512,1,1) lds=163840
; @launch kernel=k2_kernel grid=(512,1,1) block=(512,1,1) lds=81920
.amdgcn_target "amdgcn-amd-amdhsa--gfx950"
.text
.globl k1_kernel
.p2align 8
.type k1_kernel,@function
k1_kernel:
    s_cmp_ge_u32 s2, 256
    s_nop 0
    s_cbranch_scc1 .k1_end
    s_load_dwordx4 s[4:7], s[0:1], 0
    s_load_dwordx4 s[8:11], s[0:1], 32
    s_load_dwordx2 s[12:13], s[0:1], 72
    s_load_dwordx2 s[64:65], s[0:1], 16
    s_load_dwordx2 s[66:67], s[0:1], 48
    s_and_b32 s32, s2, 7
    s_lshr_b32 s33, s2, 3
    s_and_b32 s34, s32, 1
    s_lshl_b32 s34, s34, 3
    s_and_b32 s35, s33, 7
    s_add_u32 s34, s34, s35
    s_lshr_b32 s35, s32, 1
    s_lshl_b32 s35, s35, 2
    s_lshr_b32 s36, s33, 3
    s_add_u32 s35, s35, s36
    v_lshrrev_b32 v11, 6, v0
    s_nop 0
    v_readfirstlane_b32 s36, v11
    v_and_b32 v0, 63, v0
    s_and_b32 s37, s36, 3
    s_lshr_b32 s38, s36, 2
    s_lshl_b32 s39, s34, 7
    s_lshl_b32 s40, s37, 5
    s_add_u32 s39, s39, s40
    s_waitcnt lgkmcnt(0)
    s_mov_b32 s24, s4
    s_and_b32 s25, s5, 0xffff
    s_mov_b32 s26, 0x280000
    s_mov_b32 s27, 0x00020000
    s_mov_b32 s28, s12
    s_and_b32 s29, s13, 0xffff
    s_mov_b32 s30, 0x19b1000
    s_mov_b32 s31, 0x00020000
    v_and_b32 v11, 15, v0
    v_lshrrev_b32 v12, 4, v0
    v_lshrrev_b32 v13, 3, v0
    v_mul_u32_u24 v13, 1280, v13
    v_and_b32 v14, 7, v0
    v_lshl_add_u32 v13, v14, 4, v13
    s_lshl_b32 s40, s34, 7
    s_lshl_b32 s41, s36, 4
    s_add_u32 s40, s40, s41
    s_mul_i32 s40, s40, 1280
    s_add_u32 s41, s40, 10240
    buffer_load_dwordx4 v[216:219], v13, s[24:27], s40 offen offset:0
    buffer_load_dwordx4 v[236:239], v13, s[24:27], s41 offen offset:0
    buffer_load_dwordx4 v[220:223], v13, s[24:27], s40 offen offset:128
    buffer_load_dwordx4 v[240:243], v13, s[24:27], s41 offen offset:128
    buffer_load_dwordx4 v[224:227], v13, s[24:27], s40 offen offset:256
    buffer_load_dwordx4 v[244:247], v13, s[24:27], s41 offen offset:256
    buffer_load_dwordx4 v[228:231], v13, s[24:27], s40 offen offset:384
    buffer_load_dwordx4 v[248:251], v13, s[24:27], s41 offen offset:384
    buffer_load_dwordx4 v[232:235], v13, s[24:27], s40 offen offset:512
    buffer_load_dwordx4 v[252:255], v13, s[24:27], s41 offen offset:512
    buffer_load_dwordx4 v[136:139], v13, s[24:27], s40 offen offset:640
    buffer_load_dwordx4 v[156:159], v13, s[24:27], s41 offen offset:640
    buffer_load_dwordx4 v[140:143], v13, s[24:27], s40 offen offset:768
    buffer_load_dwordx4 v[160:163], v13, s[24:27], s41 offen offset:768
    buffer_load_dwordx4 v[144:147], v13, s[24:27], s40 offen offset:896
    buffer_load_dwordx4 v[164:167], v13, s[24:27], s41 offen offset:896
    buffer_load_dwordx4 v[148:151], v13, s[24:27], s40 offen offset:1024
    buffer_load_dwordx4 v[168:171], v13, s[24:27], s41 offen offset:1024
    buffer_load_dwordx4 v[152:155], v13, s[24:27], s40 offen offset:1152
    buffer_load_dwordx4 v[172:175], v13, s[24:27], s41 offen offset:1152
    s_barrier
    s_cmp_ge_u32 s35, 6
    s_nop 0
    s_cbranch_scc1 .k1gu_1
    s_movk_i32 s42, 3840
    s_mul_i32 s43, s35, 640
    s_add_u32 s16, s6, s43
    s_addc_u32 s17, s7, 0
    s_sub_u32 s18, 2457600, s43
    s_add_u32 s43, s43, 192
    s_movk_i32 s56, 512
    s_add_u32 s20, s6, s43
    s_addc_u32 s21, s7, 0
    s_sub_u32 s22, 2457600, s43
    s_mov_b32 s44, 0
    s_mov_b32 s45, 10
    s_nop 0
    s_branch .k1par_2
.k1gu_1:
    s_movk_i32 s42, 3072
    s_sub_u32 s43, s35, 6
    s_mul_i32 s44, s43, 10
    s_movk_i32 s56, 192
    s_sub_u32 s45, s44, 4
    s_cmp_gt_u32 s43, 0
    s_cselect_b32 s44, s45, s44
    s_cmp_eq_u32 s43, 0
    s_cselect_b32 s45, 6, 10
    s_lshl_b32 s43, s44, 5
    s_add_u32 s16, s8, s43
    s_addc_u32 s17, s9, 0
    s_sub_u32 s18, 1966080, s43
    s_add_u32 s20, s10, s43
    s_addc_u32 s21, s11, 0
    s_sub_u32 s22, 1966080, s43
    s_nop 0
.k1par_2:
    s_and_b32 s17, s17, 0xffff
    s_and_b32 s21, s21, 0xffff
    s_mov_b32 s19, 0x00020000
    s_mov_b32 s23, 0x00020000
    s_lshl_b32 s46, s42, 7
    s_mul_i32 s47, s36, 3072
    s_lshl_b32 s48, s36, 11
    s_add_u32 s48, s48, 24576
    s_mul_i32 s49, s36, 192
    v_add_u32 v16, s49, v0
    v_mul_u32_u24 v17, 43691, v16
    v_lshrrev_b32 v17, 19, v17
    v_mul_u32_u24 v18, 12, v17
    v_sub_u32 v18, v16, v18
    v_lshrrev_b32 v19, 1, v18
    v_bfe_u32 v20, v17, 3, 1
    v_xor_b32 v19, v19, v20
    v_and_b32 v18, 1, v18
    v_lshlrev_b32 v18, 4, v18
    v_lshl_add_u32 v18, v19, 5, v18
    v_mul_lo_u32 v17, v17, s42
    v_add_u32 v1, v17, v18
    v_add_u32 v16, s49, v0
    v_add_u32 v16, 64, v16
    v_mul_u32_u24 v17, 43691, v16
    v_lshrrev_b32 v17, 19, v17
    v_mul_u32_u24 v18, 12, v17
    v_sub_u32 v18, v16, v18
    v_lshrrev_b32 v19, 1, v18
    v_bfe_u32 v20, v17, 3, 1
    v_xor_b32 v19, v19, v20
    v_and_b32 v18, 1, v18
    v_lshlrev_b32 v18, 4, v18
    v_lshl_add_u32 v18, v19, 5, v18
    v_mul_lo_u32 v17, v17, s42
    v_add_u32 v2, v17, v18
    v_add_u32 v16, s49, v0
    v_add_u32 v16, 128, v16
    v_mul_u32_u24 v17, 43691, v16
    v_lshrrev_b32 v17, 19, v17
    v_mul_u32_u24 v18, 12, v17
    v_sub_u32 v18, v16, v18
    v_lshrrev_b32 v19, 1, v18
    v_bfe_u32 v20, v17, 3, 1
    v_xor_b32 v19, v19, v20
    v_and_b32 v18, 1, v18
    v_lshlrev_b32 v18, 4, v18
    v_lshl_add_u32 v18, v19, 5, v18
    v_mul_lo_u32 v17, v17, s42
    v_add_u32 v3, v17, v18
    s_lshl_b32 s49, s36, 7
    v_add_u32 v16, s49, v0
    v_lshrrev_b32 v17, 3, v16
    v_and_b32 v18, 7, v16
    v_lshrrev_b32 v19, 1, v18
    v_bfe_u32 v20, v17, 1, 1
    v_bfe_u32 v21, v17, 3, 1
    v_lshl_or_b32 v20, v21, 1, v20
    v_xor_b32 v19, v19, v20
    v_and_b32 v18, 1, v18
    v_lshlrev_b32 v18, 4, v18
    v_lshl_add_u32 v18, v19, 5, v18
    v_mul_lo_u32 v17, v17, s42
    v_add_u32 v4, v17, v18
    v_add_u32 v16, s49, v0
    v_add_u32 v16, 64, v16
    v_lshrrev_b32 v17, 3, v16
    v_and_b32 v18, 7, v16
    v_lshrrev_b32 v19, 1, v18
    v_bfe_u32 v20, v17, 1, 1
    v_bfe_u32 v21, v17, 3, 1
    v_lshl_or_b32 v20, v21, 1, v20
    v_xor_b32 v19, v19, v20
    v_and_b32 v18, 1, v18
    v_lshlrev_b32 v18, 4, v18
    v_lshl_add_u32 v18, v19, 5, v18
    v_mul_lo_u32 v17, v17, s42
    v_add_u32 v5, v17, v18
    s_mul_i32 s50, s46, 0
    s_mov_b32 s51, s50
    s_add_u32 m0, s47, 0
    s_nop 0
    buffer_load_dwordx4 v1, s[16:19], s50 offen lds
    s_add_u32 m0, s47, 1024
    s_nop 0
    buffer_load_dwordx4 v2, s[16:19], s50 offen lds
    s_add_u32 m0, s47, 2048
    s_nop 0
    buffer_load_dwordx4 v3, s[16:19], s50 offen lds
    s_add_u32 m0, s48, 0
    s_nop 0
    buffer_load_dwordx4 v4, s[20:23], s51 offen lds
    s_add_u32 m0, s48, 1024
    s_nop 0
    buffer_load_dwordx4 v5, s[20:23], s51 offen lds
    s_mul_i32 s50, s46, 1
    s_mov_b32 s51, s50
    s_add_u32 m0, s47, 40960
    s_nop 0
    buffer_load_dwordx4 v1, s[16:19], s50 offen lds
    s_add_u32 m0, s47, 41984
    s_nop 0
    buffer_load_dwordx4 v2, s[16:19], s50 offen lds
    s_add_u32 m0, s47, 43008
    s_nop 0
    buffer_load_dwordx4 v3, s[16:19], s50 offen lds
    s_add_u32 m0, s48, 40960
    s_nop 0
    buffer_load_dwordx4 v4, s[20:23], s51 offen lds
    s_add_u32 m0, s48, 41984
    s_nop 0
    buffer_load_dwordx4 v5, s[20:23], s51 offen lds
    s_lshl_b32 s57, s2, 9
    s_lshl_b32 s58, s36, 6
    s_add_u32 s57, s57, s58
    s_cmp_lt_u32 s57, 122880
    s_cselect_b32 s60, s66, s64
    s_cselect_b32 s61, s67, s65
    s_cselect_b32 s58, 0, 1
    s_and_b32 s61, s61, 0xffff
    s_mov_b32 s63, 0x00020000
    s_mul_i32 s59, s58, 122880
    s_sub_u32 s57, s57, s59
    s_cmp_eq_u32 s58, 0
    s_mov_b32 s62, 819200
    s_cselect_b32 s62, 1966080, s62
    s_mov_b32 s59, 640
    s_cselect_b32 s59, 1536, s59
    s_mov_b32 s68, 26083328
    s_cselect_b32 s68, 24117248, s68
    v_add_u32 v64, s57, v0
    v_lshlrev_b32 v22, 4, v64
    buffer_load_dwordx4 v[56:59], v22, s[60:63], 0 offen
    s_mov_b32 s69, 53687092
    v_mul_hi_u32 v24, v64, s69
    v_mul_u32_u24 v25, 80, v24
    v_sub_u32 v25, v64, v25
    v_mul_u32_u24 v26, 205, v25
    v_lshrrev_b32 v26, 11, v26
    v_mul_u32_u24 v27, 10, v26
    v_sub_u32 v25, v25, v27
    v_mul_lo_u32 v26, v26, s59
    v_add_u32 v24, v24, v26
    v_mul_u32_u24 v24, 160, v24
    v_lshl_add_u32 v64, v25, 4, v24
    v_add_u32 v64, s68, v64
    s_mov_b32 s60, s64
    s_and_b32 s61, s65, 0xffff
    s_mov_b32 s62, 819200
    s_lshl_b32 s57, s2, 9
    s_lshl_b32 s58, s36, 6
    s_add_u32 s57, s57, s58
    s_add_u32 s57, s57, 8192
    v_add_u32 v65, s57, v0
    v_lshlrev_b32 v22, 4, v65
    buffer_load_dwordx4 v[60:63], v22, s[60:63], 0 offen
    v_cmp_gt_u32 vcc, 51200, v65
    s_mov_b32 s59, 640
    s_mov_b32 s69, 53687092
    v_mul_hi_u32 v24, v65, s69
    v_mul_u32_u24 v25, 80, v24
    v_sub_u32 v25, v65, v25
    v_mul_u32_u24 v26, 205, v25
    v_lshrrev_b32 v26, 11, v26
    v_mul_u32_u24 v27, 10, v26
    v_sub_u32 v25, v25, v27
    v_mul_lo_u32 v26, v26, s59
    v_add_u32 v24, v24, v26
    v_mul_u32_u24 v24, 160, v24
    v_lshl_add_u32 v65, v25, 4, v24
    v_add_u32 v65, 26083328, v65
    v_mov_b32 v24, 0x40000000
    v_cndmask_b32 v65, v24, v65, vcc
    v_mov_b32 v16, 0
    v_mov_b32 v17, 0
    v_mov_b32 v18, 0
    v_mov_b32 v19, 0
    v_mov_b32 v20, 0x3f803f80
    s_waitcnt vmcnt(31)
    v_dot2_f32_bf16 v16, v216, v20, v16
    v_dot2_f32_bf16 v17, v216, v216, v17
    v_dot2_f32_bf16 v16, v217, v20, v16
    v_dot2_f32_bf16 v17, v217, v217, v17
    v_dot2_f32_bf16 v16, v218, v20, v16
    v_dot2_f32_bf16 v17, v218, v218, v17
    v_dot2_f32_bf16 v16, v219, v20, v16
    v_dot2_f32_bf16 v17, v219, v219, v17
    s_waitcnt vmcnt(30)
    v_dot2_f32_bf16 v18, v236, v20, v18
    v_dot2_f32_bf16 v19, v236, v236, v19
    v_dot2_f32_bf16 v18, v237, v20, v18
    v_dot2_f32_bf16 v19, v237, v237, v19
    v_dot2_f32_bf16 v18, v238, v20, v18
    v_dot2_f32_bf16 v19, v238, v238, v19
    v_dot2_f32_bf16 v18, v239, v20, v18
    v_dot2_f32_bf16 v19, v239, v239, v19
    s_waitcnt vmcnt(29)
    v_dot2_f32_bf16 v16, v220, v20, v16
    v_dot2_f32_bf16 v17, v220, v220, v17
    v_dot2_f32_bf16 v16, v221, v20, v16
    v_dot2_f32_bf16 v17, v221, v221, v17
    v_dot2_f32_bf16 v16, v222, v20, v16
    v_dot2_f32_bf16 v17, v222, v222, v17
    v_dot2_f32_bf16 v16, v223, v20, v16
    v_dot2_f32_bf16 v17, v223, v223, v17
    s_waitcnt vmcnt(28)
    v_dot2_f32_bf16 v18, v240, v20, v18
    v_dot2_f32_bf16 v19, v240, v240, v19
    v_dot2_f32_bf16 v18, v241, v20, v18
    v_dot2_f32_bf16 v19, v241, v241, v19
    v_dot2_f32_bf16 v18, v242, v20, v18
    v_dot2_f32_bf16 v19, v242, v242, v19
    v_dot2_f32_bf16 v18, v243, v20, v18
    v_dot2_f32_bf16 v19, v243, v243, v19
    s_waitcnt vmcnt(27)
    v_dot2_f32_bf16 v16, v224, v20, v16
    v_dot2_f32_bf16 v17, v224, v224, v17
    v_dot2_f32_bf16 v16, v225, v20, v16
    v_dot2_f32_bf16 v17, v225, v225, v17
    v_dot2_f32_bf16 v16, v226, v20, v16
    v_dot2_f32_bf16 v17, v226, v226, v17
    v_dot2_f32_bf16 v16, v227, v20, v16
    v_dot2_f32_bf16 v17, v227, v227, v17
    s_waitcnt vmcnt(26)
    v_dot2_f32_bf16 v18, v244, v20, v18
    v_dot2_f32_bf16 v19, v244, v244, v19
    v_dot2_f32_bf16 v18, v245, v20, v18
    v_dot2_f32_bf16 v19, v245, v245, v19
    v_dot2_f32_bf16 v18, v246, v20, v18
    v_dot2_f32_bf16 v19, v246, v246, v19
    v_dot2_f32_bf16 v18, v247, v20, v18
    v_dot2_f32_bf16 v19, v247, v247, v19
    s_waitcnt vmcnt(25)
    v_dot2_f32_bf16 v16, v228, v20, v16
    v_dot2_f32_bf16 v17, v228, v228, v17
    v_dot2_f32_bf16 v16, v229, v20, v16
    v_dot2_f32_bf16 v17, v229, v229, v17
    v_dot2_f32_bf16 v16, v230, v20, v16
    v_dot2_f32_bf16 v17, v230, v230, v17
    v_dot2_f32_bf16 v16, v231, v20, v16
    v_dot2_f32_bf16 v17, v231, v231, v17
    s_waitcnt vmcnt(24)
    v_dot2_f32_bf16 v18, v248, v20, v18
    v_dot2_f32_bf16 v19, v248, v248, v19
    v_dot2_f32_bf16 v18, v249, v20, v18
    v_dot2_f32_bf16 v19, v249, v249, v19
    v_dot2_f32_bf16 v18, v250, v20, v18
    v_dot2_f32_bf16 v19, v250, v250, v19
    v_dot2_f32_bf16 v18, v251, v20, v18
    v_dot2_f32_bf16 v19, v251, v251, v19
    s_waitcnt vmcnt(23)
    v_dot2_f32_bf16 v16, v232, v20, v16
    v_dot2_f32_bf16 v17, v232, v232, v17
    v_dot2_f32_bf16 v16, v233, v20, v16
    v_dot2_f32_bf16 v17, v233, v233, v17
    v_dot2_f32_bf16 v16, v234, v20, v16
    v_dot2_f32_bf16 v17, v234, v234, v17
    v_dot2_f32_bf16 v16, v235, v20, v16
    v_dot2_f32_bf16 v17, v235, v235, v17
    s_waitcnt vmcnt(22)
    v_dot2_f32_bf16 v18, v252, v20, v18
    v_dot2_f32_bf16 v19, v252, v252, v19
    v_dot2_f32_bf16 v18, v253, v20, v18
    v_dot2_f32_bf16 v19, v253, v253, v19
    v_dot2_f32_bf16 v18, v254, v20, v18
    v_dot2_f32_bf16 v19, v254, v254, v19
    v_dot2_f32_bf16 v18, v255, v20, v18
    v_dot2_f32_bf16 v19, v255, v255, v19
    s_waitcnt vmcnt(21)
    v_dot2_f32_bf16 v16, v136, v20, v16
    v_dot2_f32_bf16 v17, v136, v136, v17
    v_dot2_f32_bf16 v16, v137, v20, v16
    v_dot2_f32_bf16 v17, v137, v137, v17
    v_dot2_f32_bf16 v16, v138, v20, v16
    v_dot2_f32_bf16 v17, v138, v138, v17
    v_dot2_f32_bf16 v16, v139, v20, v16
    v_dot2_f32_bf16 v17, v139, v139, v17
    s_waitcnt vmcnt(20)
    v_dot2_f32_bf16 v18, v156, v20, v18
    v_dot2_f32_bf16 v19, v156, v156, v19
    v_dot2_f32_bf16 v18, v157, v20, v18
    v_dot2_f32_bf16 v19, v157, v157, v19
    v_dot2_f32_bf16 v18, v158, v20, v18
    v_dot2_f32_bf16 v19, v158, v158, v19
    v_dot2_f32_bf16 v18, v159, v20, v18
    v_dot2_f32_bf16 v19, v159, v159, v19
    s_waitcnt vmcnt(19)
    v_dot2_f32_bf16 v16, v140, v20, v16
    v_dot2_f32_bf16 v17, v140, v140, v17
    v_dot2_f32_bf16 v16, v141, v20, v16
    v_dot2_f32_bf16 v17, v141, v141, v17
    v_dot2_f32_bf16 v16, v142, v20, v16
    v_dot2_f32_bf16 v17, v142, v142, v17
    v_dot2_f32_bf16 v16, v143, v20, v16
    v_dot2_f32_bf16 v17, v143, v143, v17
    s_waitcnt vmcnt(18)
    v_dot2_f32_bf16 v18, v160, v20, v18
    v_dot2_f32_bf16 v19, v160, v160, v19
    v_dot2_f32_bf16 v18, v161, v20, v18
    v_dot2_f32_bf16 v19, v161, v161, v19
    v_dot2_f32_bf16 v18, v162, v20, v18
    v_dot2_f32_bf16 v19, v162, v162, v19
    v_dot2_f32_bf16 v18, v163, v20, v18
    v_dot2_f32_bf16 v19, v163, v163, v19
    s_waitcnt vmcnt(17)
    v_dot2_f32_bf16 v16, v144, v20, v16
    v_dot2_f32_bf16 v17, v144, v144, v17
    v_dot2_f32_bf16 v16, v145, v20, v16
    v_dot2_f32_bf16 v17, v145, v145, v17
    v_dot2_f32_bf16 v16, v146, v20, v16
    v_dot2_f32_bf16 v17, v146, v146, v17
    v_dot2_f32_bf16 v16, v147, v20, v16
    v_dot2_f32_bf16 v17, v147, v147, v17
    s_waitcnt vmcnt(16)
    v_dot2_f32_bf16 v18, v164, v20, v18
    v_dot2_f32_bf16 v19, v164, v164, v19
    v_dot2_f32_bf16 v18, v165, v20, v18
    v_dot2_f32_bf16 v19, v165, v165, v19
    v_dot2_f32_bf16 v18, v166, v20, v18
    v_dot2_f32_bf16 v19, v166, v166, v19
    v_dot2_f32_bf16 v18, v167, v20, v18
    v_dot2_f32_bf16 v19, v167, v167, v19
    s_waitcnt vmcnt(15)
    v_dot2_f32_bf16 v16, v148, v20, v16
    v_dot2_f32_bf16 v17, v148, v148, v17
    v_dot2_f32_bf16 v16, v149, v20, v16
    v_dot2_f32_bf16 v17, v149, v149, v17
    v_dot2_f32_bf16 v16, v150, v20, v16
    v_dot2_f32_bf16 v17, v150, v150, v17
    v_dot2_f32_bf16 v16, v151, v20, v16
    v_dot2_f32_bf16 v17, v151, v151, v17
    s_waitcnt vmcnt(14)
    v_dot2_f32_bf16 v18, v168, v20, v18
    v_dot2_f32_bf16 v19, v168, v168, v19
    v_dot2_f32_bf16 v18, v169, v20, v18
    v_dot2_f32_bf16 v19, v169, v169, v19
    v_dot2_f32_bf16 v18, v170, v20, v18
    v_dot2_f32_bf16 v19, v170, v170, v19
    v_dot2_f32_bf16 v18, v171, v20, v18
    v_dot2_f32_bf16 v19, v171, v171, v19
    s_waitcnt vmcnt(13)
    v_dot2_f32_bf16 v16, v152, v20, v16
    v_dot2_f32_bf16 v17, v152, v152, v17
    v_dot2_f32_bf16 v16, v153, v20, v16
    v_dot2_f32_bf16 v17, v153, v153, v17
    v_dot2_f32_bf16 v16, v154, v20, v16
    v_dot2_f32_bf16 v17, v154, v154, v17
    v_dot2_f32_bf16 v16, v155, v20, v16
    v_dot2_f32_bf16 v17, v155, v155, v17
    s_waitcnt vmcnt(12)
    v_dot2_f32_bf16 v18, v172, v20, v18
    v_dot2_f32_bf16 v19, v172, v172, v19
    v_dot2_f32_bf16 v18, v173, v20, v18
    v_dot2_f32_bf16 v19, v173, v173, v19
    v_dot2_f32_bf16 v18, v174, v20, v18
    v_dot2_f32_bf16 v19, v174, v174, v19
    v_dot2_f32_bf16 v18, v175, v20, v18
    v_dot2_f32_bf16 v19, v175, v175, v19
    v_add_f32_dpp v16, v16, v16 quad_perm:[1,0,3,2] row_mask:0xf bank_mask:0xf
    v_add_f32_dpp v17, v17, v17 quad_perm:[1,0,3,2] row_mask:0xf bank_mask:0xf
    v_add_f32_dpp v18, v18, v18 quad_perm:[1,0,3,2] row_mask:0xf bank_mask:0xf
    v_add_f32_dpp v19, v19, v19 quad_perm:[1,0,3,2] row_mask:0xf bank_mask:0xf
    v_add_f32_dpp v16, v16, v16 quad_perm:[2,3,0,1] row_mask:0xf bank_mask:0xf
    v_add_f32_dpp v17, v17, v17 quad_perm:[2,3,0,1] row_mask:0xf bank_mask:0xf
    v_add_f32_dpp v18, v18, v18 quad_perm:[2,3,0,1] row_mask:0xf bank_mask:0xf
    v_add_f32_dpp v19, v19, v19 quad_perm:[2,3,0,1] row_mask:0xf bank_mask:0xf
    v_add_f32_dpp v16, v16, v16 row_half_mirror row_mask:0xf bank_mask:0xf
    v_add_f32_dpp v17, v17, v17 row_half_mirror row_mask:0xf bank_mask:0xf
    v_add_f32_dpp v18, v18, v18 row_half_mirror row_mask:0xf bank_mask:0xf
    v_add_f32_dpp v19, v19, v19 row_half_mirror row_mask:0xf bank_mask:0xf
    v_mul_f32 v24, 0x3acccccd, v16
    v_mul_f32 v25, 0x3acccccd, v17
    v_fma_f32 v25, -v24, v24, v25
    v_max_f32 v25, 0, v25
    v_cvt_pk_bf16_f32 v26, v24, v25
    v_lshlrev_b32 v24, 16, v26
    v_and_b32 v25, 0xffff0000, v26
    v_add_f32 v25, 0x3727c5ac, v25
    v_cvt_pk_bf16_f32 v26, v25, v25
    v_lshlrev_b32 v25, 16, v26
    v_sqrt_f32 v25, v25
    s_nop 0
    v_cvt_pk_bf16_f32 v26, v25, v25
    v_lshlrev_b32 v25, 16, v26
    v_rcp_f32 v28, v25
    s_nop 0
    v_mul_f32 v30, v24, v28
    v_sub_f32 v30, 0, v30
    v_mov_b32 v29, v28
    v_mov_b32 v31, v30
    v_mul_f32 v24, 0x3acccccd, v18
    v_mul_f32 v25, 0x3acccccd, v19
    v_fma_f32 v25, -v24, v24, v25
    v_max_f32 v25, 0, v25
    v_cvt_pk_bf16_f32 v26, v24, v25
    v_lshlrev_b32 v24, 16, v26
    v_and_b32 v25, 0xffff0000, v26
    v_add_f32 v25, 0x3727c5ac, v25
    v_cvt_pk_bf16_f32 v26, v25, v25
    v_lshlrev_b32 v25, 16, v26
    v_sqrt_f32 v25, v25
    s_nop 0
    v_cvt_pk_bf16_f32 v26, v25, v25
    v_lshlrev_b32 v25, 16, v26
    v_rcp_f32 v32, v25
    s_nop 0
    v_mul_f32 v34, v24, v32
    v_sub_f32 v34, 0, v34
    v_mov_b32 v33, v32
    v_mov_b32 v35, v34
    s_lshl_b32 s49, s36, 4
    v_lshrrev_b32 v24, 3, v0
    v_add_u32 v24, s49, v24
    v_bfe_u32 v25, v24, 1, 3
    v_xor_b32 v25, v25, v14
    v_mul_u32_u24 v24, 640, v24
    v_lshl_add_u32 v24, v25, 4, v24
    v_add_u32 v16, 81920, v24
    v_lshrrev_b32 v24, 3, v0
    v_add_u32 v24, s49, v24
    v_add_u32 v24, 8, v24
    v_bfe_u32 v25, v24, 1, 3
    v_xor_b32 v25, v25, v14
    v_mul_u32_u24 v24, 640, v24
    v_lshl_add_u32 v24, v25, 4, v24
    v_add_u32 v17, 81920, v24
    s_lshl_b32 s49, s37, 5
    v_add_u32 v24, s49, v11
    v_bfe_u32 v25, v24, 1, 3
    v_xor_b32 v25, v25, v12
    v_mul_u32_u24 v24, 640, v24
    v_add_u32 v24, 81920, v24
    v_lshl_add_u32 v20, v25, 4, v24
    v_xor_b32 v25, 4, v25
    v_lshl_add_u32 v21, v25, 4, v24
    v_add_u32 v24, s49, v11
    v_add_u32 v24, 16, v24
    v_bfe_u32 v25, v24, 1, 3
    v_xor_b32 v25, v25, v12
    v_mul_u32_u24 v24, 640, v24
    v_add_u32 v24, 81920, v24
    v_lshl_add_u32 v22, v25, 4, v24
    v_xor_b32 v25, 4, v25
    v_lshl_add_u32 v23, v25, 4, v24
    v_lshlrev_b32 v40, 16, v216
    v_and_b32 v41, 0xffff0000, v216
    v_lshlrev_b32 v42, 16, v217
    v_and_b32 v43, 0xffff0000, v217
    v_lshlrev_b32 v44, 16, v218
    v_and_b32 v45, 0xffff0000, v218
    v_lshlrev_b32 v46, 16, v219
    v_and_b32 v47, 0xffff0000, v219
    v_pk_fma_f32 v[40:41], v[40:41], v[28:29], v[30:31]
    v_pk_fma_f32 v[42:43], v[42:43], v[28:29], v[30:31]
    v_pk_fma_f32 v[44:45], v[44:45], v[28:29], v[30:31]
    v_pk_fma_f32 v[46:47], v[46:47], v[28:29], v[30:31]
    v_cvt_pk_bf16_f32 v216, v40, v41
    v_cvt_pk_bf16_f32 v217, v42, v43
    v_cvt_pk_bf16_f32 v218, v44, v45
    v_cvt_pk_bf16_f32 v219, v46, v47
    ds_write_b128 v16, v[216:219] offset:0
    v_lshlrev_b32 v48, 16, v236
    v_and_b32 v49, 0xffff0000, v236
    v_lshlrev_b32 v50, 16, v237
    v_and_b32 v51, 0xffff0000, v237
    v_lshlrev_b32 v52, 16, v238
    v_and_b32 v53, 0xffff0000, v238
    v_lshlrev_b32 v54, 16, v239
    v_and_b32 v55, 0xffff0000, v239
    v_pk_fma_f32 v[48:49], v[48:49], v[32:33], v[34:35]
    v_pk_fma_f32 v[50:51], v[50:51], v[32:33], v[34:35]
    v_pk_fma_f32 v[52:53], v[52:53], v[32:33], v[34:35]
    v_pk_fma_f32 v[54:55], v[54:55], v[32:33], v[34:35]
    v_cvt_pk_bf16_f32 v236, v48, v49
    v_cvt_pk_bf16_f32 v237, v50, v51
    v_cvt_pk_bf16_f32 v238, v52, v53
    v_cvt_pk_bf16_f32 v239, v54, v55
    ds_write_b128 v17, v[236:239] offset:0
    v_lshlrev_b32 v40, 16, v220
    v_and_b32 v41, 0xffff0000, v220
    v_lshlrev_b32 v42, 16, v221
    v_and_b32 v43, 0xffff0000, v221
    v_lshlrev_b32 v44, 16, v222
    v_and_b32 v45, 0xffff0000, v222
    v_lshlrev_b32 v46, 16, v223
    v_and_b32 v47, 0xffff0000, v223
    v_pk_fma_f32 v[40:41], v[40:41], v[28:29], v[30:31]
    v_pk_fma_f32 v[42:43], v[42:43], v[28:29], v[30:31]
    v_pk_fma_f32 v[44:45], v[44:45], v[28:29], v[30:31]
    v_pk_fma_f32 v[46:47], v[46:47], v[28:29], v[30:31]
    v_cvt_pk_bf16_f32 v220, v40, v41
    v_cvt_pk_bf16_f32 v221, v42, v43
    v_cvt_pk_bf16_f32 v222, v44, v45
    v_cvt_pk_bf16_f32 v223, v46, v47
    ds_write_b128 v16, v[220:223] offset:128
    v_lshlrev_b32 v48, 16, v240
    v_and_b32 v49, 0xffff0000, v240
    v_lshlrev_b32 v50, 16, v241
    v_and_b32 v51, 0xffff0000, v241
    v_lshlrev_b32 v52, 16, v242
    v_and_b32 v53, 0xffff0000, v242
    v_lshlrev_b32 v54, 16, v243
    v_and_b32 v55, 0xffff0000, v243
    v_pk_fma_f32 v[48:49], v[48:49], v[32:33], v[34:35]
    v_pk_fma_f32 v[50:51], v[50:51], v[32:33], v[34:35]
    v_pk_fma_f32 v[52:53], v[52:53], v[32:33], v[34:35]
    v_pk_fma_f32 v[54:55], v[54:55], v[32:33], v[34:35]
    v_cvt_pk_bf16_f32 v240, v48, v49
    v_cvt_pk_bf16_f32 v241, v50, v51
    v_cvt_pk_bf16_f32 v242, v52, v53
    v_cvt_pk_bf16_f32 v243, v54, v55
    ds_write_b128 v17, v[240:243] offset:128
    v_lshlrev_b32 v40, 16, v224
    v_and_b32 v41, 0xffff0000, v224
    v_lshlrev_b32 v42, 16, v225
    v_and_b32 v43, 0xffff0000, v225
    v_lshlrev_b32 v44, 16, v226
    v_and_b32 v45, 0xffff0000, v226
    v_lshlrev_b32 v46, 16, v227
    v_and_b32 v47, 0xffff0000, v227
    v_pk_fma_f32 v[40:41], v[40:41], v[28:29], v[30:31]
    v_pk_fma_f32 v[42:43], v[42:43], v[28:29], v[30:31]
    v_pk_fma_f32 v[44:45], v[44:45], v[28:29], v[30:31]
    v_pk_fma_f32 v[46:47], v[46:47], v[28:29], v[30:31]
    v_cvt_pk_bf16_f32 v224, v40, v41
    v_cvt_pk_bf16_f32 v225, v42, v43
    v_cvt_pk_bf16_f32 v226, v44, v45
    v_cvt_pk_bf16_f32 v227, v46, v47
    ds_write_b128 v16, v[224:227] offset:256
    v_lshlrev_b32 v48, 16, v244
    v_and_b32 v49, 0xffff0000, v244
    v_lshlrev_b32 v50, 16, v245
    v_and_b32 v51, 0xffff0000, v245
    v_lshlrev_b32 v52, 16, v246
    v_and_b32 v53, 0xffff0000, v246
    v_lshlrev_b32 v54, 16, v247
    v_and_b32 v55, 0xffff0000, v247
    v_pk_fma_f32 v[48:49], v[48:49], v[32:33], v[34:35]
    v_pk_fma_f32 v[50:51], v[50:51], v[32:33], v[34:35]
    v_pk_fma_f32 v[52:53], v[52:53], v[32:33], v[34:35]
    v_pk_fma_f32 v[54:55], v[54:55], v[32:33], v[34:35]
    v_cvt_pk_bf16_f32 v244, v48, v49
    v_cvt_pk_bf16_f32 v245, v50, v51
    v_cvt_pk_bf16_f32 v246, v52, v53
    v_cvt_pk_bf16_f32 v247, v54, v55
    ds_write_b128 v17, v[244:247] offset:256
    v_lshlrev_b32 v40, 16, v228
    v_and_b32 v41, 0xffff0000, v228
    v_lshlrev_b32 v42, 16, v229
    v_and_b32 v43, 0xffff0000, v229
    v_lshlrev_b32 v44, 16, v230
    v_and_b32 v45, 0xffff0000, v230
    v_lshlrev_b32 v46, 16, v231
    v_and_b32 v47, 0xffff0000, v231
    v_pk_fma_f32 v[40:41], v[40:41], v[28:29], v[30:31]
    v_pk_fma_f32 v[42:43], v[42:43], v[28:29], v[30:31]
    v_pk_fma_f32 v[44:45], v[44:45], v[28:29], v[30:31]
    v_pk_fma_f32 v[46:47], v[46:47], v[28:29], v[30:31]
    v_cvt_pk_bf16_f32 v228, v40, v41
    v_cvt_pk_bf16_f32 v229, v42, v43
    v_cvt_pk_bf16_f32 v230, v44, v45
    v_cvt_pk_bf16_f32 v231, v46, v47
    ds_write_b128 v16, v[228:231] offset:384
    v_lshlrev_b32 v48, 16, v248
    v_and_b32 v49, 0xffff0000, v248
    v_lshlrev_b32 v50, 16, v249
    v_and_b32 v51, 0xffff0000, v249
    v_lshlrev_b32 v52, 16, v250
    v_and_b32 v53, 0xffff0000, v250
    v_lshlrev_b32 v54, 16, v251
    v_and_b32 v55, 0xffff0000, v251
    v_pk_fma_f32 v[48:49], v[48:49], v[32:33], v[34:35]
    v_pk_fma_f32 v[50:51], v[50:51], v[32:33], v[34:35]
    v_pk_fma_f32 v[52:53], v[52:53], v[32:33], v[34:35]
    v_pk_fma_f32 v[54:55], v[54:55], v[32:33], v[34:35]
    v_cvt_pk_bf16_f32 v248, v48, v49
    v_cvt_pk_bf16_f32 v249, v50, v51
    v_cvt_pk_bf16_f32 v250, v52, v53
    v_cvt_pk_bf16_f32 v251, v54, v55
    ds_write_b128 v17, v[248:251] offset:384
    v_lshlrev_b32 v40, 16, v232
    v_and_b32 v41, 0xffff0000, v232
    v_lshlrev_b32 v42, 16, v233
    v_and_b32 v43, 0xffff0000, v233
    v_lshlrev_b32 v44, 16, v234
    v_and_b32 v45, 0xffff0000, v234
    v_lshlrev_b32 v46, 16, v235
    v_and_b32 v47, 0xffff0000, v235
    v_pk_fma_f32 v[40:41], v[40:41], v[28:29], v[30:31]
    v_pk_fma_f32 v[42:43], v[42:43], v[28:29], v[30:31]
    v_pk_fma_f32 v[44:45], v[44:45], v[28:29], v[30:31]
    v_pk_fma_f32 v[46:47], v[46:47], v[28:29], v[30:31]
    v_cvt_pk_bf16_f32 v232, v40, v41
    v_cvt_pk_bf16_f32 v233, v42, v43
    v_cvt_pk_bf16_f32 v234, v44, v45
    v_cvt_pk_bf16_f32 v235, v46, v47
    ds_write_b128 v16, v[232:235] offset:512
    v_lshlrev_b32 v48, 16, v252
    v_and_b32 v49, 0xffff0000, v252
    v_lshlrev_b32 v50, 16, v253
    v_and_b32 v51, 0xffff0000, v253
    v_lshlrev_b32 v52, 16, v254
    v_and_b32 v53, 0xffff0000, v254
    v_lshlrev_b32 v54, 16, v255
    v_and_b32 v55, 0xffff0000, v255
    v_pk_fma_f32 v[48:49], v[48:49], v[32:33], v[34:35]
    v_pk_fma_f32 v[50:51], v[50:51], v[32:33], v[34:35]
    v_pk_fma_f32 v[52:53], v[52:53], v[32:33], v[34:35]
    v_pk_fma_f32 v[54:55], v[54:55], v[32:33], v[34:35]
    v_cvt_pk_bf16_f32 v252, v48, v49
    v_cvt_pk_bf16_f32 v253, v50, v51
    v_cvt_pk_bf16_f32 v254, v52, v53
    v_cvt_pk_bf16_f32 v255, v54, v55
    ds_write_b128 v17, v[252:255] offset:512
    s_waitcnt lgkmcnt(0)
    s_barrier
    ds_read_b128 v[96:99], v20 offset:0
    ds_read_b128 v[176:179], v22 offset:0
    ds_read_b128 v[100:103], v21 offset:0
    ds_read_b128 v[180:183], v23 offset:0
    ds_read_b128 v[104:107], v20 offset:128
    ds_read_b128 v[184:187], v22 offset:128
    ds_read_b128 v[108:111], v21 offset:128
    ds_read_b128 v[188:191], v23 offset:128
    ds_read_b128 v[112:115], v20 offset:256
    ds_read_b128 v[192:195], v22 offset:256
    ds_read_b128 v[116:119], v21 offset:256
    ds_read_b128 v[196:199], v23 offset:256
    ds_read_b128 v[120:123], v20 offset:384
    ds_read_b128 v[200:203], v22 offset:384
    ds_read_b128 v[124:127], v21 offset:384
    ds_read_b128 v[204:207], v23 offset:384
    ds_read_b128 v[128:131], v20 offset:512
    ds_read_b128 v[208:211], v22 offset:512
    ds_read_b128 v[132:135], v21 offset:512
    ds_read_b128 v[212:215], v23 offset:512
    v_lshlrev_b32 v40, 16, v136
    v_and_b32 v41, 0xffff0000, v136
    v_lshlrev_b32 v42, 16, v137
    v_and_b32 v43, 0xffff0000, v137
    v_lshlrev_b32 v44, 16, v138
    v_and_b32 v45, 0xffff0000, v138
    v_lshlrev_b32 v46, 16, v139
    v_and_b32 v47, 0xffff0000, v139
    v_pk_fma_f32 v[40:41], v[40:41], v[28:29], v[30:31]
    v_pk_fma_f32 v[42:43], v[42:43], v[28:29], v[30:31]
    v_pk_fma_f32 v[44:45], v[44:45], v[28:29], v[30:31]
    v_pk_fma_f32 v[46:47], v[46:47], v[28:29], v[30:31]
    v_cvt_pk_bf16_f32 v136, v40, v41
    v_cvt_pk_bf16_f32 v137, v42, v43
    v_cvt_pk_bf16_f32 v138, v44, v45
    v_cvt_pk_bf16_f32 v139, v46, v47
    v_lshlrev_b32 v48, 16, v156
    v_and_b32 v49, 0xffff0000, v156
    v_lshlrev_b32 v50, 16, v157
    v_and_b32 v51, 0xffff0000, v157
    v_lshlrev_b32 v52, 16, v158
    v_and_b32 v53, 0xffff0000, v158
    v_lshlrev_b32 v54, 16, v159
    v_and_b32 v55, 0xffff0000, v159
    v_pk_fma_f32 v[48:49], v[48:49], v[32:33], v[34:35]
    v_pk_fma_f32 v[50:51], v[50:51], v[32:33], v[34:35]
    v_pk_fma_f32 v[52:53], v[52:53], v[32:33], v[34:35]
    v_pk_fma_f32 v[54:55], v[54:55], v[32:33], v[34:35]
    v_cvt_pk_bf16_f32 v156, v48, v49
    v_cvt_pk_bf16_f32 v157, v50, v51
    v_cvt_pk_bf16_f32 v158, v52, v53
    v_cvt_pk_bf16_f32 v159, v54, v55
    v_lshlrev_b32 v40, 16, v140
    v_and_b32 v41, 0xffff0000, v140
    v_lshlrev_b32 v42, 16, v141
    v_and_b32 v43, 0xffff0000, v141
    v_lshlrev_b32 v44, 16, v142
    v_and_b32 v45, 0xffff0000, v142
    v_lshlrev_b32 v46, 16, v143
    v_and_b32 v47, 0xffff0000, v143
    v_pk_fma_f32 v[40:41], v[40:41], v[28:29], v[30:31]
    v_pk_fma_f32 v[42:43], v[42:43], v[28:29], v[30:31]
    v_pk_fma_f32 v[44:45], v[44:45], v[28:29], v[30:31]
    v_pk_fma_f32 v[46:47], v[46:47], v[28:29], v[30:31]
    v_cvt_pk_bf16_f32 v140, v40, v41
    v_cvt_pk_bf16_f32 v141, v42, v43
    v_cvt_pk_bf16_f32 v142, v44, v45
    v_cvt_pk_bf16_f32 v143, v46, v47
    v_lshlrev_b32 v48, 16, v160
    v_and_b32 v49, 0xffff0000, v160
    v_lshlrev_b32 v50, 16, v161
    v_and_b32 v51, 0xffff0000, v161
    v_lshlrev_b32 v52, 16, v162
    v_and_b32 v53, 0xffff0000, v162
    v_lshlrev_b32 v54, 16, v163
    v_and_b32 v55, 0xffff0000, v163
    v_pk_fma_f32 v[48:49], v[48:49], v[32:33], v[34:35]
    v_pk_fma_f32 v[50:51], v[50:51], v[32:33], v[34:35]
    v_pk_fma_f32 v[52:53], v[52:53], v[32:33], v[34:35]
    v_pk_fma_f32 v[54:55], v[54:55], v[32:33], v[34:35]
    v_cvt_pk_bf16_f32 v160, v48, v49
    v_cvt_pk_bf16_f32 v161, v50, v51
    v_cvt_pk_bf16_f32 v162, v52, v53
    v_cvt_pk_bf16_f32 v163, v54, v55
    v_lshlrev_b32 v40, 16, v144
    v_and_b32 v41, 0xffff0000, v144
    v_lshlrev_b32 v42, 16, v145
    v_and_b32 v43, 0xffff0000, v145
    v_lshlrev_b32 v44, 16, v146
    v_and_b32 v45, 0xffff0000, v146
    v_lshlrev_b32 v46, 16, v147
    v_and_b32 v47, 0xffff0000, v147
    v_pk_fma_f32 v[40:41], v[40:41], v[28:29], v[30:31]
    v_pk_fma_f32 v[42:43], v[42:43], v[28:29], v[30:31]
    v_pk_fma_f32 v[44:45], v[44:45], v[28:29], v[30:31]
    v_pk_fma_f32 v[46:47], v[46:47], v[28:29], v[30:31]
    v_cvt_pk_bf16_f32 v144, v40, v41
    v_cvt_pk_bf16_f32 v145, v42, v43
    v_cvt_pk_bf16_f32 v146, v44, v45
    v_cvt_pk_bf16_f32 v147, v46, v47
    v_lshlrev_b32 v48, 16, v164
    v_and_b32 v49, 0xffff0000, v164
    v_lshlrev_b32 v50, 16, v165
    v_and_b32 v51, 0xffff0000, v165
    v_lshlrev_b32 v52, 16, v166
    v_and_b32 v53, 0xffff0000, v166
    v_lshlrev_b32 v54, 16, v167
    v_and_b32 v55, 0xffff0000, v167
    v_pk_fma_f32 v[48:49], v[48:49], v[32:33], v[34:35]
    v_pk_fma_f32 v[50:51], v[50:51], v[32:33], v[34:35]
    v_pk_fma_f32 v[52:53], v[52:53], v[32:33], v[34:35]
    v_pk_fma_f32 v[54:55], v[54:55], v[32:33], v[34:35]
    v_cvt_pk_bf16_f32 v164, v48, v49
    v_cvt_pk_bf16_f32 v165, v50, v51
    v_cvt_pk_bf16_f32 v166, v52, v53
    v_cvt_pk_bf16_f32 v167, v54, v55
    v_lshlrev_b32 v40, 16, v148
    v_and_b32 v41, 0xffff0000, v148
    v_lshlrev_b32 v42, 16, v149
    v_and_b32 v43, 0xffff0000, v149
    v_lshlrev_b32 v44, 16, v150
    v_and_b32 v45, 0xffff0000, v150
    v_lshlrev_b32 v46, 16, v151
    v_and_b32 v47, 0xffff0000, v151
    v_pk_fma_f32 v[40:41], v[40:41], v[28:29], v[30:31]
    v_pk_fma_f32 v[42:43], v[42:43], v[28:29], v[30:31]
    v_pk_fma_f32 v[44:45], v[44:45], v[28:29], v[30:31]
    v_pk_fma_f32 v[46:47], v[46:47], v[28:29], v[30:31]
    v_cvt_pk_bf16_f32 v148, v40, v41
    v_cvt_pk_bf16_f32 v149, v42, v43
    v_cvt_pk_bf16_f32 v150, v44, v45
    v_cvt_pk_bf16_f32 v151, v46, v47
    v_lshlrev_b32 v48, 16, v168
    v_and_b32 v49, 0xffff0000, v168
    v_lshlrev_b32 v50, 16, v169
    v_and_b32 v51, 0xffff0000, v169
    v_lshlrev_b32 v52, 16, v170
    v_and_b32 v53, 0xffff0000, v170
    v_lshlrev_b32 v54, 16, v171
    v_and_b32 v55, 0xffff0000, v171
    v_pk_fma_f32 v[48:49], v[48:49], v[32:33], v[34:35]
    v_pk_fma_f32 v[50:51], v[50:51], v[32:33], v[34:35]
    v_pk_fma_f32 v[52:53], v[52:53], v[32:33], v[34:35]
    v_pk_fma_f32 v[54:55], v[54:55], v[32:33], v[34:35]
    v_cvt_pk_bf16_f32 v168, v48, v49
    v_cvt_pk_bf16_f32 v169, v50, v51
    v_cvt_pk_bf16_f32 v170, v52, v53
    v_cvt_pk_bf16_f32 v171, v54, v55
    v_lshlrev_b32 v40, 16, v152
    v_and_b32 v41, 0xffff0000, v152
    v_lshlrev_b32 v42, 16, v153
    v_and_b32 v43, 0xffff0000, v153
    v_lshlrev_b32 v44, 16, v154
    v_and_b32 v45, 0xffff0000, v154
    v_lshlrev_b32 v46, 16, v155
    v_and_b32 v47, 0xffff0000, v155
    v_pk_fma_f32 v[40:41], v[40:41], v[28:29], v[30:31]
    v_pk_fma_f32 v[42:43], v[42:43], v[28:29], v[30:31]
    v_pk_fma_f32 v[44:45], v[44:45], v[28:29], v[30:31]
    v_pk_fma_f32 v[46:47], v[46:47], v[28:29], v[30:31]
    v_cvt_pk_bf16_f32 v152, v40, v41
    v_cvt_pk_bf16_f32 v153, v42, v43
    v_cvt_pk_bf16_f32 v154, v44, v45
    v_cvt_pk_bf16_f32 v155, v46, v47
    v_lshlrev_b32 v48, 16, v172
    v_and_b32 v49, 0xffff0000, v172
    v_lshlrev_b32 v50, 16, v173
    v_and_b32 v51, 0xffff0000, v173
    v_lshlrev_b32 v52, 16, v174
    v_and_b32 v53, 0xffff0000, v174
    v_lshlrev_b32 v54, 16, v175
    v_and_b32 v55, 0xffff0000, v175
    v_pk_fma_f32 v[48:49], v[48:49], v[32:33], v[34:35]
    v_pk_fma_f32 v[50:51], v[50:51], v[32:33], v[34:35]
    v_pk_fma_f32 v[52:53], v[52:53], v[32:33], v[34:35]
    v_pk_fma_f32 v[54:55], v[54:55], v[32:33], v[34:35]
    v_cvt_pk_bf16_f32 v172, v48, v49
    v_cvt_pk_bf16_f32 v173, v50, v51
    v_cvt_pk_bf16_f32 v174, v52, v53
    v_cvt_pk_bf16_f32 v175, v54, v55
    s_waitcnt lgkmcnt(0)
    s_barrier
    ds_write_b128 v16, v[136:139] offset:0
    ds_write_b128 v17, v[156:159] offset:0
    ds_write_b128 v16, v[140:143] offset:128
    ds_write_b128 v17, v[160:163] offset:128
    ds_write_b128 v16, v[144:147] offset:256
    ds_write_b128 v17, v[164:167] offset:256
    ds_write_b128 v16, v[148:151] offset:384
    ds_write_b128 v17, v[168:171] offset:384
    ds_write_b128 v16, v[152:155] offset:512
    ds_write_b128 v17, v[172:175] offset:512
    s_waitcnt lgkmcnt(0)
    s_barrier
    ds_read_b128 v[136:139], v20 offset:0
    ds_read_b128 v[216:219], v22 offset:0
    ds_read_b128 v[140:143], v21 offset:0
    ds_read_b128 v[220:223], v23 offset:0
    ds_read_b128 v[144:147], v20 offset:128
    ds_read_b128 v[224:227], v22 offset:128
    ds_read_b128 v[148:151], v21 offset:128
    ds_read_b128 v[228:231], v23 offset:128
    ds_read_b128 v[152:155], v20 offset:256
    ds_read_b128 v[232:235], v22 offset:256
    ds_read_b128 v[156:159], v21 offset:256
    ds_read_b128 v[236:239], v23 offset:256
    ds_read_b128 v[160:163], v20 offset:384
    ds_read_b128 v[240:243], v22 offset:384
    ds_read_b128 v[164:167], v21 offset:384
    ds_read_b128 v[244:247], v23 offset:384
    ds_read_b128 v[168:171], v20 offset:512
    ds_read_b128 v[248:251], v22 offset:512
    ds_read_b128 v[172:175], v21 offset:512
    ds_read_b128 v[252:255], v23 offset:512
    s_waitcnt lgkmcnt(0)
    s_or_b32 s57, s2, s36
    s_cmp_lg_u32 s57, 0
    s_nop 0
    s_cbranch_scc1 .k1nz_3
    v_mov_b32 v24, 0
    v_mov_b32 v25, 0
    v_mov_b32 v26, 0
    v_mov_b32 v27, 0
    v_lshlrev_b32 v22, 5, v0
    s_mov_b32 s57, 26935296
    buffer_store_dwordx4 v[24:27], v22, s[28:31], s57 offen
    buffer_store_dwordx4 v[24:27], v22, s[28:31], s57 offen offset:16
    s_waitcnt vmcnt(0)
    s_nop 0
.k1nz_3:
    s_waitcnt vmcnt(0)
    buffer_store_dwordx4 v[56:59], v64, s[28:31], 0 offen
    buffer_store_dwordx4 v[60:63], v65, s[28:31], 0 offen
    s_cmp_ge_u32 s35, 6
    s_nop 0
    s_cbranch_scc1 .k1g_5
    s_cmp_ge_u32 s35, 4
    s_nop 0
    s_cbranch_scc1 .k1v_4
    v_and_b32 v11, 15, v0
    v_lshrrev_b32 v12, 4, v0
    s_waitcnt lgkmcnt(0)
    s_barrier
    v_bfe_u32 v16, v0, 2, 2
    v_and_b32 v17, 3, v0
    v_lshl_add_u32 v18, v12, 3, v16
    v_and_b32 v19, 1, v12
    v_mul_u32_u24 v21, 192, v18
    v_lshl_add_u32 v21, v17, 3, v21
    s_cmp_eq_u32 s38, 0
    s_cselect_b32 s50, 0, 2
    v_xor_b32 v20, s50, v19
    v_lshl_add_u32 v6, v20, 5, v21
    s_cmp_eq_u32 s38, 0
    s_cselect_b32 s50, 1, 3
    v_xor_b32 v20, s50, v19
    v_lshl_add_u32 v7, v20, 5, v21
    s_cmp_eq_u32 s38, 0
    s_cselect_b32 s50, 4, 5
    v_xor_b32 v20, s50, v19
    v_lshl_add_u32 v8, v20, 5, v21
    v_lshrrev_b32 v20, 1, v16
    v_lshl_or_b32 v19, v19, 1, v20
    v_lshlrev_b32 v21, 7, v18
    v_lshl_add_u32 v21, v17, 3, v21
    v_add_u32 v21, 24576, v21
    s_lshl_b32 s49, s38, 1
    s_add_u32 s50, s49, 0
    v_xor_b32 v20, s50, v19
    v_lshl_add_u32 v9, v20, 5, v21
    s_add_u32 s50, s49, 1
    v_xor_b32 v20, s50, v19
    v_lshl_add_u32 v10, v20, 5, v21
    ds_read_b64_tr_b16 v[16:17], v6 offset:0
    ds_read_b64_tr_b16 v[18:19], v6 offset:768
    ds_read_b64_tr_b16 v[20:21], v7 offset:0
    ds_read_b64_tr_b16 v[22:23], v7 offset:768
    ds_read_b64_tr_b16 v[24:25], v8 offset:0
    ds_read_b64_tr_b16 v[26:27], v8 offset:768
    ds_read_b64_tr_b16 v[28:29], v9 offset:0
    ds_read_b64_tr_b16 v[30:31], v9 offset:512
    ds_read_b64_tr_b16 v[32:33], v10 offset:0
    ds_read_b64_tr_b16 v[34:35], v10 offset:512
    s_waitcnt lgkmcnt(6)
    v_mfma_f32_16x16x32_bf16 v[56:59], v[16:19], v[96:99], 0
    v_mfma_f32_16x16x32_bf16 v[60:63], v[16:19], v[176:179], 0
    ds_read_b64_tr_b16 v[36:37], v6 offset:6144
    ds_read_b64_tr_b16 v[38:39], v6 offset:6912
    v_mfma_f32_16x16x32_bf16 v[64:67], v[20:23], v[96:99], 0
    v_mfma_f32_16x16x32_bf16 v[68:71], v[20:23], v[176:179], 0
    ds_read_b64_tr_b16 v[40:41], v7 offset:6144
    ds_read_b64_tr_b16 v[42:43], v7 offset:6912
    s_mul_i32 s50, s46, 2
    s_mov_b32 s51, s50
    s_add_u32 m0, s47, 81920
    s_nop 0
    buffer_load_dwordx4 v1, s[16:19], s50 offen lds
    s_waitcnt lgkmcnt(4)
    v_mfma_f32_16x16x32_bf16 v[72:75], v[24:27], v[96:99], 0
    v_mfma_f32_16x16x32_bf16 v[76:79], v[24:27], v[176:179], 0
    ds_read_b64_tr_b16 v[44:45], v8 offset:6144
    ds_read_b64_tr_b16 v[46:47], v8 offset:6912
    v_mfma_f32_16x16x32_bf16 v[80:83], v[28:31], v[96:99], 0
    v_mfma_f32_16x16x32_bf16 v[84:87], v[28:31], v[176:179], 0
    ds_read_b64_tr_b16 v[48:49], v9 offset:4096
    ds_read_b64_tr_b16 v[50:51], v9 offset:4608
    s_add_u32 m0, s47, 82944
    s_nop 0
    buffer_load_dwordx4 v2, s[16:19], s50 offen lds
    v_mfma_f32_16x16x32_bf16 v[88:91], v[32:35], v[96:99], 0
    v_mfma_f32_16x16x32_bf16 v[92:95], v[32:35], v[176:179], 0
    ds_read_b64_tr_b16 v[52:53], v10 offset:4096
    ds_read_b64_tr_b16 v[54:55], v10 offset:4608
    s_waitcnt lgkmcnt(6)
    v_mfma_f32_16x16x32_bf16 v[56:59], v[36:39], v[100:103], v[56:59]
    v_mfma_f32_16x16x32_bf16 v[60:63], v[36:39], v[180:183], v[60:63]
    ds_read_b64_tr_b16 v[16:17], v6 offset:12288
    ds_read_b64_tr_b16 v[18:19], v6 offset:13056
    v_mfma_f32_16x16x32_bf16 v[64:67], v[40:43], v[100:103], v[64:67]
    v_mfma_f32_16x16x32_bf16 v[68:71], v[40:43], v[180:183], v[68:71]
    ds_read_b64_tr_b16 v[20:21], v7 offset:12288
    ds_read_b64_tr_b16 v[22:23], v7 offset:13056
    s_add_u32 m0, s47, 83968
    s_nop 0
    buffer_load_dwordx4 v3, s[16:19], s50 offen lds
    s_waitcnt lgkmcnt(4)
    v_mfma_f32_16x16x32_bf16 v[72:75], v[44:47], v[100:103], v[72:75]
    v_mfma_f32_16x16x32_bf16 v[76:79], v[44:47], v[180:183], v[76:79]
    ds_read_b64_tr_b16 v[24:25], v8 offset:12288
    ds_read_b64_tr_b16 v[26:27], v8 offset:13056
    v_mfma_f32_16x16x32_bf16 v[80:83], v[48:51], v[100:103], v[80:83]
    v_mfma_f32_16x16x32_bf16 v[84:87], v[48:51], v[180:183], v[84:87]
    ds_read_b64_tr_b16 v[28:29], v9 offset:8192
    ds_read_b64_tr_b16 v[30:31], v9 offset:8704
    s_add_u32 m0, s48, 81920
    s_nop 0
    buffer_load_dwordx4 v4, s[20:23], s51 offen lds
    v_mfma_f32_16x16x32_bf16 v[88:91], v[52:55], v[100:103], v[88:91]
    v_mfma_f32_16x16x32_bf16 v[92:95], v[52:55], v[180:183], v[92:95]
    ds_read_b64_tr_b16 v[32:33], v10 offset:8192
    ds_read_b64_tr_b16 v[34:35], v10 offset:8704
    s_waitcnt lgkmcnt(6)
    v_mfma_f32_16x16x32_bf16 v[56:59], v[16:19], v[104:107], v[56:59]
    v_mfma_f32_16x16x32_bf16 v[60:63], v[16:19], v[184:187], v[60:63]
    ds_read_b64_tr_b16 v[36:37], v6 offset:18432
    ds_read_b64_tr_b16 v[38:39], v6 offset:19200
    v_mfma_f32_16x16x32_bf16 v[64:67], v[20:23], v[104:107], v[64:67]
    v_mfma_f32_16x16x32_bf16 v[68:71], v[20:23], v[184:187], v[68:71]
    ds_read_b64_tr_b16 v[40:41], v7 offset:18432
    ds_read_b64_tr_b16 v[42:43], v7 offset:19200
    s_add_u32 m0, s48, 82944
    s_nop 0
    buffer_load_dwordx4 v5, s[20:23], s51 offen lds
    s_waitcnt lgkmcnt(4)
    v_mfma_f32_16x16x32_bf16 v[72:75], v[24:27], v[104:107], v[72:75]
    v_mfma_f32_16x16x32_bf16 v[76:79], v[24:27], v[184:187], v[76:79]
    ds_read_b64_tr_b16 v[44:45], v8 offset:18432
    ds_read_b64_tr_b16 v[46:47], v8 offset:19200
    v_mfma_f32_16x16x32_bf16 v[80:83], v[28:31], v[104:107], v[80:83]
    v_mfma_f32_16x16x32_bf16 v[84:87], v[28:31], v[184:187], v[84:87]
    ds_read_b64_tr_b16 v[48:49], v9 offset:12288
    ds_read_b64_tr_b16 v[50:51], v9 offset:12800
    v_mfma_f32_16x16x32_bf16 v[88:91], v[32:35], v[104:107], v[88:91]
    v_mfma_f32_16x16x32_bf16 v[92:95], v[32:35], v[184:187], v[92:95]
    ds_read_b64_tr_b16 v[52:53], v10 offset:12288
    ds_read_b64_tr_b16 v[54:55], v10 offset:12800
    s_waitcnt lgkmcnt(0)
    s_barrier
    v_add_u32 v6, 40960, v6
    v_add_u32 v7, 40960, v7
    v_add_u32 v8, 40960, v8
    v_add_u32 v9, 40960, v9
    v_add_u32 v10, 40960, v10
    v_mfma_f32_16x16x32_bf16 v[56:59], v[36:39], v[108:111], v[56:59]
    v_mfma_f32_16x16x32_bf16 v[60:63], v[36:39], v[188:191], v[60:63]
    ds_read_b64_tr_b16 v[16:17], v6 offset:0
    ds_read_b64_tr_b16 v[18:19], v6 offset:768
    v_mfma_f32_16x16x32_bf16 v[64:67], v[40:43], v[108:111], v[64:67]
    v_mfma_f32_16x16x32_bf16 v[68:71], v[40:43], v[188:191], v[68:71]
    ds_read_b64_tr_b16 v[20:21], v7 offset:0
    ds_read_b64_tr_b16 v[22:23], v7 offset:768
    s_mul_i32 s50, s46, 3
    s_mov_b32 s51, s50
    s_add_u32 m0, s47, 0
    s_nop 0
    buffer_load_dwordx4 v1, s[16:19], s50 offen lds
    v_mfma_f32_16x16x32_bf16 v[72:75], v[44:47], v[108:111], v[72:75]
    v_mfma_f32_16x16x32_bf16 v[76:79], v[44:47], v[188:191], v[76:79]
    ds_read_b64_tr_b16 v[24:25], v8 offset:0
    ds_read_b64_tr_b16 v[26:27], v8 offset:768
    v_mfma_f32_16x16x32_bf16 v[80:83], v[48:51], v[108:111], v[80:83]
    v_mfma_f32_16x16x32_bf16 v[84:87], v[48:51], v[188:191], v[84:87]
    ds_read_b64_tr_b16 v[28:29], v9 offset:0
    ds_read_b64_tr_b16 v[30:31], v9 offset:512
    s_add_u32 m0, s47, 1024
    s_nop 0
    buffer_load_dwordx4 v2, s[16:19], s50 offen lds
    v_mfma_f32_16x16x32_bf16 v[88:91], v[52:55], v[108:111], v[88:91]
    v_mfma_f32_16x16x32_bf16 v[92:95], v[52:55], v[188:191], v[92:95]
    ds_read_b64_tr_b16 v[32:33], v10 offset:0
    ds_read_b64_tr_b16 v[34:35], v10 offset:512
    s_waitcnt lgkmcnt(6)
    v_mfma_f32_16x16x32_bf16 v[56:59], v[16:19], v[112:115], v[56:59]
    v_mfma_f32_16x16x32_bf16 v[60:63], v[16:19], v[192:195], v[60:63]
    ds_read_b64_tr_b16 v[36:37], v6 offset:6144
    ds_read_b64_tr_b16 v[38:39], v6 offset:6912
    v_mfma_f32_16x16x32_bf16 v[64:67], v[20:23], v[112:115], v[64:67]
    v_mfma_f32_16x16x32_bf16 v[68:71], v[20:23], v[192:195], v[68:71]
    ds_read_b64_tr_b16 v[40:41], v7 offset:6144
    ds_read_b64_tr_b16 v[42:43], v7 offset:6912
    s_add_u32 m0, s47, 2048
    s_nop 0
    buffer_load_dwordx4 v3, s[16:19], s50 offen lds
    s_waitcnt lgkmcnt(4)
    v_mfma_f32_16x16x32_bf16 v[72:75], v[24:27], v[112:115], v[72:75]
    v_mfma_f32_16x16x32_bf16 v[76:79], v[24:27], v[192:195], v[76:79]
    ds_read_b64_tr_b16 v[44:45], v8 offset:6144
    ds_read_b64_tr_b16 v[46:47], v8 offset:6912
    v_mfma_f32_16x16x32_bf16 v[80:83], v[28:31], v[112:115], v[80:83]
    v_mfma_f32_16x16x32_bf16 v[84:87], v[28:31], v[192:195], v[84:87]
    ds_read_b64_tr_b16 v[48:49], v9 offset:4096
    ds_read_b64_tr_b16 v[50:51], v9 offset:4608
    s_add_u32 m0, s48, 0
    s_nop 0
    buffer_load_dwordx4 v4, s[20:23], s51 offen lds
    v_mfma_f32_16x16x32_bf16 v[88:91], v[32:35], v[112:115], v[88:91]
    v_mfma_f32_16x16x32_bf16 v[92:95], v[32:35], v[192:195], v[92:95]
    ds_read_b64_tr_b16 v[52:53], v10 offset:4096
    ds_read_b64_tr_b16 v[54:55], v10 offset:4608
    s_waitcnt lgkmcnt(6)
    v_mfma_f32_16x16x32_bf16 v[56:59], v[36:39], v[116:119], v[56:59]
    v_mfma_f32_16x16x32_bf16 v[60:63], v[36:39], v[196:199], v[60:63]
    ds_read_b64_tr_b16 v[16:17], v6 offset:12288
    ds_read_b64_tr_b16 v[18:19], v6 offset:13056
    v_mfma_f32_16x16x32_bf16 v[64:67], v[40:43], v[116:119], v[64:67]
    v_mfma_f32_16x16x32_bf16 v[68:71], v[40:43], v[196:199], v[68:71]
    ds_read_b64_tr_b16 v[20:21], v7 offset:12288
    ds_read_b64_tr_b16 v[22:23], v7 offset:13056
    s_add_u32 m0, s48, 1024
    s_nop 0
    buffer_load_dwordx4 v5, s[20:23], s51 offen lds
    s_waitcnt lgkmcnt(4)
    v_mfma_f32_16x16x32_bf16 v[72:75], v[44:47], v[116:119], v[72:75]
    v_mfma_f32_16x16x32_bf16 v[76:79], v[44:47], v[196:199], v[76:79]
    ds_read_b64_tr_b16 v[24:25], v8 offset:12288
    ds_read_b64_tr_b16 v[26:27], v8 offset:13056
    v_mfma_f32_16x16x32_bf16 v[80:83], v[48:51], v[116:119], v[80:83]
    v_mfma_f32_16x16x32_bf16 v[84:87], v[48:51], v[196:199], v[84:87]
    ds_read_b64_tr_b16 v[28:29], v9 offset:8192
    ds_read_b64_tr_b16 v[30:31], v9 offset:8704
    v_mfma_f32_16x16x32_bf16 v[88:91], v[52:55], v[116:119], v[88:91]
    v_mfma_f32_16x16x32_bf16 v[92:95], v[52:55], v[196:199], v[92:95]
    ds_read_b64_tr_b16 v[32:33], v10 offset:8192
    ds_read_b64_tr_b16 v[34:35], v10 offset:8704
    s_waitcnt lgkmcnt(6)
    v_mfma_f32_16x16x32_bf16 v[56:59], v[16:19], v[120:123], v[56:59]
    v_mfma_f32_16x16x32_bf16 v[60:63], v[16:19], v[200:203], v[60:63]
    ds_read_b64_tr_b16 v[36:37], v6 offset:18432
    ds_read_b64_tr_b16 v[38:39], v6 offset:19200
    v_mfma_f32_16x16x32_bf16 v[64:67], v[20:23], v[120:123], v[64:67]
    v_mfma_f32_16x16x32_bf16 v[68:71], v[20:23], v[200:203], v[68:71]
    ds_read_b64_tr_b16 v[40:41], v7 offset:18432
    ds_read_b64_tr_b16 v[42:43], v7 offset:19200
    s_waitcnt lgkmcnt(4)
    v_mfma_f32_16x16x32_bf16 v[72:75], v[24:27], v[120:123], v[72:75]
    v_mfma_f32_16x16x32_bf16 v[76:79], v[24:27], v[200:203], v[76:79]
    ds_read_b64_tr_b16 v[44:45], v8 offset:18432
    ds_read_b64_tr_b16 v[46:47], v8 offset:19200
    v_mfma_f32_16x16x32_bf16 v[80:83], v[28:31], v[120:123], v[80:83]
    v_mfma_f32_16x16x32_bf16 v[84:87], v[28:31], v[200:203], v[84:87]
    ds_read_b64_tr_b16 v[48:49], v9 offset:12288
    ds_read_b64_tr_b16 v[50:51], v9 offset:12800
    v_mfma_f32_16x16x32_bf16 v[88:91], v[32:35], v[120:123], v[88:91]
    v_mfma_f32_16x16x32_bf16 v[92:95], v[32:35], v[200:203], v[92:95]
    ds_read_b64_tr_b16 v[52:53], v10 offset:12288
    ds_read_b64_tr_b16 v[54:55], v10 offset:12800
    s_waitcnt lgkmcnt(0)
    s_waitcnt vmcnt(5)
    s_barrier
    v_add_u32 v6, 40960, v6
    v_add_u32 v7, 40960, v7
    v_add_u32 v8, 40960, v8
    v_add_u32 v9, 40960, v9
    v_add_u32 v10, 40960, v10
    v_mfma_f32_16x16x32_bf16 v[56:59], v[36:39], v[124:127], v[56:59]
    v_mfma_f32_16x16x32_bf16 v[60:63], v[36:39], v[204:207], v[60:63]
    ds_read_b64_tr_b16 v[16:17], v6 offset:0
    ds_read_b64_tr_b16 v[18:19], v6 offset:768
    v_mfma_f32_16x16x32_bf16 v[64:67], v[40:43], v[124:127], v[64:67]
    v_mfma_f32_16x16x32_bf16 v[68:71], v[40:43], v[204:207], v[68:71]
    ds_read_b64_tr_b16 v[20:21], v7 offset:0
    ds_read_b64_tr_b16 v[22:23], v7 offset:768
    s_mul_i32 s50, s46, 4
    s_mov_b32 s51, s50
    s_add_u32 m0, s47, 40960
    s_nop 0
    buffer_load_dwordx4 v1, s[16:19], s50 offen lds
    v_mfma_f32_16x16x32_bf16 v[72:75], v[44:47], v[124:127], v[72:75]
    v_mfma_f32_16x16x32_bf16 v[76:79], v[44:47], v[204:207], v[76:79]
    ds_read_b64_tr_b16 v[24:25], v8 offset:0
    ds_read_b64_tr_b16 v[26:27], v8 offset:768
    v_mfma_f32_16x16x32_bf16 v[80:83], v[48:51], v[124:127], v[80:83]
    v_mfma_f32_16x16x32_bf16 v[84:87], v[48:51], v[204:207], v[84:87]
    ds_read_b64_tr_b16 v[28:29], v9 offset:0
    ds_read_b64_tr_b16 v[30:31], v9 offset:512
    s_add_u32 m0, s47, 41984
    s_nop 0
    buffer_load_dwordx4 v2, s[16:19], s50 offen lds
    v_mfma_f32_16x16x32_bf16 v[88:91], v[52:55], v[124:127], v[88:91]
    v_mfma_f32_16x16x32_bf16 v[92:95], v[52:55], v[204:207], v[92:95]
    ds_read_b64_tr_b16 v[32:33], v10 offset:0
    ds_read_b64_tr_b16 v[34:35], v10 offset:512
    s_waitcnt lgkmcnt(6)
    v_mfma_f32_16x16x32_bf16 v[56:59], v[16:19], v[128:131], v[56:59]
    v_mfma_f32_16x16x32_bf16 v[60:63], v[16:19], v[208:211], v[60:63]
    ds_read_b64_tr_b16 v[36:37], v6 offset:6144
    ds_read_b64_tr_b16 v[38:39], v6 offset:6912
    v_mfma_f32_16x16x32_bf16 v[64:67], v[20:23], v[128:131], v[64:67]
    v_mfma_f32_16x16x32_bf16 v[68:71], v[20:23], v[208:211], v[68:71]
    ds_read_b64_tr_b16 v[40:41], v7 offset:6144
    ds_read_b64_tr_b16 v[42:43], v7 offset:6912
    s_add_u32 m0, s47, 43008
    s_nop 0
    buffer_load_dwordx4 v3, s[16:19], s50 offen lds
    s_waitcnt lgkmcnt(4)
    v_mfma_f32_16x16x32_bf16 v[72:75], v[24:27], v[128:131], v[72:75]
    v_mfma_f32_16x16x32_bf16 v[76:79], v[24:27], v[208:211], v[76:79]
    ds_read_b64_tr_b16 v[44:45], v8 offset:6144
    ds_read_b64_tr_b16 v[46:47], v8 offset:6912
    v_mfma_f32_16x16x32_bf16 v[80:83], v[28:31], v[128:131], v[80:83]
    v_mfma_f32_16x16x32_bf16 v[84:87], v[28:31], v[208:211], v[84:87]
    ds_read_b64_tr_b16 v[48:49], v9 offset:4096
    ds_read_b64_tr_b16 v[50:51], v9 offset:4608
    s_add_u32 m0, s48, 40960
    s_nop 0
    buffer_load_dwordx4 v4, s[20:23], s51 offen lds
    v_mfma_f32_16x16x32_bf16 v[88:91], v[32:35], v[128:131], v[88:91]
    v_mfma_f32_16x16x32_bf16 v[92:95], v[32:35], v[208:211], v[92:95]
    ds_read_b64_tr_b16 v[52:53], v10 offset:4096
    ds_read_b64_tr_b16 v[54:55], v10 offset:4608
    s_waitcnt lgkmcnt(6)
    v_mfma_f32_16x16x32_bf16 v[56:59], v[36:39], v[132:135], v[56:59]
    v_mfma_f32_16x16x32_bf16 v[60:63], v[36:39], v[212:215], v[60:63]
    ds_read_b64_tr_b16 v[16:17], v6 offset:12288
    ds_read_b64_tr_b16 v[18:19], v6 offset:13056
    v_mfma_f32_16x16x32_bf16 v[64:67], v[40:43], v[132:135], v[64:67]
    v_mfma_f32_16x16x32_bf16 v[68:71], v[40:43], v[212:215], v[68:71]
    ds_read_b64_tr_b16 v[20:21], v7 offset:12288
    ds_read_b64_tr_b16 v[22:23], v7 offset:13056
    s_add_u32 m0, s48, 41984
    s_nop 0
    buffer_load_dwordx4 v5, s[20:23], s51 offen lds
    s_waitcnt lgkmcnt(4)
    v_mfma_f32_16x16x32_bf16 v[72:75], v[44:47], v[132:135], v[72:75]
    v_mfma_f32_16x16x32_bf16 v[76:79], v[44:47], v[212:215], v[76:79]
    ds_read_b64_tr_b16 v[24:25], v8 offset:12288
    ds_read_b64_tr_b16 v[26:27], v8 offset:13056
    v_mfma_f32_16x16x32_bf16 v[80:83], v[48:51], v[132:135], v[80:83]
    v_mfma_f32_16x16x32_bf16 v[84:87], v[48:51], v[212:215], v[84:87]
    ds_read_b64_tr_b16 v[28:29], v9 offset:8192
    ds_read_b64_tr_b16 v[30:31], v9 offset:8704
    v_mfma_f32_16x16x32_bf16 v[88:91], v[52:55], v[132:135], v[88:91]
    v_mfma_f32_16x16x32_bf16 v[92:95], v[52:55], v[212:215], v[92:95]
    ds_read_b64_tr_b16 v[32:33], v10 offset:8192
    ds_read_b64_tr_b16 v[34:35], v10 offset:8704
    s_waitcnt lgkmcnt(6)
    v_mfma_f32_16x16x32_bf16 v[56:59], v[16:19], v[136:139], v[56:59]
    v_mfma_f32_16x16x32_bf16 v[60:63], v[16:19], v[216:219], v[60:63]
    ds_read_b64_tr_b16 v[36:37], v6 offset:18432
    ds_read_b64_tr_b16 v[38:39], v6 offset:19200
    v_mfma_f32_16x16x32_bf16 v[64:67], v[20:23], v[136:139], v[64:67]
    v_mfma_f32_16x16x32_bf16 v[68:71], v[20:23], v[216:219], v[68:71]
    ds_read_b64_tr_b16 v[40:41], v7 offset:18432
    ds_read_b64_tr_b16 v[42:43], v7 offset:19200
    s_waitcnt lgkmcnt(4)
    v_mfma_f32_16x16x32_bf16 v[72:75], v[24:27], v[136:139], v[72:75]
    v_mfma_f32_16x16x32_bf16 v[76:79], v[24:27], v[216:219], v[76:79]
    ds_read_b64_tr_b16 v[44:45], v8 offset:18432
    ds_read_b64_tr_b16 v[46:47], v8 offset:19200
    v_mfma_f32_16x16x32_bf16 v[80:83], v[28:31], v[136:139], v[80:83]
    v_mfma_f32_16x16x32_bf16 v[84:87], v[28:31], v[216:219], v[84:87]
    ds_read_b64_tr_b16 v[48:49], v9 offset:12288
    ds_read_b64_tr_b16 v[50:51], v9 offset:12800
    v_mfma_f32_16x16x32_bf16 v[88:91], v[32:35], v[136:139], v[88:91]
    v_mfma_f32_16x16x32_bf16 v[92:95], v[32:35], v[216:219], v[92:95]
    ds_read_b64_tr_b16 v[52:53], v10 offset:12288
    ds_read_b64_tr_b16 v[54:55], v10 offset:12800
    s_waitcnt lgkmcnt(0)
    s_waitcnt vmcnt(5)
    s_barrier
    v_subrev_u32 v6, 81920, v6
    v_subrev_u32 v7, 81920, v7
    v_subrev_u32 v8, 81920, v8
    v_subrev_u32 v9, 81920, v9
    v_subrev_u32 v10, 81920, v10
    v_mfma_f32_16x16x32_bf16 v[56:59], v[36:39], v[140:143], v[56:59]
    v_mfma_f32_16x16x32_bf16 v[60:63], v[36:39], v[220:223], v[60:63]
    ds_read_b64_tr_b16 v[16:17], v6 offset:0
    ds_read_b64_tr_b16 v[18:19], v6 offset:768
    v_mfma_f32_16x16x32_bf16 v[64:67], v[40:43], v[140:143], v[64:67]
    v_mfma_f32_16x16x32_bf16 v[68:71], v[40:43], v[220:223], v[68:71]
    ds_read_b64_tr_b16 v[20:21], v7 offset:0
    ds_read_b64_tr_b16 v[22:23], v7 offset:768
    s_mul_i32 s50, s46, 0
    s_add_u32 s51, s50, s56
    s_add_u32 s50, s50, 128
    s_add_u32 m0, s47, 81920
    s_nop 0
    buffer_load_dwordx4 v1, s[20:23], s50 offen lds
    v_mfma_f32_16x16x32_bf16 v[72:75], v[44:47], v[140:143], v[72:75]
    v_mfma_f32_16x16x32_bf16 v[76:79], v[44:47], v[220:223], v[76:79]
    ds_read_b64_tr_b16 v[24:25], v8 offset:0
    ds_read_b64_tr_b16 v[26:27], v8 offset:768
    v_mfma_f32_16x16x32_bf16 v[80:83], v[48:51], v[140:143], v[80:83]
    v_mfma_f32_16x16x32_bf16 v[84:87], v[48:51], v[220:223], v[84:87]
    ds_read_b64_tr_b16 v[28:29], v9 offset:0
    ds_read_b64_tr_b16 v[30:31], v9 offset:512
    s_add_u32 m0, s47, 82944
    s_nop 0
    buffer_load_dwordx4 v2, s[20:23], s50 offen lds
    v_mfma_f32_16x16x32_bf16 v[88:91], v[52:55], v[140:143], v[88:91]
    v_mfma_f32_16x16x32_bf16 v[92:95], v[52:55], v[220:223], v[92:95]
    ds_read_b64_tr_b16 v[32:33], v10 offset:0
    ds_read_b64_tr_b16 v[34:35], v10 offset:512
    s_waitcnt lgkmcnt(6)
    v_mfma_f32_16x16x32_bf16 v[56:59], v[16:19], v[144:147], v[56:59]
    v_mfma_f32_16x16x32_bf16 v[60:63], v[16:19], v[224:227], v[60:63]
    ds_read_b64_tr_b16 v[36:37], v6 offset:6144
    ds_read_b64_tr_b16 v[38:39], v6 offset:6912
    v_mfma_f32_16x16x32_bf16 v[64:67], v[20:23], v[144:147], v[64:67]
    v_mfma_f32_16x16x32_bf16 v[68:71], v[20:23], v[224:227], v[68:71]
    ds_read_b64_tr_b16 v[40:41], v7 offset:6144
    ds_read_b64_tr_b16 v[42:43], v7 offset:6912
    s_add_u32 m0, s47, 83968
    s_nop 0
    buffer_load_dwordx4 v3, s[20:23], s50 offen lds
    s_waitcnt lgkmcnt(4)
    v_mfma_f32_16x16x32_bf16 v[72:75], v[24:27], v[144:147], v[72:75]
    v_mfma_f32_16x16x32_bf16 v[76:79], v[24:27], v[224:227], v[76:79]
    ds_read_b64_tr_b16 v[44:45], v8 offset:6144
    ds_read_b64_tr_b16 v[46:47], v8 offset:6912
    v_mfma_f32_16x16x32_bf16 v[80:83], v[28:31], v[144:147], v[80:83]
    v_mfma_f32_16x16x32_bf16 v[84:87], v[28:31], v[224:227], v[84:87]
    ds_read_b64_tr_b16 v[48:49], v9 offset:4096
    ds_read_b64_tr_b16 v[50:51], v9 offset:4608
    s_add_u32 m0, s48, 81920
    s_nop 0
    buffer_load_dwordx4 v4, s[16:19], s51 offen lds
    v_mfma_f32_16x16x32_bf16 v[88:91], v[32:35], v[144:147], v[88:91]
    v_mfma_f32_16x16x32_bf16 v[92:95], v[32:35], v[224:227], v[92:95]
    ds_read_b64_tr_b16 v[52:53], v10 offset:4096
    ds_read_b64_tr_b16 v[54:55], v10 offset:4608
    s_waitcnt lgkmcnt(6)
    v_mfma_f32_16x16x32_bf16 v[56:59], v[36:39], v[148:151], v[56:59]
    v_mfma_f32_16x16x32_bf16 v[60:63], v[36:39], v[228:231], v[60:63]
    ds_read_b64_tr_b16 v[16:17], v6 offset:12288
    ds_read_b64_tr_b16 v[18:19], v6 offset:13056
    v_mfma_f32_16x16x32_bf16 v[64:67], v[40:43], v[148:151], v[64:67]
    v_mfma_f32_16x16x32_bf16 v[68:71], v[40:43], v[228:231], v[68:71]
    ds_read_b64_tr_b16 v[20:21], v7 offset:12288
    ds_read_b64_tr_b16 v[22:23], v7 offset:13056
    s_add_u32 m0, s48, 82944
    s_nop 0
    buffer_load_dwordx4 v5, s[16:19], s51 offen lds
    s_waitcnt lgkmcnt(4)
    v_mfma_f32_16x16x32_bf16 v[72:75], v[44:47], v[148:151], v[72:75]
    v_mfma_f32_16x16x32_bf16 v[76:79], v[44:47], v[228:231], v[76:79]
    ds_read_b64_tr_b16 v[24:25], v8 offset:12288
    ds_read_b64_tr_b16 v[26:27], v8 offset:13056
    v_mfma_f32_16x16x32_bf16 v[80:83], v[48:51], v[148:151], v[80:83]
    v_mfma_f32_16x16x32_bf16 v[84:87], v[48:51], v[228:231], v[84:87]
    ds_read_b64_tr_b16 v[28:29], v9 offset:8192
    ds_read_b64_tr_b16 v[30:31], v9 offset:8704
    v_mfma_f32_16x16x32_bf16 v[88:91], v[52:55], v[148:151], v[88:91]
    v_mfma_f32_16x16x32_bf16 v[92:95], v[52:55], v[228:231], v[92:95]
    ds_read_b64_tr_b16 v[32:33], v10 offset:8192
    ds_read_b64_tr_b16 v[34:35], v10 offset:8704
    s_waitcnt lgkmcnt(6)
    v_mfma_f32_16x16x32_bf16 v[56:59], v[16:19], v[152:155], v[56:59]
    v_mfma_f32_16x16x32_bf16 v[60:63], v[16:19], v[232:235], v[60:63]
    ds_read_b64_tr_b16 v[36:37], v6 offset:18432
    ds_read_b64_tr_b16 v[38:39], v6 offset:19200
    v_mfma_f32_16x16x32_bf16 v[64:67], v[20:23], v[152:155], v[64:67]
    v_mfma_f32_16x16x32_bf16 v[68:71], v[20:23], v[232:235], v[68:71]
    ds_read_b64_tr_b16 v[40:41], v7 offset:18432
    ds_read_b64_tr_b16 v[42:43], v7 offset:19200
    s_waitcnt lgkmcnt(4)
    v_mfma_f32_16x16x32_bf16 v[72:75], v[24:27], v[152:155], v[72:75]
    v_mfma_f32_16x16x32_bf16 v[76:79], v[24:27], v[232:235], v[76:79]
    ds_read_b64_tr_b16 v[44:45], v8 offset:18432
    ds_read_b64_tr_b16 v[46:47], v8 offset:19200
    v_mfma_f32_16x16x32_bf16 v[80:83], v[28:31], v[152:155], v[80:83]
    v_mfma_f32_16x16x32_bf16 v[84:87], v[28:31], v[232:235], v[84:87]
    ds_read_b64_tr_b16 v[48:49], v9 offset:12288
    ds_read_b64_tr_b16 v[50:51], v9 offset:12800
    v_mfma_f32_16x16x32_bf16 v[88:91], v[32:35], v[152:155], v[88:91]
    v_mfma_f32_16x16x32_bf16 v[92:95], v[32:35], v[232:235], v[92:95]
    ds_read_b64_tr_b16 v[52:53], v10 offset:12288
    ds_read_b64_tr_b16 v[54:55], v10 offset:12800
    s_waitcnt lgkmcnt(0)
    s_waitcnt vmcnt(5)
    s_barrier
    v_add_u32 v6, 40960, v6
    v_add_u32 v7, 40960, v7
    v_add_u32 v8, 40960, v8
    v_add_u32 v9, 40960, v9
    v_add_u32 v10, 40960, v10
    v_mfma_f32_16x16x32_bf16 v[56:59], v[36:39], v[156:159], v[56:59]
    v_mfma_f32_16x16x32_bf16 v[60:63], v[36:39], v[236:239], v[60:63]
    ds_read_b64_tr_b16 v[16:17], v6 offset:0
    ds_read_b64_tr_b16 v[18:19], v6 offset:768
    v_mfma_f32_16x16x32_bf16 v[64:67], v[40:43], v[156:159], v[64:67]
    v_mfma_f32_16x16x32_bf16 v[68:71], v[40:43], v[236:239], v[68:71]
    ds_read_b64_tr_b16 v[20:21], v7 offset:0
    ds_read_b64_tr_b16 v[22:23], v7 offset:768
    s_mul_i32 s50, s46, 1
    s_add_u32 s51, s50, s56
    s_add_u32 s50, s50, 128
    s_add_u32 m0, s47, 0
    s_nop 0
    buffer_load_dwordx4 v1, s[20:23], s50 offen lds
    v_mfma_f32_16x16x32_bf16 v[72:75], v[44:47], v[156:159], v[72:75]
    v_mfma_f32_16x16x32_bf16 v[76:79], v[44:47], v[236:239], v[76:79]
    ds_read_b64_tr_b16 v[24:25], v8 offset:0
    ds_read_b64_tr_b16 v[26:27], v8 offset:768
    v_mfma_f32_16x16x32_bf16 v[80:83], v[48:51], v[156:159], v[80:83]
    v_mfma_f32_16x16x32_bf16 v[84:87], v[48:51], v[236:239], v[84:87]
    ds_read_b64_tr_b16 v[28:29], v9 offset:0
    ds_read_b64_tr_b16 v[30:31], v9 offset:512
    s_add_u32 m0, s47, 1024
    s_nop 0
    buffer_load_dwordx4 v2, s[20:23], s50 offen lds
    v_mfma_f32_16x16x32_bf16 v[88:91], v[52:55], v[156:159], v[88:91]
    v_mfma_f32_16x16x32_bf16 v[92:95], v[52:55], v[236:239], v[92:95]
    ds_read_b64_tr_b16 v[32:33], v10 offset:0
    ds_read_b64_tr_b16 v[34:35], v10 offset:512
    s_waitcnt lgkmcnt(6)
    v_mfma_f32_16x16x32_bf16 v[56:59], v[16:19], v[160:163], v[56:59]
    v_mfma_f32_16x16x32_bf16 v[60:63], v[16:19], v[240:243], v[60:63]
    ds_read_b64_tr_b16 v[36:37], v6 offset:6144
    ds_read_b64_tr_b16 v[38:39], v6 offset:6912
    v_mfma_f32_16x16x32_bf16 v[64:67], v[20:23], v[160:163], v[64:67]
    v_mfma_f32_16x16x32_bf16 v[68:71], v[20:23], v[240:243], v[68:71]
    ds_read_b64_tr_b16 v[40:41], v7 offset:6144
    ds_read_b64_tr_b16 v[42:43], v7 offset:6912
    s_add_u32 m0, s47, 2048
    s_nop 0
    buffer_load_dwordx4 v3, s[20:23], s50 offen lds
    s_waitcnt lgkmcnt(4)
    v_mfma_f32_16x16x32_bf16 v[72:75], v[24:27], v[160:163], v[72:75]
    v_mfma_f32_16x16x32_bf16 v[76:79], v[24:27], v[240:243], v[76:79]
    ds_read_b64_tr_b16 v[44:45], v8 offset:6144
    ds_read_b64_tr_b16 v[46:47], v8 offset:6912
    v_mfma_f32_16x16x32_bf16 v[80:83], v[28:31], v[160:163], v[80:83]
    v_mfma_f32_16x16x32_bf16 v[84:87], v[28:31], v[240:243], v[84:87]
    ds_read_b64_tr_b16 v[48:49], v9 offset:4096
    ds_read_b64_tr_b16 v[50:51], v9 offset:4608
    s_add_u32 m0, s48, 0
    s_nop 0
    buffer_load_dwordx4 v4, s[16:19], s51 offen lds
    v_mfma_f32_16x16x32_bf16 v[88:91], v[32:35], v[160:163], v[88:91]
    v_mfma_f32_16x16x32_bf16 v[92:95], v[32:35], v[240:243], v[92:95]
    ds_read_b64_tr_b16 v[52:53], v10 offset:4096
    ds_read_b64_tr_b16 v[54:55], v10 offset:4608
    s_waitcnt lgkmcnt(6)
    v_mfma_f32_16x16x32_bf16 v[56:59], v[36:39], v[164:167], v[56:59]
    v_mfma_f32_16x16x32_bf16 v[60:63], v[36:39], v[244:247], v[60:63]
    ds_read_b64_tr_b16 v[16:17], v6 offset:12288
    ds_read_b64_tr_b16 v[18:19], v6 offset:13056
    v_mfma_f32_16x16x32_bf16 v[64:67], v[40:43], v[164:167], v[64:67]
    v_mfma_f32_16x16x32_bf16 v[68:71], v[40:43], v[244:247], v[68:71]
    ds_read_b64_tr_b16 v[20:21], v7 offset:12288
    ds_read_b64_tr_b16 v[22:23], v7 offset:13056
    s_add_u32 m0, s48, 1024
    s_nop 0
    buffer_load_dwordx4 v5, s[16:19], s51 offen lds
    s_waitcnt lgkmcnt(4)
    v_mfma_f32_16x16x32_bf16 v[72:75], v[44:47], v[164:167], v[72:75]
    v_mfma_f32_16x16x32_bf16 v[76:79], v[44:47], v[244:247], v[76:79]
    ds_read_b64_tr_b16 v[24:25], v8 offset:12288
    ds_read_b64_tr_b16 v[26:27], v8 offset:13056
    v_mfma_f32_16x16x32_bf16 v[80:83], v[48:51], v[164:167], v[80:83]
    v_mfma_f32_16x16x32_bf16 v[84:87], v[48:51], v[244:247], v[84:87]
    ds_read_b64_tr_b16 v[28:29], v9 offset:8192
    ds_read_b64_tr_b16 v[30:31], v9 offset:8704
    v_mfma_f32_16x16x32_bf16 v[88:91], v[52:55], v[164:167], v[88:91]
    v_mfma_f32_16x16x32_bf16 v[92:95], v[52:55], v[244:247], v[92:95]
    ds_read_b64_tr_b16 v[32:33], v10 offset:8192
    ds_read_b64_tr_b16 v[34:35], v10 offset:8704
    s_waitcnt lgkmcnt(6)
    v_mfma_f32_16x16x32_bf16 v[56:59], v[16:19], v[168:171], v[56:59]
    v_mfma_f32_16x16x32_bf16 v[60:63], v[16:19], v[248:251], v[60:63]
    ds_read_b64_tr_b16 v[36:37], v6 offset:18432
    ds_read_b64_tr_b16 v[38:39], v6 offset:19200
    v_mfma_f32_16x16x32_bf16 v[64:67], v[20:23], v[168:171], v[64:67]
    v_mfma_f32_16x16x32_bf16 v[68:71], v[20:23], v[248:251], v[68:71]
    ds_read_b64_tr_b16 v[40:41], v7 offset:18432
    ds_read_b64_tr_b16 v[42:43], v7 offset:19200
    s_waitcnt lgkmcnt(4)
    v_mfma_f32_16x16x32_bf16 v[72:75], v[24:27], v[168:171], v[72:75]
    v_mfma_f32_16x16x32_bf16 v[76:79], v[24:27], v[248:251], v[76:79]
    ds_read_b64_tr_b16 v[44:45], v8 offset:18432
    ds_read_b64_tr_b16 v[46:47], v8 offset:19200
    v_mfma_f32_16x16x32_bf16 v[80:83], v[28:31], v[168:171], v[80:83]
    v_mfma_f32_16x16x32_bf16 v[84:87], v[28:31], v[248:251], v[84:87]
    ds_read_b64_tr_b16 v[48:49], v9 offset:12288
    ds_read_b64_tr_b16 v[50:51], v9 offset:12800
    v_mfma_f32_16x16x32_bf16 v[88:91], v[32:35], v[168:171], v[88:91]
    v_mfma_f32_16x16x32_bf16 v[92:95], v[32:35], v[248:251], v[92:95]
    ds_read_b64_tr_b16 v[52:53], v10 offset:12288
    ds_read_b64_tr_b16 v[54:55], v10 offset:12800
    s_waitcnt lgkmcnt(0)
    s_waitcnt vmcnt(5)
    s_barrier
    v_bfe_u32 v16, v0, 2, 2
    v_and_b32 v17, 3, v0
    v_lshl_add_u32 v18, v12, 3, v16
    v_and_b32 v19, 1, v12
    v_mul_u32_u24 v21, 192, v18
    v_lshl_add_u32 v21, v17, 3, v21
    v_add_u32 v21, 81920, v21
    s_cmp_eq_u32 s38, 0
    s_cselect_b32 s50, 0, 1
    v_xor_b32 v20, s50, v19
    v_lshl_add_u32 v6, v20, 5, v21
    s_cmp_eq_u32 s38, 0
    s_cselect_b32 s50, 2, 4
    v_xor_b32 v20, s50, v19
    v_lshl_add_u32 v7, v20, 5, v21
    s_cmp_eq_u32 s38, 0
    s_cselect_b32 s50, 3, 5
    v_xor_b32 v20, s50, v19
    v_lshl_add_u32 v8, v20, 5, v21
    v_lshrrev_b32 v20, 1, v16
    v_lshl_or_b32 v19, v19, 1, v20
    v_lshlrev_b32 v21, 7, v18
    v_lshl_add_u32 v21, v17, 3, v21
    v_add_u32 v21, 106496, v21
    s_lshl_b32 s49, s38, 1
    s_add_u32 s50, s49, 0
    v_xor_b32 v20, s50, v19
    v_lshl_add_u32 v9, v20, 5, v21
    s_add_u32 s50, s49, 1
    v_xor_b32 v20, s50, v19
    v_lshl_add_u32 v10, v20, 5, v21
    v_mfma_f32_16x16x32_bf16 v[56:59], v[36:39], v[172:175], v[56:59]
    v_mfma_f32_16x16x32_bf16 v[60:63], v[36:39], v[252:255], v[60:63]
    ds_read_b64_tr_b16 v[16:17], v6 offset:0
    ds_read_b64_tr_b16 v[18:19], v6 offset:768
    v_mfma_f32_16x16x32_bf16 v[64:67], v[40:43], v[172:175], v[64:67]
    v_mfma_f32_16x16x32_bf16 v[68:71], v[40:43], v[252:255], v[68:71]
    ds_read_b64_tr_b16 v[20:21], v7 offset:0
    ds_read_b64_tr_b16 v[22:23], v7 offset:768
    s_mul_i32 s50, s46, 2
    s_add_u32 s51, s50, s56
    s_add_u32 s50, s50, 128
    s_add_u32 m0, s47, 40960
    s_nop 0
    buffer_load_dwordx4 v1, s[20:23], s50 offen lds
    v_mfma_f32_16x16x32_bf16 v[72:75], v[44:47], v[172:175], v[72:75]
    v_mfma_f32_16x16x32_bf16 v[76:79], v[44:47], v[252:255], v[76:79]
    ds_read_b64_tr_b16 v[24:25], v8 offset:0
    ds_read_b64_tr_b16 v[26:27], v8 offset:768
    v_mfma_f32_16x16x32_bf16 v[80:83], v[48:51], v[172:175], v[80:83]
    v_mfma_f32_16x16x32_bf16 v[84:87], v[48:51], v[252:255], v[84:87]
    ds_read_b64_tr_b16 v[28:29], v9 offset:0
    ds_read_b64_tr_b16 v[30:31], v9 offset:512
    s_add_u32 m0, s47, 41984
    s_nop 0
    buffer_load_dwordx4 v2, s[20:23], s50 offen lds
    v_mfma_f32_16x16x32_bf16 v[88:91], v[52:55], v[172:175], v[88:91]
    v_mfma_f32_16x16x32_bf16 v[92:95], v[52:55], v[252:255], v[92:95]
    ds_read_b64_tr_b16 v[32:33], v10 offset:0
    ds_read_b64_tr_b16 v[34:35], v10 offset:512
    s_and_b32 s52, s35, 1
    s_mul_i32 s52, s52, 80
    s_lshr_b32 s53, s35, 1
    s_mul_i32 s53, s53, 4194304
    s_mul_i32 s55, s39, 40
    s_add_u32 s53, s53, s55
    v_lshlrev_b32 v13, 3, v11
    s_cmp_eq_u32 s38, 0
    s_cselect_b32 s54, 0, 2
    s_lshl_b32 s54, s54, 2
    s_add_u32 s54, s54, s52
    v_add_u32 v36, s54, v12
    v_mul_u32_u24 v37, 205, v36
    v_lshrrev_b32 v37, 10, v37
    v_mul_u32_u24 v38, 5, v37
    v_sub_u32 v38, v36, v38
    v_mul_u32_u24 v37, 81920, v37
    v_lshl_add_u32 v37, v38, 7, v37
    v_add_u32 v37, v37, v13
    v_cvt_pk_bf16_f32 v40, v56, v57
    v_cvt_pk_bf16_f32 v41, v58, v59
    buffer_store_dwordx2 v[40:41], v37, s[28:31], s53 offen offset:0
    v_cvt_pk_bf16_f32 v42, v60, v61
    v_cvt_pk_bf16_f32 v43, v62, v63
    buffer_store_dwordx2 v[42:43], v37, s[28:31], s53 offen offset:640
    s_cmp_eq_u32 s38, 0
    s_cselect_b32 s54, 1, 3
    s_lshl_b32 s54, s54, 2
    s_add_u32 s54, s54, s52
    v_add_u32 v44, s54, v12
    v_mul_u32_u24 v45, 205, v44
    v_lshrrev_b32 v45, 10, v45
    v_mul_u32_u24 v46, 5, v45
    v_sub_u32 v46, v44, v46
    v_mul_u32_u24 v45, 81920, v45
    v_lshl_add_u32 v45, v46, 7, v45
    v_add_u32 v45, v45, v13
    v_cvt_pk_bf16_f32 v48, v64, v65
    v_cvt_pk_bf16_f32 v49, v66, v67
    buffer_store_dwordx2 v[48:49], v45, s[28:31], s53 offen offset:0
    v_cvt_pk_bf16_f32 v50, v68, v69
    v_cvt_pk_bf16_f32 v51, v70, v71
    buffer_store_dwordx2 v[50:51], v45, s[28:31], s53 offen offset:640
    s_cmp_eq_u32 s38, 0
    s_cselect_b32 s54, 4, 5
    s_lshl_b32 s54, s54, 2
    s_add_u32 s54, s54, s52
    v_add_u32 v36, s54, v12
    v_mul_u32_u24 v37, 205, v36
    v_lshrrev_b32 v37, 10, v37
    v_mul_u32_u24 v38, 5, v37
    v_sub_u32 v38, v36, v38
    v_mul_u32_u24 v37, 81920, v37
    v_lshl_add_u32 v37, v38, 7, v37
    v_add_u32 v37, v37, v13
    v_cvt_pk_bf16_f32 v40, v72, v73
    v_cvt_pk_bf16_f32 v41, v74, v75
    buffer_store_dwordx2 v[40:41], v37, s[28:31], s53 offen offset:0
    v_cvt_pk_bf16_f32 v42, v76, v77
    v_cvt_pk_bf16_f32 v43, v78, v79
    buffer_store_dwordx2 v[42:43], v37, s[28:31], s53 offen offset:640
    s_cmp_eq_u32 s38, 0
    s_cselect_b32 s54, 6, 8
    s_lshl_b32 s54, s54, 2
    s_add_u32 s54, s54, s52
    v_add_u32 v44, s54, v12
    v_mul_u32_u24 v45, 205, v44
    v_lshrrev_b32 v45, 10, v45
    v_mul_u32_u24 v46, 5, v45
    v_sub_u32 v46, v44, v46
    v_mul_u32_u24 v45, 81920, v45
    v_lshl_add_u32 v45, v46, 7, v45
    v_add_u32 v45, v45, v13
    v_cvt_pk_bf16_f32 v48, v80, v81
    v_cvt_pk_bf16_f32 v49, v82, v83
    buffer_store_dwordx2 v[48:49], v45, s[28:31], s53 offen offset:0
    v_cvt_pk_bf16_f32 v50, v84, v85
    v_cvt_pk_bf16_f32 v51, v86, v87
    buffer_store_dwordx2 v[50:51], v45, s[28:31], s53 offen offset:640
    s_cmp_eq_u32 s38, 0
    s_cselect_b32 s54, 7, 9
    s_lshl_b32 s54, s54, 2
    s_add_u32 s54, s54, s52
    v_add_u32 v36, s54, v12
    v_mul_u32_u24 v37, 205, v36
    v_lshrrev_b32 v37, 10, v37
    v_mul_u32_u24 v38, 5, v37
    v_sub_u32 v38, v36, v38
    v_mul_u32_u24 v37, 81920, v37
    v_lshl_add_u32 v37, v38, 7, v37
    v_add_u32 v37, v37, v13
    v_cvt_pk_bf16_f32 v40, v88, v89
    v_cvt_pk_bf16_f32 v41, v90, v91
    buffer_store_dwordx2 v[40:41], v37, s[28:31], s53 offen offset:0
    v_cvt_pk_bf16_f32 v42, v92, v93
    v_cvt_pk_bf16_f32 v43, v94, v95
    buffer_store_dwordx2 v[42:43], v37, s[28:31], s53 offen offset:640
    s_waitcnt lgkmcnt(6)
    v_mfma_f32_16x16x32_bf16 v[56:59], v[16:19], v[96:99], 0
    v_mfma_f32_16x16x32_bf16 v[60:63], v[16:19], v[176:179], 0
    ds_read_b64_tr_b16 v[36:37], v6 offset:6144
    ds_read_b64_tr_b16 v[38:39], v6 offset:6912
    v_mfma_f32_16x16x32_bf16 v[64:67], v[20:23], v[96:99], 0
    v_mfma_f32_16x16x32_bf16 v[68:71], v[20:23], v[176:179], 0
    ds_read_b64_tr_b16 v[40:41], v7 offset:6144
    ds_read_b64_tr_b16 v[42:43], v7 offset:6912
    s_add_u32 m0, s47, 43008
    s_nop 0
    buffer_load_dwordx4 v3, s[20:23], s50 offen lds
    s_waitcnt lgkmcnt(4)
    v_mfma_f32_16x16x32_bf16 v[72:75], v[24:27], v[96:99], 0
    v_mfma_f32_16x16x32_bf16 v[76:79], v[24:27], v[176:179], 0
    ds_read_b64_tr_b16 v[44:45], v8 offset:6144
    ds_read_b64_tr_b16 v[46:47], v8 offset:6912
    v_mfma_f32_16x16x32_bf16 v[80:83], v[28:31], v[96:99], 0
    v_mfma_f32_16x16x32_bf16 v[84:87], v[28:31], v[176:179], 0
    ds_read_b64_tr_b16 v[48:49], v9 offset:4096
    ds_read_b64_tr_b16 v[50:51], v9 offset:4608
    s_add_u32 m0, s48, 40960
    s_nop 0
    buffer_load_dwordx4 v4, s[16:19], s51 offen lds
    v_mfma_f32_16x16x32_bf16 v[88:91], v[32:35], v[96:99], 0
    v_mfma_f32_16x16x32_bf16 v[92:95], v[32:35], v[176:179], 0
    ds_read_b64_tr_b16 v[52:53], v10 offset:4096
    ds_read_b64_tr_b16 v[54:55], v10 offset:4608
    s_waitcnt lgkmcnt(6)
    v_mfma_f32_16x16x32_bf16 v[56:59], v[36:39], v[100:103], v[56:59]
    v_mfma_f32_16x16x32_bf16 v[60:63], v[36:39], v[180:183], v[60:63]
    ds_read_b64_tr_b16 v[16:17], v6 offset:12288
    ds_read_b64_tr_b16 v[18:19], v6 offset:13056
    v_mfma_f32_16x16x32_bf16 v[64:67], v[40:43], v[100:103], v[64:67]
    v_mfma_f32_16x16x32_bf16 v[68:71], v[40:43], v[180:183], v[68:71]
    ds_read_b64_tr_b16 v[20:21], v7 offset:12288
    ds_read_b64_tr_b16 v[22:23], v7 offset:13056
    s_add_u32 m0, s48, 41984
    s_nop 0
    buffer_load_dwordx4 v5, s[16:19], s51 offen lds
    s_waitcnt lgkmcnt(4)
    v_mfma_f32_16x16x32_bf16 v[72:75], v[44:47], v[100:103], v[72:75]
    v_mfma_f32_16x16x32_bf16 v[76:79], v[44:47], v[180:183], v[76:79]
    ds_read_b64_tr_b16 v[24:25], v8 offset:12288
    ds_read_b64_tr_b16 v[26:27], v8 offset:13056
    v_mfma_f32_16x16x32_bf16 v[80:83], v[48:51], v[100:103], v[80:83]
    v_mfma_f32_16x16x32_bf16 v[84:87], v[48:51], v[180:183], v[84:87]
    ds_read_b64_tr_b16 v[28:29], v9 offset:8192
    ds_read_b64_tr_b16 v[30:31], v9 offset:8704
    v_mfma_f32_16x16x32_bf16 v[88:91], v[52:55], v[100:103], v[88:91]
    v_mfma_f32_16x16x32_bf16 v[92:95], v[52:55], v[180:183], v[92:95]
    ds_read_b64_tr_b16 v[32:33], v10 offset:8192
    ds_read_b64_tr_b16 v[34:35], v10 offset:8704
    s_waitcnt lgkmcnt(6)
    v_mfma_f32_16x16x32_bf16 v[56:59], v[16:19], v[104:107], v[56:59]
    v_mfma_f32_16x16x32_bf16 v[60:63], v[16:19], v[184:187], v[60:63]
    ds_read_b64_tr_b16 v[36:37], v6 offset:18432
    ds_read_b64_tr_b16 v[38:39], v6 offset:19200
    v_mfma_f32_16x16x32_bf16 v[64:67], v[20:23], v[104:107], v[64:67]
    v_mfma_f32_16x16x32_bf16 v[68:71], v[20:23], v[184:187], v[68:71]
    ds_read_b64_tr_b16 v[40:41], v7 offset:18432
    ds_read_b64_tr_b16 v[42:43], v7 offset:19200
    s_waitcnt lgkmcnt(4)
    v_mfma_f32_16x16x32_bf16 v[72:75], v[24:27], v[104:107], v[72:75]
    v_mfma_f32_16x16x32_bf16 v[76:79], v[24:27], v[184:187], v[76:79]
    ds_read_b64_tr_b16 v[44:45], v8 offset:18432
    ds_read_b64_tr_b16 v[46:47], v8 offset:19200
    v_mfma_f32_16x16x32_bf16 v[80:83], v[28:31], v[104:107], v[80:83]
    v_mfma_f32_16x16x32_bf16 v[84:87], v[28:31], v[184:187], v[84:87]
    ds_read_b64_tr_b16 v[48:49], v9 offset:12288
    ds_read_b64_tr_b16 v[50:51], v9 offset:12800
    v_mfma_f32_16x16x32_bf16 v[88:91], v[32:35], v[104:107], v[88:91]
    v_mfma_f32_16x16x32_bf16 v[92:95], v[32:35], v[184:187], v[92:95]
    ds_read_b64_tr_b16 v[52:53], v10 offset:12288
    ds_read_b64_tr_b16 v[54:55], v10 offset:12800
    s_waitcnt lgkmcnt(0)
    s_waitcnt vmcnt(15)
    s_barrier
    v_subrev_u32 v6, 81920, v6
    v_subrev_u32 v7, 81920, v7
    v_subrev_u32 v8, 81920, v8
    v_subrev_u32 v9, 81920, v9
    v_subrev_u32 v10, 81920, v10
    v_mfma_f32_16x16x32_bf16 v[56:59], v[36:39], v[108:111], v[56:59]
    v_mfma_f32_16x16x32_bf16 v[60:63], v[36:39], v[188:191], v[60:63]
    ds_read_b64_tr_b16 v[16:17], v6 offset:0
    ds_read_b64_tr_b16 v[18:19], v6 offset:768
    v_mfma_f32_16x16x32_bf16 v[64:67], v[40:43], v[108:111], v[64:67]
    v_mfma_f32_16x16x32_bf16 v[68:71], v[40:43], v[188:191], v[68:71]
    ds_read_b64_tr_b16 v[20:21], v7 offset:0
    ds_read_b64_tr_b16 v[22:23], v7 offset:768
    s_mul_i32 s50, s46, 3
    s_add_u32 s51, s50, s56
    s_add_u32 s50, s50, 128
    s_add_u32 m0, s47, 81920
    s_nop 0
    buffer_load_dwordx4 v1, s[20:23], s50 offen lds
    v_mfma_f32_16x16x32_bf16 v[72:75], v[44:47], v[108:111], v[72:75]
    v_mfma_f32_16x16x32_bf16 v[76:79], v[44:47], v[188:191], v[76:79]
    ds_read_b64_tr_b16 v[24:25], v8 offset:0
    ds_read_b64_tr_b16 v[26:27], v8 offset:768
    v_mfma_f32_16x16x32_bf16 v[80:83], v[48:51], v[108:111], v[80:83]
    v_mfma_f32_16x16x32_bf16 v[84:87], v[48:51], v[188:191], v[84:87]
    ds_read_b64_tr_b16 v[28:29], v9 offset:0
    ds_read_b64_tr_b16 v[30:31], v9 offset:512
    s_add_u32 m0, s47, 82944
    s_nop 0
    buffer_load_dwordx4 v2, s[20:23], s50 offen lds
    v_mfma_f32_16x16x32_bf16 v[88:91], v[52:55], v[108:111], v[88:91]
    v_mfma_f32_16x16x32_bf16 v[92:95], v[52:55], v[188:191], v[92:95]
    ds_read_b64_tr_b16 v[32:33], v10 offset:0
    ds_read_b64_tr_b16 v[34:35], v10 offset:512
    s_waitcnt lgkmcnt(6)
    v_mfma_f32_16x16x32_bf16 v[56:59], v[16:19], v[112:115], v[56:59]
    v_mfma_f32_16x16x32_bf16 v[60:63], v[16:19], v[192:195], v[60:63]
    ds_read_b64_tr_b16 v[36:37], v6 offset:6144
    ds_read_b64_tr_b16 v[38:39], v6 offset:6912
    v_mfma_f32_16x16x32_bf16 v[64:67], v[20:23], v[112:115], v[64:67]
    v_mfma_f32_16x16x32_bf16 v[68:71], v[20:23], v[192:195], v[68:71]
    ds_read_b64_tr_b16 v[40:41], v7 offset:6144
    ds_read_b64_tr_b16 v[42:43], v7 offset:6912
    s_add_u32 m0, s47, 83968
    s_nop 0
    buffer_load_dwordx4 v3, s[20:23], s50 offen lds
    s_waitcnt lgkmcnt(4)
    v_mfma_f32_16x16x32_bf16 v[72:75], v[24:27], v[112:115], v[72:75]
    v_mfma_f32_16x16x32_bf16 v[76:79], v[24:27], v[192:195], v[76:79]
    ds_read_b64_tr_b16 v[44:45], v8 offset:6144
    ds_read_b64_tr_b16 v[46:47], v8 offset:6912
    v_mfma_f32_16x16x32_bf16 v[80:83], v[28:31], v[112:115], v[80:83]
    v_mfma_f32_16x16x32_bf16 v[84:87], v[28:31], v[192:195], v[84:87]
    ds_read_b64_tr_b16 v[48:49], v9 offset:4096
    ds_read_b64_tr_b16 v[50:51], v9 offset:4608
    s_add_u32 m0, s48, 81920
    s_nop 0
    buffer_load_dwordx4 v4, s[16:19], s51 offen lds
    v_mfma_f32_16x16x32_bf16 v[88:91], v[32:35], v[112:115], v[88:91]
    v_mfma_f32_16x16x32_bf16 v[92:95], v[32:35], v[192:195], v[92:95]
    ds_read_b64_tr_b16 v[52:53], v10 offset:4096
    ds_read_b64_tr_b16 v[54:55], v10 offset:4608
    s_waitcnt lgkmcnt(6)
    v_mfma_f32_16x16x32_bf16 v[56:59], v[36:39], v[116:119], v[56:59]
    v_mfma_f32_16x16x32_bf16 v[60:63], v[36:39], v[196:199], v[60:63]
    ds_read_b64_tr_b16 v[16:17], v6 offset:12288
    ds_read_b64_tr_b16 v[18:19], v6 offset:13056
    v_mfma_f32_16x16x32_bf16 v[64:67], v[40:43], v[116:119], v[64:67]
    v_mfma_f32_16x16x32_bf16 v[68:71], v[40:43], v[196:199], v[68:71]
    ds_read_b64_tr_b16 v[20:21], v7 offset:12288
    ds_read_b64_tr_b16 v[22:23], v7 offset:13056
    s_add_u32 m0, s48, 82944
    s_nop 0
    buffer_load_dwordx4 v5, s[16:19], s51 offen lds
    s_waitcnt lgkmcnt(4)
    v_mfma_f32_16x16x32_bf16 v[72:75], v[44:47], v[116:119], v[72:75]
    v_mfma_f32_16x16x32_bf16 v[76:79], v[44:47], v[196:199], v[76:79]
    ds_read_b64_tr_b16 v[24:25], v8 offset:12288
    ds_read_b64_tr_b16 v[26:27], v8 offset:13056
    v_mfma_f32_16x16x32_bf16 v[80:83], v[48:51], v[116:119], v[80:83]
    v_mfma_f32_16x16x32_bf16 v[84:87], v[48:51], v[196:199], v[84:87]
    ds_read_b64_tr_b16 v[28:29], v9 offset:8192
    ds_read_b64_tr_b16 v[30:31], v9 offset:8704
    v_mfma_f32_16x16x32_bf16 v[88:91], v[52:55], v[116:119], v[88:91]
    v_mfma_f32_16x16x32_bf16 v[92:95], v[52:55], v[196:199], v[92:95]
    ds_read_b64_tr_b16 v[32:33], v10 offset:8192
    ds_read_b64_tr_b16 v[34:35], v10 offset:8704
    s_waitcnt lgkmcnt(6)
    v_mfma_f32_16x16x32_bf16 v[56:59], v[16:19], v[120:123], v[56:59]
    v_mfma_f32_16x16x32_bf16 v[60:63], v[16:19], v[200:203], v[60:63]
    ds_read_b64_tr_b16 v[36:37], v6 offset:18432
    ds_read_b64_tr_b16 v[38:39], v6 offset:19200
    v_mfma_f32_16x16x32_bf16 v[64:67], v[20:23], v[120:123], v[64:67]
    v_mfma_f32_16x16x32_bf16 v[68:71], v[20:23], v[200:203], v[68:71]
    ds_read_b64_tr_b16 v[40:41], v7 offset:18432
    ds_read_b64_tr_b16 v[42:43], v7 offset:19200
    s_waitcnt lgkmcnt(4)
    v_mfma_f32_16x16x32_bf16 v[72:75], v[24:27], v[120:123], v[72:75]
    v_mfma_f32_16x16x32_bf16 v[76:79], v[24:27], v[200:203], v[76:79]
    ds_read_b64_tr_b16 v[44:45], v8 offset:18432
    ds_read_b64_tr_b16 v[46:47], v8 offset:19200
    v_mfma_f32_16x16x32_bf16 v[80:83], v[28:31], v[120:123], v[80:83]
    v_mfma_f32_16x16x32_bf16 v[84:87], v[28:31], v[200:203], v[84:87]
    ds_read_b64_tr_b16 v[48:49], v9 offset:12288
    ds_read_b64_tr_b16 v[50:51], v9 offset:12800
    v_mfma_f32_16x16x32_bf16 v[88:91], v[32:35], v[120:123], v[88:91]
    v_mfma_f32_16x16x32_bf16 v[92:95], v[32:35], v[200:203], v[92:95]
    ds_read_b64_tr_b16 v[52:53], v10 offset:12288
    ds_read_b64_tr_b16 v[54:55], v10 offset:12800
    s_waitcnt lgkmcnt(0)
    s_waitcnt vmcnt(5)
    s_barrier
    v_add_u32 v6, 40960, v6
    v_add_u32 v7, 40960, v7
    v_add_u32 v8, 40960, v8
    v_add_u32 v9, 40960, v9
    v_add_u32 v10, 40960, v10
    v_mfma_f32_16x16x32_bf16 v[56:59], v[36:39], v[124:127], v[56:59]
    v_mfma_f32_16x16x32_bf16 v[60:63], v[36:39], v[204:207], v[60:63]
    ds_read_b64_tr_b16 v[16:17], v6 offset:0
    ds_read_b64_tr_b16 v[18:19], v6 offset:768
    v_mfma_f32_16x16x32_bf16 v[64:67], v[40:43], v[124:127], v[64:67]
    v_mfma_f32_16x16x32_bf16 v[68:71], v[40:43], v[204:207], v[68:71]
    ds_read_b64_tr_b16 v[20:21], v7 offset:0
    ds_read_b64_tr_b16 v[22:23], v7 offset:768
    s_mul_i32 s50, s46, 4
    s_add_u32 s51, s50, s56
    s_add_u32 s50, s50, 128
    s_add_u32 m0, s47, 0
    s_nop 0
    buffer_load_dwordx4 v1, s[20:23], s50 offen lds
    v_mfma_f32_16x16x32_bf16 v[72:75], v[44:47], v[124:127], v[72:75]
    v_mfma_f32_16x16x32_bf16 v[76:79], v[44:47], v[204:207], v[76:79]
    ds_read_b64_tr_b16 v[24:25], v8 offset:0
    ds_read_b64_tr_b16 v[26:27], v8 offset:768
    v_mfma_f32_16x16x32_bf16 v[80:83], v[48:51], v[124:127], v[80:83]
    v_mfma_f32_16x16x32_bf16 v[84:87], v[48:51], v[204:207], v[84:87]
    ds_read_b64_tr_b16 v[28:29], v9 offset:0
    ds_read_b64_tr_b16 v[30:31], v9 offset:512
    s_add_u32 m0, s47, 1024
    s_nop 0
    buffer_load_dwordx4 v2, s[20:23], s50 offen lds
    v_mfma_f32_16x16x32_bf16 v[88:91], v[52:55], v[124:127], v[88:91]
    v_mfma_f32_16x16x32_bf16 v[92:95], v[52:55], v[204:207], v[92:95]
    ds_read_b64_tr_b16 v[32:33], v10 offset:0
    ds_read_b64_tr_b16 v[34:35], v10 offset:512
    s_waitcnt lgkmcnt(6)
    v_mfma_f32_16x16x32_bf16 v[56:59], v[16:19], v[128:131], v[56:59]
    v_mfma_f32_16x16x32_bf16 v[60:63], v[16:19], v[208:211], v[60:63]
    ds_read_b64_tr_b16 v[36:37], v6 offset:6144
    ds_read_b64_tr_b16 v[38:39], v6 offset:6912
    v_mfma_f32_16x16x32_bf16 v[64:67], v[20:23], v[128:131], v[64:67]
    v_mfma_f32_16x16x32_bf16 v[68:71], v[20:23], v[208:211], v[68:71]
    ds_read_b64_tr_b16 v[40:41], v7 offset:6144
    ds_read_b64_tr_b16 v[42:43], v7 offset:6912
    s_add_u32 m0, s47, 2048
    s_nop 0
    buffer_load_dwordx4 v3, s[20:23], s50 offen lds
    s_waitcnt lgkmcnt(4)
    v_mfma_f32_16x16x32_bf16 v[72:75], v[24:27], v[128:131], v[72:75]
    v_mfma_f32_16x16x32_bf16 v[76:79], v[24:27], v[208:211], v[76:79]
    ds_read_b64_tr_b16 v[44:45], v8 offset:6144
    ds_read_b64_tr_b16 v[46:47], v8 offset:6912
    v_mfma_f32_16x16x32_bf16 v[80:83], v[28:31], v[128:131], v[80:83]
    v_mfma_f32_16x16x32_bf16 v[84:87], v[28:31], v[208:211], v[84:87]
    ds_read_b64_tr_b16 v[48:49], v9 offset:4096
    ds_read_b64_tr_b16 v[50:51], v9 offset:4608
    s_add_u32 m0, s48, 0
    s_nop 0
    buffer_load_dwordx4 v4, s[16:19], s51 offen lds
    v_mfma_f32_16x16x32_bf16 v[88:91], v[32:35], v[128:131], v[88:91]
    v_mfma_f32_16x16x32_bf16 v[92:95], v[32:35], v[208:211], v[92:95]
    ds_read_b64_tr_b16 v[52:53], v10 offset:4096
    ds_read_b64_tr_b16 v[54:55], v10 offset:4608
    s_waitcnt lgkmcnt(6)
    v_mfma_f32_16x16x32_bf16 v[56:59], v[36:39], v[132:135], v[56:59]
    v_mfma_f32_16x16x32_bf16 v[60:63], v[36:39], v[212:215], v[60:63]
    ds_read_b64_tr_b16 v[16:17], v6 offset:12288
    ds_read_b64_tr_b16 v[18:19], v6 offset:13056
    v_mfma_f32_16x16x32_bf16 v[64:67], v[40:43], v[132:135], v[64:67]
    v_mfma_f32_16x16x32_bf16 v[68:71], v[40:43], v[212:215], v[68:71]
    ds_read_b64_tr_b16 v[20:21], v7 offset:12288
    ds_read_b64_tr_b16 v[22:23], v7 offset:13056
    s_add_u32 m0, s48, 1024
    s_nop 0
    buffer_load_dwordx4 v5, s[16:19], s51 offen lds
    s_waitcnt lgkmcnt(4)
    v_mfma_f32_16x16x32_bf16 v[72:75], v[44:47], v[132:135], v[72:75]
    v_mfma_f32_16x16x32_bf16 v[76:79], v[44:47], v[212:215], v[76:79]
    ds_read_b64_tr_b16 v[24:25], v8 offset:12288
    ds_read_b64_tr_b16 v[26:27], v8 offset:13056
    v_mfma_f32_16x16x32_bf16 v[80:83], v[48:51], v[132:135], v[80:83]
    v_mfma_f32_16x16x32_bf16 v[84:87], v[48:51], v[212:215], v[84:87]
    ds_read_b64_tr_b16 v[28:29], v9 offset:8192
    ds_read_b64_tr_b16 v[30:31], v9 offset:8704
    v_mfma_f32_16x16x32_bf16 v[88:91], v[52:55], v[132:135], v[88:91]
    v_mfma_f32_16x16x32_bf16 v[92:95], v[52:55], v[212:215], v[92:95]
    ds_read_b64_tr_b16 v[32:33], v10 offset:8192
    ds_read_b64_tr_b16 v[34:35], v10 offset:8704
    s_waitcnt lgkmcnt(6)
    v_mfma_f32_16x16x32_bf16 v[56:59], v[16:19], v[136:139], v[56:59]
    v_mfma_f32_16x16x32_bf16 v[60:63], v[16:19], v[216:219], v[60:63]
    ds_read_b64_tr_b16 v[36:37], v6 offset:18432
    ds_read_b64_tr_b16 v[38:39], v6 offset:19200
    v_mfma_f32_16x16x32_bf16 v[64:67], v[20:23], v[136:139], v[64:67]
    v_mfma_f32_16x16x32_bf16 v[68:71], v[20:23], v[216:219], v[68:71]
    ds_read_b64_tr_b16 v[40:41], v7 offset:18432
    ds_read_b64_tr_b16 v[42:43], v7 offset:19200
    s_waitcnt lgkmcnt(4)
    v_mfma_f32_16x16x32_bf16 v[72:75], v[24:27], v[136:139], v[72:75]
    v_mfma_f32_16x16x32_bf16 v[76:79], v[24:27], v[216:219], v[76:79]
    ds_read_b64_tr_b16 v[44:45], v8 offset:18432
    ds_read_b64_tr_b16 v[46:47], v8 offset:19200
    v_mfma_f32_16x16x32_bf16 v[80:83], v[28:31], v[136:139], v[80:83]
    v_mfma_f32_16x16x32_bf16 v[84:87], v[28:31], v[216:219], v[84:87]
    ds_read_b64_tr_b16 v[48:49], v9 offset:12288
    ds_read_b64_tr_b16 v[50:51], v9 offset:12800
    v_mfma_f32_16x16x32_bf16 v[88:91], v[32:35], v[136:139], v[88:91]
    v_mfma_f32_16x16x32_bf16 v[92:95], v[32:35], v[216:219], v[92:95]
    ds_read_b64_tr_b16 v[52:53], v10 offset:12288
    ds_read_b64_tr_b16 v[54:55], v10 offset:12800
    s_waitcnt lgkmcnt(0)
    s_waitcnt vmcnt(5)
    s_barrier
    v_add_u32 v6, 40960, v6
    v_add_u32 v7, 40960, v7
    v_add_u32 v8, 40960, v8
    v_add_u32 v9, 40960, v9
    v_add_u32 v10, 40960, v10
    v_mfma_f32_16x16x32_bf16 v[56:59], v[36:39], v[140:143], v[56:59]
    v_mfma_f32_16x16x32_bf16 v[60:63], v[36:39], v[220:223], v[60:63]
    ds_read_b64_tr_b16 v[16:17], v6 offset:0
    ds_read_b64_tr_b16 v[18:19], v6 offset:768
    v_mfma_f32_16x16x32_bf16 v[64:67], v[40:43], v[140:143], v[64:67]
    v_mfma_f32_16x16x32_bf16 v[68:71], v[40:43], v[220:223], v[68:71]
    ds_read_b64_tr_b16 v[20:21], v7 offset:0
    ds_read_b64_tr_b16 v[22:23], v7 offset:768
    v_mfma_f32_16x16x32_bf16 v[72:75], v[44:47], v[140:143], v[72:75]
    v_mfma_f32_16x16x32_bf16 v[76:79], v[44:47], v[220:223], v[76:79]
    ds_read_b64_tr_b16 v[24:25], v8 offset:0
    ds_read_b64_tr_b16 v[26:27], v8 offset:768
    v_mfma_f32_16x16x32_bf16 v[80:83], v[48:51], v[140:143], v[80:83]
    v_mfma_f32_16x16x32_bf16 v[84:87], v[48:51], v[220:223], v[84:87]
    ds_read_b64_tr_b16 v[28:29], v9 offset:0
    ds_read_b64_tr_b16 v[30:31], v9 offset:512
    v_mfma_f32_16x16x32_bf16 v[88:91], v[52:55], v[140:143], v[88:91]
    v_mfma_f32_16x16x32_bf16 v[92:95], v[52:55], v[220:223], v[92:95]
    ds_read_b64_tr_b16 v[32:33], v10 offset:0
    ds_read_b64_tr_b16 v[34:35], v10 offset:512
    s_waitcnt lgkmcnt(6)
    v_mfma_f32_16x16x32_bf16 v[56:59], v[16:19], v[144:147], v[56:59]
    v_mfma_f32_16x16x32_bf16 v[60:63], v[16:19], v[224:227], v[60:63]
    ds_read_b64_tr_b16 v[36:37], v6 offset:6144
    ds_read_b64_tr_b16 v[38:39], v6 offset:6912
    v_mfma_f32_16x16x32_bf16 v[64:67], v[20:23], v[144:147], v[64:67]
    v_mfma_f32_16x16x32_bf16 v[68:71], v[20:23], v[224:227], v[68:71]
    ds_read_b64_tr_b16 v[40:41], v7 offset:6144
    ds_read_b64_tr_b16 v[42:43], v7 offset:6912
    s_waitcnt lgkmcnt(4)
    v_mfma_f32_16x16x32_bf16 v[72:75], v[24:27], v[144:147], v[72:75]
    v_mfma_f32_16x16x32_bf16 v[76:79], v[24:27], v[224:227], v[76:79]
    ds_read_b64_tr_b16 v[44:45], v8 offset:6144
    ds_read_b64_tr_b16 v[46:47], v8 offset:6912
    v_mfma_f32_16x16x32_bf16 v[80:83], v[28:31], v[144:147], v[80:83]
    v_mfma_f32_16x16x32_bf16 v[84:87], v[28:31], v[224:227], v[84:87]
    ds_read_b64_tr_b16 v[48:49], v9 offset:4096
    ds_read_b64_tr_b16 v[50:51], v9 offset:4608
    v_mfma_f32_16x16x32_bf16 v[88:91], v[32:35], v[144:147], v[88:91]
    v_mfma_f32_16x16x32_bf16 v[92:95], v[32:35], v[224:227], v[92:95]
    ds_read_b64_tr_b16 v[52:53], v10 offset:4096
    ds_read_b64_tr_b16 v[54:55], v10 offset:4608
    s_waitcnt lgkmcnt(6)
    v_mfma_f32_16x16x32_bf16 v[56:59], v[36:39], v[148:151], v[56:59]
    v_mfma_f32_16x16x32_bf16 v[60:63], v[36:39], v[228:231], v[60:63]
    ds_read_b64_tr_b16 v[16:17], v6 offset:12288
    ds_read_b64_tr_b16 v[18:19], v6 offset:13056
    v_mfma_f32_16x16x32_bf16 v[64:67], v[40:43], v[148:151], v[64:67]
    v_mfma_f32_16x16x32_bf16 v[68:71], v[40:43], v[228:231], v[68:71]
    ds_read_b64_tr_b16 v[20:21], v7 offset:12288
    ds_read_b64_tr_b16 v[22:23], v7 offset:13056
    s_waitcnt lgkmcnt(4)
    v_mfma_f32_16x16x32_bf16 v[72:75], v[44:47], v[148:151], v[72:75]
    v_mfma_f32_16x16x32_bf16 v[76:79], v[44:47], v[228:231], v[76:79]
    ds_read_b64_tr_b16 v[24:25], v8 offset:12288
    ds_read_b64_tr_b16 v[26:27], v8 offset:13056
    v_mfma_f32_16x16x32_bf16 v[80:83], v[48:51], v[148:151], v[80:83]
    v_mfma_f32_16x16x32_bf16 v[84:87], v[48:51], v[228:231], v[84:87]
    ds_read_b64_tr_b16 v[28:29], v9 offset:8192
    ds_read_b64_tr_b16 v[30:31], v9 offset:8704
    v_mfma_f32_16x16x32_bf16 v[88:91], v[52:55], v[148:151], v[88:91]
    v_mfma_f32_16x16x32_bf16 v[92:95], v[52:55], v[228:231], v[92:95]
    ds_read_b64_tr_b16 v[32:33], v10 offset:8192
    ds_read_b64_tr_b16 v[34:35], v10 offset:8704
    s_waitcnt lgkmcnt(6)
    v_mfma_f32_16x16x32_bf16 v[56:59], v[16:19], v[152:155], v[56:59]
    v_mfma_f32_16x16x32_bf16 v[60:63], v[16:19], v[232:235], v[60:63]
    ds_read_b64_tr_b16 v[36:37], v6 offset:18432
    ds_read_b64_tr_b16 v[38:39], v6 offset:19200
    v_mfma_f32_16x16x32_bf16 v[64:67], v[20:23], v[152:155], v[64:67]
    v_mfma_f32_16x16x32_bf16 v[68:71], v[20:23], v[232:235], v[68:71]
    ds_read_b64_tr_b16 v[40:41], v7 offset:18432
    ds_read_b64_tr_b16 v[42:43], v7 offset:19200
    s_waitcnt lgkmcnt(4)
    v_mfma_f32_16x16x32_bf16 v[72:75], v[24:27], v[152:155], v[72:75]
    v_mfma_f32_16x16x32_bf16 v[76:79], v[24:27], v[232:235], v[76:79]
    ds_read_b64_tr_b16 v[44:45], v8 offset:18432
    ds_read_b64_tr_b16 v[46:47], v8 offset:19200
    v_mfma_f32_16x16x32_bf16 v[80:83], v[28:31], v[152:155], v[80:83]
    v_mfma_f32_16x16x32_bf16 v[84:87], v[28:31], v[232:235], v[84:87]
    ds_read_b64_tr_b16 v[48:49], v9 offset:12288
    ds_read_b64_tr_b16 v[50:51], v9 offset:12800
    v_mfma_f32_16x16x32_bf16 v[88:91], v[32:35], v[152:155], v[88:91]
    v_mfma_f32_16x16x32_bf16 v[92:95], v[32:35], v[232:235], v[92:95]
    ds_read_b64_tr_b16 v[52:53], v10 offset:12288
    ds_read_b64_tr_b16 v[54:55], v10 offset:12800
    s_waitcnt lgkmcnt(0)
    s_waitcnt vmcnt(0)
    s_barrier
    v_subrev_u32 v6, 81920, v6
    v_subrev_u32 v7, 81920, v7
    v_subrev_u32 v8, 81920, v8
    v_subrev_u32 v9, 81920, v9
    v_subrev_u32 v10, 81920, v10
    v_mfma_f32_16x16x32_bf16 v[56:59], v[36:39], v[156:159], v[56:59]
    v_mfma_f32_16x16x32_bf16 v[60:63], v[36:39], v[236:239], v[60:63]
    ds_read_b64_tr_b16 v[16:17], v6 offset:0
    ds_read_b64_tr_b16 v[18:19], v6 offset:768
    v_mfma_f32_16x16x32_bf16 v[64:67], v[40:43], v[156:159], v[64:67]
    v_mfma_f32_16x16x32_bf16 v[68:71], v[40:43], v[236:239], v[68:71]
    ds_read_b64_tr_b16 v[20:21], v7 offset:0
    ds_read_b64_tr_b16 v[22:23], v7 offset:768
    v_mfma_f32_16x16x32_bf16 v[72:75], v[44:47], v[156:159], v[72:75]
    v_mfma_f32_16x16x32_bf16 v[76:79], v[44:47], v[236:239], v[76:79]
    ds_read_b64_tr_b16 v[24:25], v8 offset:0
    ds_read_b64_tr_b16 v[26:27], v8 offset:768
    v_mfma_f32_16x16x32_bf16 v[80:83], v[48:51], v[156:159], v[80:83]
    v_mfma_f32_16x16x32_bf16 v[84:87], v[48:51], v[236:239], v[84:87]
    ds_read_b64_tr_b16 v[28:29], v9 offset:0
    ds_read_b64_tr_b16 v[30:31], v9 offset:512
    v_mfma_f32_16x16x32_bf16 v[88:91], v[52:55], v[156:159], v[88:91]
    v_mfma_f32_16x16x32_bf16 v[92:95], v[52:55], v[236:239], v[92:95]
    ds_read_b64_tr_b16 v[32:33], v10 offset:0
    ds_read_b64_tr_b16 v[34:35], v10 offset:512
    s_waitcnt lgkmcnt(6)
    v_mfma_f32_16x16x32_bf16 v[56:59], v[16:19], v[160:163], v[56:59]
    v_mfma_f32_16x16x32_bf16 v[60:63], v[16:19], v[240:243], v[60:63]
    ds_read_b64_tr_b16 v[36:37], v6 offset:6144
    ds_read_b64_tr_b16 v[38:39], v6 offset:6912
    v_mfma_f32_16x16x32_bf16 v[64:67], v[20:23], v[160:163], v[64:67]
    v_mfma_f32_16x16x32_bf16 v[68:71], v[20:23], v[240:243], v[68:71]
    ds_read_b64_tr_b16 v[40:41], v7 offset:6144
    ds_read_b64_tr_b16 v[42:43], v7 offset:6912
    s_waitcnt lgkmcnt(4)
    v_mfma_f32_16x16x32_bf16 v[72:75], v[24:27], v[160:163], v[72:75]
    v_mfma_f32_16x16x32_bf16 v[76:79], v[24:27], v[240:243], v[76:79]
    ds_read_b64_tr_b16 v[44:45], v8 offset:6144
    ds_read_b64_tr_b16 v[46:47], v8 offset:6912
    v_mfma_f32_16x16x32_bf16 v[80:83], v[28:31], v[160:163], v[80:83]
    v_mfma_f32_16x16x32_bf16 v[84:87], v[28:31], v[240:243], v[84:87]
    ds_read_b64_tr_b16 v[48:49], v9 offset:4096
    ds_read_b64_tr_b16 v[50:51], v9 offset:4608
    v_mfma_f32_16x16x32_bf16 v[88:91], v[32:35], v[160:163], v[88:91]
    v_mfma_f32_16x16x32_bf16 v[92:95], v[32:35], v[240:243], v[92:95]
    ds_read_b64_tr_b16 v[52:53], v10 offset:4096
    ds_read_b64_tr_b16 v[54:55], v10 offset:4608
    s_waitcnt lgkmcnt(6)
    v_mfma_f32_16x16x32_bf16 v[56:59], v[36:39], v[164:167], v[56:59]
    v_mfma_f32_16x16x32_bf16 v[60:63], v[36:39], v[244:247], v[60:63]
    ds_read_b64_tr_b16 v[16:17], v6 offset:12288
    ds_read_b64_tr_b16 v[18:19], v6 offset:13056
    v_mfma_f32_16x16x32_bf16 v[64:67], v[40:43], v[164:167], v[64:67]
    v_mfma_f32_16x16x32_bf16 v[68:71], v[40:43], v[244:247], v[68:71]
    ds_read_b64_tr_b16 v[20:21], v7 offset:12288
    ds_read_b64_tr_b16 v[22:23], v7 offset:13056
    s_waitcnt lgkmcnt(4)
    v_mfma_f32_16x16x32_bf16 v[72:75], v[44:47], v[164:167], v[72:75]
    v_mfma_f32_16x16x32_bf16 v[76:79], v[44:47], v[244:247], v[76:79]
    ds_read_b64_tr_b16 v[24:25], v8 offset:12288
    ds_read_b64_tr_b16 v[26:27], v8 offset:13056
    v_mfma_f32_16x16x32_bf16 v[80:83], v[48:51], v[164:167], v[80:83]
    v_mfma_f32_16x16x32_bf16 v[84:87], v[48:51], v[244:247], v[84:87]
    ds_read_b64_tr_b16 v[28:29], v9 offset:8192
    ds_read_b64_tr_b16 v[30:31], v9 offset:8704
    v_mfma_f32_16x16x32_bf16 v[88:91], v[52:55], v[164:167], v[88:91]
    v_mfma_f32_16x16x32_bf16 v[92:95], v[52:55], v[244:247], v[92:95]
    ds_read_b64_tr_b16 v[32:33], v10 offset:8192
    ds_read_b64_tr_b16 v[34:35], v10 offset:8704
    s_waitcnt lgkmcnt(6)
    v_mfma_f32_16x16x32_bf16 v[56:59], v[16:19], v[168:171], v[56:59]
    v_mfma_f32_16x16x32_bf16 v[60:63], v[16:19], v[248:251], v[60:63]
    ds_read_b64_tr_b16 v[36:37], v6 offset:18432
    ds_read_b64_tr_b16 v[38:39], v6 offset:19200
    v_mfma_f32_16x16x32_bf16 v[64:67], v[20:23], v[168:171], v[64:67]
    v_mfma_f32_16x16x32_bf16 v[68:71], v[20:23], v[248:251], v[68:71]
    ds_read_b64_tr_b16 v[40:41], v7 offset:18432
    ds_read_b64_tr_b16 v[42:43], v7 offset:19200
    s_waitcnt lgkmcnt(4)
    v_mfma_f32_16x16x32_bf16 v[72:75], v[24:27], v[168:171], v[72:75]
    v_mfma_f32_16x16x32_bf16 v[76:79], v[24:27], v[248:251], v[76:79]
    ds_read_b64_tr_b16 v[44:45], v8 offset:18432
    ds_read_b64_tr_b16 v[46:47], v8 offset:19200
    v_mfma_f32_16x16x32_bf16 v[80:83], v[28:31], v[168:171], v[80:83]
    v_mfma_f32_16x16x32_bf16 v[84:87], v[28:31], v[248:251], v[84:87]
    ds_read_b64_tr_b16 v[48:49], v9 offset:12288
    ds_read_b64_tr_b16 v[50:51], v9 offset:12800
    v_mfma_f32_16x16x32_bf16 v[88:91], v[32:35], v[168:171], v[88:91]
    v_mfma_f32_16x16x32_bf16 v[92:95], v[32:35], v[248:251], v[92:95]
    ds_read_b64_tr_b16 v[52:53], v10 offset:12288
    ds_read_b64_tr_b16 v[54:55], v10 offset:12800
    s_waitcnt lgkmcnt(6)
    v_mfma_f32_16x16x32_bf16 v[56:59], v[36:39], v[172:175], v[56:59]
    v_mfma_f32_16x16x32_bf16 v[60:63], v[36:39], v[252:255], v[60:63]
    v_mfma_f32_16x16x32_bf16 v[64:67], v[40:43], v[172:175], v[64:67]
    v_mfma_f32_16x16x32_bf16 v[68:71], v[40:43], v[252:255], v[68:71]
    s_waitcnt lgkmcnt(0)
    v_mfma_f32_16x16x32_bf16 v[72:75], v[44:47], v[172:175], v[72:75]
    v_mfma_f32_16x16x32_bf16 v[76:79], v[44:47], v[252:255], v[76:79]
    v_mfma_f32_16x16x32_bf16 v[80:83], v[48:51], v[172:175], v[80:83]
    v_mfma_f32_16x16x32_bf16 v[84:87], v[48:51], v[252:255], v[84:87]
    v_mfma_f32_16x16x32_bf16 v[88:91], v[52:55], v[172:175], v[88:91]
    v_mfma_f32_16x16x32_bf16 v[92:95], v[52:55], v[252:255], v[92:95]
    s_and_b32 s52, s35, 1
    s_mul_i32 s52, s52, 80
    s_lshr_b32 s53, s35, 1
    s_mul_i32 s53, s53, 4194304
    s_mul_i32 s55, s39, 40
    s_add_u32 s53, s53, s55
    v_lshlrev_b32 v13, 3, v11
    s_cmp_eq_u32 s38, 0
    s_cselect_b32 s54, 10, 11
    s_lshl_b32 s54, s54, 2
    s_add_u32 s54, s54, s52
    v_add_u32 v36, s54, v12
    v_mul_u32_u24 v37, 205, v36
    v_lshrrev_b32 v37, 10, v37
    v_mul_u32_u24 v38, 5, v37
    v_sub_u32 v38, v36, v38
    v_mul_u32_u24 v37, 81920, v37
    v_lshl_add_u32 v37, v38, 7, v37
    v_add_u32 v37, v37, v13
    v_cvt_pk_bf16_f32 v40, v56, v57
    v_cvt_pk_bf16_f32 v41, v58, v59
    buffer_store_dwordx2 v[40:41], v37, s[28:31], s53 offen offset:0
    v_cvt_pk_bf16_f32 v42, v60, v61
    v_cvt_pk_bf16_f32 v43, v62, v63
    buffer_store_dwordx2 v[42:43], v37, s[28:31], s53 offen offset:640
    s_cmp_eq_u32 s38, 0
    s_cselect_b32 s54, 12, 14
    s_lshl_b32 s54, s54, 2
    s_add_u32 s54, s54, s52
    v_add_u32 v44, s54, v12
    v_mul_u32_u24 v45, 205, v44
    v_lshrrev_b32 v45, 10, v45
    v_mul_u32_u24 v46, 5, v45
    v_sub_u32 v46, v44, v46
    v_mul_u32_u24 v45, 81920, v45
    v_lshl_add_u32 v45, v46, 7, v45
    v_add_u32 v45, v45, v13
    v_cvt_pk_bf16_f32 v48, v64, v65
    v_cvt_pk_bf16_f32 v49, v66, v67
    buffer_store_dwordx2 v[48:49], v45, s[28:31], s53 offen offset:0
    v_cvt_pk_bf16_f32 v50, v68, v69
    v_cvt_pk_bf16_f32 v51, v70, v71
    buffer_store_dwordx2 v[50:51], v45, s[28:31], s53 offen offset:640
    s_cmp_eq_u32 s38, 0
    s_cselect_b32 s54, 13, 15
    s_lshl_b32 s54, s54, 2
    s_add_u32 s54, s54, s52
    v_add_u32 v36, s54, v12
    v_mul_u32_u24 v37, 205, v36
    v_lshrrev_b32 v37, 10, v37
    v_mul_u32_u24 v38, 5, v37
    v_sub_u32 v38, v36, v38
    v_mul_u32_u24 v37, 81920, v37
    v_lshl_add_u32 v37, v38, 7, v37
    v_add_u32 v37, v37, v13
    v_cvt_pk_bf16_f32 v40, v72, v73
    v_cvt_pk_bf16_f32 v41, v74, v75
    buffer_store_dwordx2 v[40:41], v37, s[28:31], s53 offen offset:0
    v_cvt_pk_bf16_f32 v42, v76, v77
    v_cvt_pk_bf16_f32 v43, v78, v79
    buffer_store_dwordx2 v[42:43], v37, s[28:31], s53 offen offset:640
    s_cmp_eq_u32 s38, 0
    s_cselect_b32 s54, 16, 18
    s_lshl_b32 s54, s54, 2
    s_add_u32 s54, s54, s52
    v_add_u32 v44, s54, v12
    v_mul_u32_u24 v45, 205, v44
    v_lshrrev_b32 v45, 10, v45
    v_mul_u32_u24 v46, 5, v45
    v_sub_u32 v46, v44, v46
    v_mul_u32_u24 v45, 81920, v45
    v_lshl_add_u32 v45, v46, 7, v45
    v_add_u32 v45, v45, v13
    v_cvt_pk_bf16_f32 v48, v80, v81
    v_cvt_pk_bf16_f32 v49, v82, v83
    buffer_store_dwordx2 v[48:49], v45, s[28:31], s53 offen offset:0
    v_cvt_pk_bf16_f32 v50, v84, v85
    v_cvt_pk_bf16_f32 v51, v86, v87
    buffer_store_dwordx2 v[50:51], v45, s[28:31], s53 offen offset:640
    s_cmp_eq_u32 s38, 0
    s_cselect_b32 s54, 17, 19
    s_lshl_b32 s54, s54, 2
    s_add_u32 s54, s54, s52
    v_add_u32 v36, s54, v12
    v_mul_u32_u24 v37, 205, v36
    v_lshrrev_b32 v37, 10, v37
    v_mul_u32_u24 v38, 5, v37
    v_sub_u32 v38, v36, v38
    v_mul_u32_u24 v37, 81920, v37
    v_lshl_add_u32 v37, v38, 7, v37
    v_add_u32 v37, v37, v13
    v_cvt_pk_bf16_f32 v40, v88, v89
    v_cvt_pk_bf16_f32 v41, v90, v91
    buffer_store_dwordx2 v[40:41], v37, s[28:31], s53 offen offset:0
    v_cvt_pk_bf16_f32 v42, v92, v93
    v_cvt_pk_bf16_f32 v43, v94, v95
    buffer_store_dwordx2 v[42:43], v37, s[28:31], s53 offen offset:640
    s_nop 3
    s_branch .k1_end
.k1v_4:
    v_and_b32 v11, 15, v0
    v_lshrrev_b32 v12, 4, v0
    s_waitcnt lgkmcnt(0)
    s_barrier
    v_bfe_u32 v16, v0, 2, 2
    v_and_b32 v17, 3, v0
    v_lshl_add_u32 v18, v12, 3, v16
    v_and_b32 v19, 1, v12
    v_mul_u32_u24 v21, 192, v18
    v_lshl_add_u32 v21, v17, 3, v21
    s_cmp_eq_u32 s38, 0
    s_cselect_b32 s50, 0, 2
    v_xor_b32 v20, s50, v19
    v_lshl_add_u32 v6, v20, 5, v21
    s_cmp_eq_u32 s38, 0
    s_cselect_b32 s50, 1, 3
    v_xor_b32 v20, s50, v19
    v_lshl_add_u32 v7, v20, 5, v21
    s_cmp_eq_u32 s38, 0
    s_cselect_b32 s50, 4, 5
    v_xor_b32 v20, s50, v19
    v_lshl_add_u32 v8, v20, 5, v21
    v_lshrrev_b32 v20, 1, v16
    v_lshl_or_b32 v19, v19, 1, v20
    v_lshlrev_b32 v21, 7, v18
    v_lshl_add_u32 v21, v17, 3, v21
    v_add_u32 v21, 24576, v21
    s_lshl_b32 s49, s38, 1
    s_add_u32 s50, s49, 0
    v_xor_b32 v20, s50, v19
    v_lshl_add_u32 v9, v20, 5, v21
    s_add_u32 s50, s49, 1
    v_xor_b32 v20, s50, v19
    v_lshl_add_u32 v10, v20, 5, v21
    ds_read_b64_tr_b16 v[16:17], v6 offset:0
    ds_read_b64_tr_b16 v[18:19], v6 offset:768
    ds_read_b64_tr_b16 v[20:21], v7 offset:0
    ds_read_b64_tr_b16 v[22:23], v7 offset:768
    ds_read_b64_tr_b16 v[24:25], v8 offset:0
    ds_read_b64_tr_b16 v[26:27], v8 offset:768
    ds_read_b64_tr_b16 v[28:29], v9 offset:0
    ds_read_b64_tr_b16 v[30:31], v9 offset:512
    ds_read_b64_tr_b16 v[32:33], v10 offset:0
    ds_read_b64_tr_b16 v[34:35], v10 offset:512
    s_waitcnt lgkmcnt(6)
    v_mfma_f32_16x16x32_bf16 v[56:59], v[96:99], v[16:19], 0
    v_mfma_f32_16x16x32_bf16 v[60:63], v[176:179], v[16:19], 0
    ds_read_b64_tr_b16 v[36:37], v6 offset:6144
    ds_read_b64_tr_b16 v[38:39], v6 offset:6912
    v_mfma_f32_16x16x32_bf16 v[64:67], v[96:99], v[20:23], 0
    v_mfma_f32_16x16x32_bf16 v[68:71], v[176:179], v[20:23], 0
    ds_read_b64_tr_b16 v[40:41], v7 offset:6144
    ds_read_b64_tr_b16 v[42:43], v7 offset:6912
    s_mul_i32 s50, s46, 2
    s_mov_b32 s51, s50
    s_add_u32 m0, s47, 81920
    s_nop 0
    buffer_load_dwordx4 v1, s[16:19], s50 offen lds
    s_waitcnt lgkmcnt(4)
    v_mfma_f32_16x16x32_bf16 v[72:75], v[96:99], v[24:27], 0
    v_mfma_f32_16x16x32_bf16 v[76:79], v[176:179], v[24:27], 0
    ds_read_b64_tr_b16 v[44:45], v8 offset:6144
    ds_read_b64_tr_b16 v[46:47], v8 offset:6912
    v_mfma_f32_16x16x32_bf16 v[80:83], v[96:99], v[28:31], 0
    v_mfma_f32_16x16x32_bf16 v[84:87], v[176:179], v[28:31], 0
    ds_read_b64_tr_b16 v[48:49], v9 offset:4096
    ds_read_b64_tr_b16 v[50:51], v9 offset:4608
    s_add_u32 m0, s47, 82944
    s_nop 0
    buffer_load_dwordx4 v2, s[16:19], s50 offen lds
    v_mfma_f32_16x16x32_bf16 v[88:91], v[96:99], v[32:35], 0
    v_mfma_f32_16x16x32_bf16 v[92:95], v[176:179], v[32:35], 0
    ds_read_b64_tr_b16 v[52:53], v10 offset:4096
    ds_read_b64_tr_b16 v[54:55], v10 offset:4608
    s_waitcnt lgkmcnt(6)
    v_mfma_f32_16x16x32_bf16 v[56:59], v[100:103], v[36:39], v[56:59]
    v_mfma_f32_16x16x32_bf16 v[60:63], v[180:183], v[36:39], v[60:63]
    ds_read_b64_tr_b16 v[16:17], v6 offset:12288
    ds_read_b64_tr_b16 v[18:19], v6 offset:13056
    v_mfma_f32_16x16x32_bf16 v[64:67], v[100:103], v[40:43], v[64:67]
    v_mfma_f32_16x16x32_bf16 v[68:71], v[180:183], v[40:43], v[68:71]
    ds_read_b64_tr_b16 v[20:21], v7 offset:12288
    ds_read_b64_tr_b16 v[22:23], v7 offset:13056
    s_add_u32 m0, s47, 83968
    s_nop 0
    buffer_load_dwordx4 v3, s[16:19], s50 offen lds
    s_waitcnt lgkmcnt(4)
    v_mfma_f32_16x16x32_bf16 v[72:75], v[100:103], v[44:47], v[72:75]
    v_mfma_f32_16x16x32_bf16 v[76:79], v[180:183], v[44:47], v[76:79]
    ds_read_b64_tr_b16 v[24:25], v8 offset:12288
    ds_read_b64_tr_b16 v[26:27], v8 offset:13056
    v_mfma_f32_16x16x32_bf16 v[80:83], v[100:103], v[48:51], v[80:83]
    v_mfma_f32_16x16x32_bf16 v[84:87], v[180:183], v[48:51], v[84:87]
    ds_read_b64_tr_b16 v[28:29], v9 offset:8192
    ds_read_b64_tr_b16 v[30:31], v9 offset:8704
    s_add_u32 m0, s48, 81920
    s_nop 0
    buffer_load_dwordx4 v4, s[20:23], s51 offen lds
    v_mfma_f32_16x16x32_bf16 v[88:91], v[100:103], v[52:55], v[88:91]
    v_mfma_f32_16x16x32_bf16 v[92:95], v[180:183], v[52:55], v[92:95]
    ds_read_b64_tr_b16 v[32:33], v10 offset:8192
    ds_read_b64_tr_b16 v[34:35], v10 offset:8704
    s_waitcnt lgkmcnt(6)
    v_mfma_f32_16x16x32_bf16 v[56:59], v[104:107], v[16:19], v[56:59]
    v_mfma_f32_16x16x32_bf16 v[60:63], v[184:187], v[16:19], v[60:63]
    ds_read_b64_tr_b16 v[36:37], v6 offset:18432
    ds_read_b64_tr_b16 v[38:39], v6 offset:19200
    v_mfma_f32_16x16x32_bf16 v[64:67], v[104:107], v[20:23], v[64:67]
    v_mfma_f32_16x16x32_bf16 v[68:71], v[184:187], v[20:23], v[68:71]
    ds_read_b64_tr_b16 v[40:41], v7 offset:18432
    ds_read_b64_tr_b16 v[42:43], v7 offset:19200
    s_add_u32 m0, s48, 82944
    s_nop 0
    buffer_load_dwordx4 v5, s[20:23], s51 offen lds
    s_waitcnt lgkmcnt(4)
    v_mfma_f32_16x16x32_bf16 v[72:75], v[104:107], v[24:27], v[72:75]
    v_mfma_f32_16x16x32_bf16 v[76:79], v[184:187], v[24:27], v[76:79]
    ds_read_b64_tr_b16 v[44:45], v8 offset:18432
    ds_read_b64_tr_b16 v[46:47], v8 offset:19200
    v_mfma_f32_16x16x32_bf16 v[80:83], v[104:107], v[28:31], v[80:83]
    v_mfma_f32_16x16x32_bf16 v[84:87], v[184:187], v[28:31], v[84:87]
    ds_read_b64_tr_b16 v[48:49], v9 offset:12288
    ds_read_b64_tr_b16 v[50:51], v9 offset:12800
    v_mfma_f32_16x16x32_bf16 v[88:91], v[104:107], v[32:35], v[88:91]
    v_mfma_f32_16x16x32_bf16 v[92:95], v[184:187], v[32:35], v[92:95]
    ds_read_b64_tr_b16 v[52:53], v10 offset:12288
    ds_read_b64_tr_b16 v[54:55], v10 offset:12800
    s_waitcnt lgkmcnt(0)
    s_barrier
    v_add_u32 v6, 40960, v6
    v_add_u32 v7, 40960, v7
    v_add_u32 v8, 40960, v8
    v_add_u32 v9, 40960, v9
    v_add_u32 v10, 40960, v10
    v_mfma_f32_16x16x32_bf16 v[56:59], v[108:111], v[36:39], v[56:59]
    v_mfma_f32_16x16x32_bf16 v[60:63], v[188:191], v[36:39], v[60:63]
    ds_read_b64_tr_b16 v[16:17], v6 offset:0
    ds_read_b64_tr_b16 v[18:19], v6 offset:768
    v_mfma_f32_16x16x32_bf16 v[64:67], v[108:111], v[40:43], v[64:67]
    v_mfma_f32_16x16x32_bf16 v[68:71], v[188:191], v[40:43], v[68:71]
    ds_read_b64_tr_b16 v[20:21], v7 offset:0
    ds_read_b64_tr_b16 v[22:23], v7 offset:768
    s_mul_i32 s50, s46, 3
    s_mov_b32 s51, s50
    s_add_u32 m0, s47, 0
    s_nop 0
    buffer_load_dwordx4 v1, s[16:19], s50 offen lds
    v_mfma_f32_16x16x32_bf16 v[72:75], v[108:111], v[44:47], v[72:75]
    v_mfma_f32_16x16x32_bf16 v[76:79], v[188:191], v[44:47], v[76:79]
    ds_read_b64_tr_b16 v[24:25], v8 offset:0
    ds_read_b64_tr_b16 v[26:27], v8 offset:768
    v_mfma_f32_16x16x32_bf16 v[80:83], v[108:111], v[48:51], v[80:83]
    v_mfma_f32_16x16x32_bf16 v[84:87], v[188:191], v[48:51], v[84:87]
    ds_read_b64_tr_b16 v[28:29], v9 offset:0
    ds_read_b64_tr_b16 v[30:31], v9 offset:512
    s_add_u32 m0, s47, 1024
    s_nop 0
    buffer_load_dwordx4 v2, s[16:19], s50 offen lds
    v_mfma_f32_16x16x32_bf16 v[88:91], v[108:111], v[52:55], v[88:91]
    v_mfma_f32_16x16x32_bf16 v[92:95], v[188:191], v[52:55], v[92:95]
    ds_read_b64_tr_b16 v[32:33], v10 offset:0
    ds_read_b64_tr_b16 v[34:35], v10 offset:512
    s_waitcnt lgkmcnt(6)
    v_mfma_f32_16x16x32_bf16 v[56:59], v[112:115], v[16:19], v[56:59]
    v_mfma_f32_16x16x32_bf16 v[60:63], v[192:195], v[16:19], v[60:63]
    ds_read_b64_tr_b16 v[36:37], v6 offset:6144
    ds_read_b64_tr_b16 v[38:39], v6 offset:6912
    v_mfma_f32_16x16x32_bf16 v[64:67], v[112:115], v[20:23], v[64:67]
    v_mfma_f32_16x16x32_bf16 v[68:71], v[192:195], v[20:23], v[68:71]
    ds_read_b64_tr_b16 v[40:41], v7 offset:6144
    ds_read_b64_tr_b16 v[42:43], v7 offset:6912
    s_add_u32 m0, s47, 2048
    s_nop 0
    buffer_load_dwordx4 v3, s[16:19], s50 offen lds
    s_waitcnt lgkmcnt(4)
    v_mfma_f32_16x16x32_bf16 v[72:75], v[112:115], v[24:27], v[72:75]
    v_mfma_f32_16x16x32_bf16 v[76:79], v[192:195], v[24:27], v[76:79]
    ds_read_b64_tr_b16 v[44:45], v8 offset:6144
    ds_read_b64_tr_b16 v[46:47], v8 offset:6912
    v_mfma_f32_16x16x32_bf16 v[80:83], v[112:115], v[28:31], v[80:83]
    v_mfma_f32_16x16x32_bf16 v[84:87], v[192:195], v[28:31], v[84:87]
    ds_read_b64_tr_b16 v[48:49], v9 offset:4096
    ds_read_b64_tr_b16 v[50:51], v9 offset:4608
    s_add_u32 m0, s48, 0
    s_nop 0
    buffer_load_dwordx4 v4, s[20:23], s51 offen lds
    v_mfma_f32_16x16x32_bf16 v[88:91], v[112:115], v[32:35], v[88:91]
    v_mfma_f32_16x16x32_bf16 v[92:95], v[192:195], v[32:35], v[92:95]
    ds_read_b64_tr_b16 v[52:53], v10 offset:4096
    ds_read_b64_tr_b16 v[54:55], v10 offset:4608
    s_waitcnt lgkmcnt(6)
    v_mfma_f32_16x16x32_bf16 v[56:59], v[116:119], v[36:39], v[56:59]
    v_mfma_f32_16x16x32_bf16 v[60:63], v[196:199], v[36:39], v[60:63]
    ds_read_b64_tr_b16 v[16:17], v6 offset:12288
    ds_read_b64_tr_b16 v[18:19], v6 offset:13056
    v_mfma_f32_16x16x32_bf16 v[64:67], v[116:119], v[40:43], v[64:67]
    v_mfma_f32_16x16x32_bf16 v[68:71], v[196:199], v[40:43], v[68:71]
    ds_read_b64_tr_b16 v[20:21], v7 offset:12288
    ds_read_b64_tr_b16 v[22:23], v7 offset:13056
    s_add_u32 m0, s48, 1024
    s_nop 0
    buffer_load_dwordx4 v5, s[20:23], s51 offen lds
    s_waitcnt lgkmcnt(4)
    v_mfma_f32_16x16x32_bf16 v[72:75], v[116:119], v[44:47], v[72:75]
    v_mfma_f32_16x16x32_bf16 v[76:79], v[196:199], v[44:47], v[76:79]
    ds_read_b64_tr_b16 v[24:25], v8 offset:12288
    ds_read_b64_tr_b16 v[26:27], v8 offset:13056
    v_mfma_f32_16x16x32_bf16 v[80:83], v[116:119], v[48:51], v[80:83]
    v_mfma_f32_16x16x32_bf16 v[84:87], v[196:199], v[48:51], v[84:87]
    ds_read_b64_tr_b16 v[28:29], v9 offset:8192
    ds_read_b64_tr_b16 v[30:31], v9 offset:8704
    v_mfma_f32_16x16x32_bf16 v[88:91], v[116:119], v[52:55], v[88:91]
    v_mfma_f32_16x16x32_bf16 v[92:95], v[196:199], v[52:55], v[92:95]
    ds_read_b64_tr_b16 v[32:33], v10 offset:8192
    ds_read_b64_tr_b16 v[34:35], v10 offset:8704
    s_waitcnt lgkmcnt(6)
    v_mfma_f32_16x16x32_bf16 v[56:59], v[120:123], v[16:19], v[56:59]
    v_mfma_f32_16x16x32_bf16 v[60:63], v[200:203], v[16:19], v[60:63]
    ds_read_b64_tr_b16 v[36:37], v6 offset:18432
    ds_read_b64_tr_b16 v[38:39], v6 offset:19200
    v_mfma_f32_16x16x32_bf16 v[64:67], v[120:123], v[20:23], v[64:67]
    v_mfma_f32_16x16x32_bf16 v[68:71], v[200:203], v[20:23], v[68:71]
    ds_read_b64_tr_b16 v[40:41], v7 offset:18432
    ds_read_b64_tr_b16 v[42:43], v7 offset:19200
    s_waitcnt lgkmcnt(4)
    v_mfma_f32_16x16x32_bf16 v[72:75], v[120:123], v[24:27], v[72:75]
    v_mfma_f32_16x16x32_bf16 v[76:79], v[200:203], v[24:27], v[76:79]
    ds_read_b64_tr_b16 v[44:45], v8 offset:18432
    ds_read_b64_tr_b16 v[46:47], v8 offset:19200
    v_mfma_f32_16x16x32_bf16 v[80:83], v[120:123], v[28:31], v[80:83]
    v_mfma_f32_16x16x32_bf16 v[84:87], v[200:203], v[28:31], v[84:87]
    ds_read_b64_tr_b16 v[48:49], v9 offset:12288
    ds_read_b64_tr_b16 v[50:51], v9 offset:12800
    v_mfma_f32_16x16x32_bf16 v[88:91], v[120:123], v[32:35], v[88:91]
    v_mfma_f32_16x16x32_bf16 v[92:95], v[200:203], v[32:35], v[92:95]
    ds_read_b64_tr_b16 v[52:53], v10 offset:12288
    ds_read_b64_tr_b16 v[54:55], v10 offset:12800
    s_waitcnt lgkmcnt(0)
    s_waitcnt vmcnt(5)
    s_barrier
    v_add_u32 v6, 40960, v6
    v_add_u32 v7, 40960, v7
    v_add_u32 v8, 40960, v8
    v_add_u32 v9, 40960, v9
    v_add_u32 v10, 40960, v10
    v_mfma_f32_16x16x32_bf16 v[56:59], v[124:127], v[36:39], v[56:59]
    v_mfma_f32_16x16x32_bf16 v[60:63], v[204:207], v[36:39], v[60:63]
    ds_read_b64_tr_b16 v[16:17], v6 offset:0
    ds_read_b64_tr_b16 v[18:19], v6 offset:768
    v_mfma_f32_16x16x32_bf16 v[64:67], v[124:127], v[40:43], v[64:67]
    v_mfma_f32_16x16x32_bf16 v[68:71], v[204:207], v[40:43], v[68:71]
    ds_read_b64_tr_b16 v[20:21], v7 offset:0
    ds_read_b64_tr_b16 v[22:23], v7 offset:768
    s_mul_i32 s50, s46, 4
    s_mov_b32 s51, s50
    s_add_u32 m0, s47, 40960
    s_nop 0
    buffer_load_dwordx4 v1, s[16:19], s50 offen lds
    v_mfma_f32_16x16x32_bf16 v[72:75], v[124:127], v[44:47], v[72:75]
    v_mfma_f32_16x16x32_bf16 v[76:79], v[204:207], v[44:47], v[76:79]
    ds_read_b64_tr_b16 v[24:25], v8 offset:0
    ds_read_b64_tr_b16 v[26:27], v8 offset:768
    v_mfma_f32_16x16x32_bf16 v[80:83], v[124:127], v[48:51], v[80:83]
    v_mfma_f32_16x16x32_bf16 v[84:87], v[204:207], v[48:51], v[84:87]
    ds_read_b64_tr_b16 v[28:29], v9 offset:0
    ds_read_b64_tr_b16 v[30:31], v9 offset:512
    s_add_u32 m0, s47, 41984
    s_nop 0
    buffer_load_dwordx4 v2, s[16:19], s50 offen lds
    v_mfma_f32_16x16x32_bf16 v[88:91], v[124:127], v[52:55], v[88:91]
    v_mfma_f32_16x16x32_bf16 v[92:95], v[204:207], v[52:55], v[92:95]
    ds_read_b64_tr_b16 v[32:33], v10 offset:0
    ds_read_b64_tr_b16 v[34:35], v10 offset:512
    s_waitcnt lgkmcnt(6)
    v_mfma_f32_16x16x32_bf16 v[56:59], v[128:131], v[16:19], v[56:59]
    v_mfma_f32_16x16x32_bf16 v[60:63], v[208:211], v[16:19], v[60:63]
    ds_read_b64_tr_b16 v[36:37], v6 offset:6144
    ds_read_b64_tr_b16 v[38:39], v6 offset:6912
    v_mfma_f32_16x16x32_bf16 v[64:67], v[128:131], v[20:23], v[64:67]
    v_mfma_f32_16x16x32_bf16 v[68:71], v[208:211], v[20:23], v[68:71]
    ds_read_b64_tr_b16 v[40:41], v7 offset:6144
    ds_read_b64_tr_b16 v[42:43], v7 offset:6912
    s_add_u32 m0, s47, 43008
    s_nop 0
    buffer_load_dwordx4 v3, s[16:19], s50 offen lds
    s_waitcnt lgkmcnt(4)
    v_mfma_f32_16x16x32_bf16 v[72:75], v[128:131], v[24:27], v[72:75]
    v_mfma_f32_16x16x32_bf16 v[76:79], v[208:211], v[24:27], v[76:79]
    ds_read_b64_tr_b16 v[44:45], v8 offset:6144
    ds_read_b64_tr_b16 v[46:47], v8 offset:6912
    v_mfma_f32_16x16x32_bf16 v[80:83], v[128:131], v[28:31], v[80:83]
    v_mfma_f32_16x16x32_bf16 v[84:87], v[208:211], v[28:31], v[84:87]
    ds_read_b64_tr_b16 v[48:49], v9 offset:4096
    ds_read_b64_tr_b16 v[50:51], v9 offset:4608
    s_add_u32 m0, s48, 40960
    s_nop 0
    buffer_load_dwordx4 v4, s[20:23], s51 offen lds
    v_mfma_f32_16x16x32_bf16 v[88:91], v[128:131], v[32:35], v[88:91]
    v_mfma_f32_16x16x32_bf16 v[92:95], v[208:211], v[32:35], v[92:95]
    ds_read_b64_tr_b16 v[52:53], v10 offset:4096
    ds_read_b64_tr_b16 v[54:55], v10 offset:4608
    s_waitcnt lgkmcnt(6)
    v_mfma_f32_16x16x32_bf16 v[56:59], v[132:135], v[36:39], v[56:59]
    v_mfma_f32_16x16x32_bf16 v[60:63], v[212:215], v[36:39], v[60:63]
    ds_read_b64_tr_b16 v[16:17], v6 offset:12288
    ds_read_b64_tr_b16 v[18:19], v6 offset:13056
    v_mfma_f32_16x16x32_bf16 v[64:67], v[132:135], v[40:43], v[64:67]
    v_mfma_f32_16x16x32_bf16 v[68:71], v[212:215], v[40:43], v[68:71]
    ds_read_b64_tr_b16 v[20:21], v7 offset:12288
    ds_read_b64_tr_b16 v[22:23], v7 offset:13056
    s_add_u32 m0, s48, 41984
    s_nop 0
    buffer_load_dwordx4 v5, s[20:23], s51 offen lds
    s_waitcnt lgkmcnt(4)
    v_mfma_f32_16x16x32_bf16 v[72:75], v[132:135], v[44:47], v[72:75]
    v_mfma_f32_16x16x32_bf16 v[76:79], v[212:215], v[44:47], v[76:79]
    ds_read_b64_tr_b16 v[24:25], v8 offset:12288
    ds_read_b64_tr_b16 v[26:27], v8 offset:13056
    v_mfma_f32_16x16x32_bf16 v[80:83], v[132:135], v[48:51], v[80:83]
    v_mfma_f32_16x16x32_bf16 v[84:87], v[212:215], v[48:51], v[84:87]
    ds_read_b64_tr_b16 v[28:29], v9 offset:8192
    ds_read_b64_tr_b16 v[30:31], v9 offset:8704
    v_mfma_f32_16x16x32_bf16 v[88:91], v[132:135], v[52:55], v[88:91]
    v_mfma_f32_16x16x32_bf16 v[92:95], v[212:215], v[52:55], v[92:95]
    ds_read_b64_tr_b16 v[32:33], v10 offset:8192
    ds_read_b64_tr_b16 v[34:35], v10 offset:8704
    s_waitcnt lgkmcnt(6)
    v_mfma_f32_16x16x32_bf16 v[56:59], v[136:139], v[16:19], v[56:59]
    v_mfma_f32_16x16x32_bf16 v[60:63], v[216:219], v[16:19], v[60:63]
    ds_read_b64_tr_b16 v[36:37], v6 offset:18432
    ds_read_b64_tr_b16 v[38:39], v6 offset:19200
    v_mfma_f32_16x16x32_bf16 v[64:67], v[136:139], v[20:23], v[64:67]
    v_mfma_f32_16x16x32_bf16 v[68:71], v[216:219], v[20:23], v[68:71]
    ds_read_b64_tr_b16 v[40:41], v7 offset:18432
    ds_read_b64_tr_b16 v[42:43], v7 offset:19200
    s_waitcnt lgkmcnt(4)
    v_mfma_f32_16x16x32_bf16 v[72:75], v[136:139], v[24:27], v[72:75]
    v_mfma_f32_16x16x32_bf16 v[76:79], v[216:219], v[24:27], v[76:79]
    ds_read_b64_tr_b16 v[44:45], v8 offset:18432
    ds_read_b64_tr_b16 v[46:47], v8 offset:19200
    v_mfma_f32_16x16x32_bf16 v[80:83], v[136:139], v[28:31], v[80:83]
    v_mfma_f32_16x16x32_bf16 v[84:87], v[216:219], v[28:31], v[84:87]
    ds_read_b64_tr_b16 v[48:49], v9 offset:12288
    ds_read_b64_tr_b16 v[50:51], v9 offset:12800
    v_mfma_f32_16x16x32_bf16 v[88:91], v[136:139], v[32:35], v[88:91]
    v_mfma_f32_16x16x32_bf16 v[92:95], v[216:219], v[32:35], v[92:95]
    ds_read_b64_tr_b16 v[52:53], v10 offset:12288
    ds_read_b64_tr_b16 v[54:55], v10 offset:12800
    s_waitcnt lgkmcnt(0)
    s_waitcnt vmcnt(5)
    s_barrier
    v_subrev_u32 v6, 81920, v6
    v_subrev_u32 v7, 81920, v7
    v_subrev_u32 v8, 81920, v8
    v_subrev_u32 v9, 81920, v9
    v_subrev_u32 v10, 81920, v10
    v_mfma_f32_16x16x32_bf16 v[56:59], v[140:143], v[36:39], v[56:59]
    v_mfma_f32_16x16x32_bf16 v[60:63], v[220:223], v[36:39], v[60:63]
    ds_read_b64_tr_b16 v[16:17], v6 offset:0
    ds_read_b64_tr_b16 v[18:19], v6 offset:768
    v_mfma_f32_16x16x32_bf16 v[64:67], v[140:143], v[40:43], v[64:67]
    v_mfma_f32_16x16x32_bf16 v[68:71], v[220:223], v[40:43], v[68:71]
    ds_read_b64_tr_b16 v[20:21], v7 offset:0
    ds_read_b64_tr_b16 v[22:23], v7 offset:768
    s_mul_i32 s50, s46, 0
    s_add_u32 s51, s50, s56
    s_add_u32 s50, s50, 128
    s_add_u32 m0, s47, 81920
    s_nop 0
    buffer_load_dwordx4 v1, s[20:23], s50 offen lds
    v_mfma_f32_16x16x32_bf16 v[72:75], v[140:143], v[44:47], v[72:75]
    v_mfma_f32_16x16x32_bf16 v[76:79], v[220:223], v[44:47], v[76:79]
    ds_read_b64_tr_b16 v[24:25], v8 offset:0
    ds_read_b64_tr_b16 v[26:27], v8 offset:768
    v_mfma_f32_16x16x32_bf16 v[80:83], v[140:143], v[48:51], v[80:83]
    v_mfma_f32_16x16x32_bf16 v[84:87], v[220:223], v[48:51], v[84:87]
    ds_read_b64_tr_b16 v[28:29], v9 offset:0
    ds_read_b64_tr_b16 v[30:31], v9 offset:512
    s_add_u32 m0, s47, 82944
    s_nop 0
    buffer_load_dwordx4 v2, s[20:23], s50 offen lds
    v_mfma_f32_16x16x32_bf16 v[88:91], v[140:143], v[52:55], v[88:91]
    v_mfma_f32_16x16x32_bf16 v[92:95], v[220:223], v[52:55], v[92:95]
    ds_read_b64_tr_b16 v[32:33], v10 offset:0
    ds_read_b64_tr_b16 v[34:35], v10 offset:512
    s_waitcnt lgkmcnt(6)
    v_mfma_f32_16x16x32_bf16 v[56:59], v[144:147], v[16:19], v[56:59]
    v_mfma_f32_16x16x32_bf16 v[60:63], v[224:227], v[16:19], v[60:63]
    ds_read_b64_tr_b16 v[36:37], v6 offset:6144
    ds_read_b64_tr_b16 v[38:39], v6 offset:6912
    v_mfma_f32_16x16x32_bf16 v[64:67], v[144:147], v[20:23], v[64:67]
    v_mfma_f32_16x16x32_bf16 v[68:71], v[224:227], v[20:23], v[68:71]
    ds_read_b64_tr_b16 v[40:41], v7 offset:6144
    ds_read_b64_tr_b16 v[42:43], v7 offset:6912
    s_add_u32 m0, s47, 83968
    s_nop 0
    buffer_load_dwordx4 v3, s[20:23], s50 offen lds
    s_waitcnt lgkmcnt(4)
    v_mfma_f32_16x16x32_bf16 v[72:75], v[144:147], v[24:27], v[72:75]
    v_mfma_f32_16x16x32_bf16 v[76:79], v[224:227], v[24:27], v[76:79]
    ds_read_b64_tr_b16 v[44:45], v8 offset:6144
    ds_read_b64_tr_b16 v[46:47], v8 offset:6912
    v_mfma_f32_16x16x32_bf16 v[80:83], v[144:147], v[28:31], v[80:83]
    v_mfma_f32_16x16x32_bf16 v[84:87], v[224:227], v[28:31], v[84:87]
    ds_read_b64_tr_b16 v[48:49], v9 offset:4096
    ds_read_b64_tr_b16 v[50:51], v9 offset:4608
    s_add_u32 m0, s48, 81920
    s_nop 0
    buffer_load_dwordx4 v4, s[16:19], s51 offen lds
    v_mfma_f32_16x16x32_bf16 v[88:91], v[144:147], v[32:35], v[88:91]
    v_mfma_f32_16x16x32_bf16 v[92:95], v[224:227], v[32:35], v[92:95]
    ds_read_b64_tr_b16 v[52:53], v10 offset:4096
    ds_read_b64_tr_b16 v[54:55], v10 offset:4608
    s_waitcnt lgkmcnt(6)
    v_mfma_f32_16x16x32_bf16 v[56:59], v[148:151], v[36:39], v[56:59]
    v_mfma_f32_16x16x32_bf16 v[60:63], v[228:231], v[36:39], v[60:63]
    ds_read_b64_tr_b16 v[16:17], v6 offset:12288
    ds_read_b64_tr_b16 v[18:19], v6 offset:13056
    v_mfma_f32_16x16x32_bf16 v[64:67], v[148:151], v[40:43], v[64:67]
    v_mfma_f32_16x16x32_bf16 v[68:71], v[228:231], v[40:43], v[68:71]
    ds_read_b64_tr_b16 v[20:21], v7 offset:12288
    ds_read_b64_tr_b16 v[22:23], v7 offset:13056
    s_add_u32 m0, s48, 82944
    s_nop 0
    buffer_load_dwordx4 v5, s[16:19], s51 offen lds
    s_waitcnt lgkmcnt(4)
    v_mfma_f32_16x16x32_bf16 v[72:75], v[148:151], v[44:47], v[72:75]
    v_mfma_f32_16x16x32_bf16 v[76:79], v[228:231], v[44:47], v[76:79]
    ds_read_b64_tr_b16 v[24:25], v8 offset:12288
    ds_read_b64_tr_b16 v[26:27], v8 offset:13056
    v_mfma_f32_16x16x32_bf16 v[80:83], v[148:151], v[48:51], v[80:83]
    v_mfma_f32_16x16x32_bf16 v[84:87], v[228:231], v[48:51], v[84:87]
    ds_read_b64_tr_b16 v[28:29], v9 offset:8192
    ds_read_b64_tr_b16 v[30:31], v9 offset:8704
    v_mfma_f32_16x16x32_bf16 v[88:91], v[148:151], v[52:55], v[88:91]
    v_mfma_f32_16x16x32_bf16 v[92:95], v[228:231], v[52:55], v[92:95]
    ds_read_b64_tr_b16 v[32:33], v10 offset:8192
    ds_read_b64_tr_b16 v[34:35], v10 offset:8704
    s_waitcnt lgkmcnt(6)
    v_mfma_f32_16x16x32_bf16 v[56:59], v[152:155], v[16:19], v[56:59]
    v_mfma_f32_16x16x32_bf16 v[60:63], v[232:235], v[16:19], v[60:63]
    ds_read_b64_tr_b16 v[36:37], v6 offset:18432
    ds_read_b64_tr_b16 v[38:39], v6 offset:19200
    v_mfma_f32_16x16x32_bf16 v[64:67], v[152:155], v[20:23], v[64:67]
    v_mfma_f32_16x16x32_bf16 v[68:71], v[232:235], v[20:23], v[68:71]
    ds_read_b64_tr_b16 v[40:41], v7 offset:18432
    ds_read_b64_tr_b16 v[42:43], v7 offset:19200
    s_waitcnt lgkmcnt(4)
    v_mfma_f32_16x16x32_bf16 v[72:75], v[152:155], v[24:27], v[72:75]
    v_mfma_f32_16x16x32_bf16 v[76:79], v[232:235], v[24:27], v[76:79]
    ds_read_b64_tr_b16 v[44:45], v8 offset:18432
    ds_read_b64_tr_b16 v[46:47], v8 offset:19200
    v_mfma_f32_16x16x32_bf16 v[80:83], v[152:155], v[28:31], v[80:83]
    v_mfma_f32_16x16x32_bf16 v[84:87], v[232:235], v[28:31], v[84:87]
    ds_read_b64_tr_b16 v[48:49], v9 offset:12288
    ds_read_b64_tr_b16 v[50:51], v9 offset:12800
    v_mfma_f32_16x16x32_bf16 v[88:91], v[152:155], v[32:35], v[88:91]
    v_mfma_f32_16x16x32_bf16 v[92:95], v[232:235], v[32:35], v[92:95]
    ds_read_b64_tr_b16 v[52:53], v10 offset:12288
    ds_read_b64_tr_b16 v[54:55], v10 offset:12800
    s_waitcnt lgkmcnt(0)
    s_waitcnt vmcnt(5)
    s_barrier
    v_add_u32 v6, 40960, v6
    v_add_u32 v7, 40960, v7
    v_add_u32 v8, 40960, v8
    v_add_u32 v9, 40960, v9
    v_add_u32 v10, 40960, v10
    v_mfma_f32_16x16x32_bf16 v[56:59], v[156:159], v[36:39], v[56:59]
    v_mfma_f32_16x16x32_bf16 v[60:63], v[236:239], v[36:39], v[60:63]
    ds_read_b64_tr_b16 v[16:17], v6 offset:0
    ds_read_b64_tr_b16 v[18:19], v6 offset:768
    v_mfma_f32_16x16x32_bf16 v[64:67], v[156:159], v[40:43], v[64:67]
    v_mfma_f32_16x16x32_bf16 v[68:71], v[236:239], v[40:43], v[68:71]
    ds_read_b64_tr_b16 v[20:21], v7 offset:0
    ds_read_b64_tr_b16 v[22:23], v7 offset:768
    s_mul_i32 s50, s46, 1
    s_add_u32 s51, s50, s56
    s_add_u32 s50, s50, 128
    s_add_u32 m0, s47, 0
    s_nop 0
    buffer_load_dwordx4 v1, s[20:23], s50 offen lds
    v_mfma_f32_16x16x32_bf16 v[72:75], v[156:159], v[44:47], v[72:75]
    v_mfma_f32_16x16x32_bf16 v[76:79], v[236:239], v[44:47], v[76:79]
    ds_read_b64_tr_b16 v[24:25], v8 offset:0
    ds_read_b64_tr_b16 v[26:27], v8 offset:768
    v_mfma_f32_16x16x32_bf16 v[80:83], v[156:159], v[48:51], v[80:83]
    v_mfma_f32_16x16x32_bf16 v[84:87], v[236:239], v[48:51], v[84:87]
    ds_read_b64_tr_b16 v[28:29], v9 offset:0
    ds_read_b64_tr_b16 v[30:31], v9 offset:512
    s_add_u32 m0, s47, 1024
    s_nop 0
    buffer_load_dwordx4 v2, s[20:23], s50 offen lds
    v_mfma_f32_16x16x32_bf16 v[88:91], v[156:159], v[52:55], v[88:91]
    v_mfma_f32_16x16x32_bf16 v[92:95], v[236:239], v[52:55], v[92:95]
    ds_read_b64_tr_b16 v[32:33], v10 offset:0
    ds_read_b64_tr_b16 v[34:35], v10 offset:512
    s_waitcnt lgkmcnt(6)
    v_mfma_f32_16x16x32_bf16 v[56:59], v[160:163], v[16:19], v[56:59]
    v_mfma_f32_16x16x32_bf16 v[60:63], v[240:243], v[16:19], v[60:63]
    ds_read_b64_tr_b16 v[36:37], v6 offset:6144
    ds_read_b64_tr_b16 v[38:39], v6 offset:6912
    v_mfma_f32_16x16x32_bf16 v[64:67], v[160:163], v[20:23], v[64:67]
    v_mfma_f32_16x16x32_bf16 v[68:71], v[240:243], v[20:23], v[68:71]
    ds_read_b64_tr_b16 v[40:41], v7 offset:6144
    ds_read_b64_tr_b16 v[42:43], v7 offset:6912
    s_add_u32 m0, s47, 2048
    s_nop 0
    buffer_load_dwordx4 v3, s[20:23], s50 offen lds
    s_waitcnt lgkmcnt(4)
    v_mfma_f32_16x16x32_bf16 v[72:75], v[160:163], v[24:27], v[72:75]
    v_mfma_f32_16x16x32_bf16 v[76:79], v[240:243], v[24:27], v[76:79]
    ds_read_b64_tr_b16 v[44:45], v8 offset:6144
    ds_read_b64_tr_b16 v[46:47], v8 offset:6912
    v_mfma_f32_16x16x32_bf16 v[80:83], v[160:163], v[28:31], v[80:83]
    v_mfma_f32_16x16x32_bf16 v[84:87], v[240:243], v[28:31], v[84:87]
    ds_read_b64_tr_b16 v[48:49], v9 offset:4096
    ds_read_b64_tr_b16 v[50:51], v9 offset:4608
    s_add_u32 m0, s48, 0
    s_nop 0
    buffer_load_dwordx4 v4, s[16:19], s51 offen lds
    v_mfma_f32_16x16x32_bf16 v[88:91], v[160:163], v[32:35], v[88:91]
    v_mfma_f32_16x16x32_bf16 v[92:95], v[240:243], v[32:35], v[92:95]
    ds_read_b64_tr_b16 v[52:53], v10 offset:4096
    ds_read_b64_tr_b16 v[54:55], v10 offset:4608
    s_waitcnt lgkmcnt(6)
    v_mfma_f32_16x16x32_bf16 v[56:59], v[164:167], v[36:39], v[56:59]
    v_mfma_f32_16x16x32_bf16 v[60:63], v[244:247], v[36:39], v[60:63]
    ds_read_b64_tr_b16 v[16:17], v6 offset:12288
    ds_read_b64_tr_b16 v[18:19], v6 offset:13056
    v_mfma_f32_16x16x32_bf16 v[64:67], v[164:167], v[40:43], v[64:67]
    v_mfma_f32_16x16x32_bf16 v[68:71], v[244:247], v[40:43], v[68:71]
    ds_read_b64_tr_b16 v[20:21], v7 offset:12288
    ds_read_b64_tr_b16 v[22:23], v7 offset:13056
    s_add_u32 m0, s48, 1024
    s_nop 0
    buffer_load_dwordx4 v5, s[16:19], s51 offen lds
    s_waitcnt lgkmcnt(4)
    v_mfma_f32_16x16x32_bf16 v[72:75], v[164:167], v[44:47], v[72:75]
    v_mfma_f32_16x16x32_bf16 v[76:79], v[244:247], v[44:47], v[76:79]
    ds_read_b64_tr_b16 v[24:25], v8 offset:12288
    ds_read_b64_tr_b16 v[26:27], v8 offset:13056
    v_mfma_f32_16x16x32_bf16 v[80:83], v[164:167], v[48:51], v[80:83]
    v_mfma_f32_16x16x32_bf16 v[84:87], v[244:247], v[48:51], v[84:87]
    ds_read_b64_tr_b16 v[28:29], v9 offset:8192
    ds_read_b64_tr_b16 v[30:31], v9 offset:8704
    v_mfma_f32_16x16x32_bf16 v[88:91], v[164:167], v[52:55], v[88:91]
    v_mfma_f32_16x16x32_bf16 v[92:95], v[244:247], v[52:55], v[92:95]
    ds_read_b64_tr_b16 v[32:33], v10 offset:8192
    ds_read_b64_tr_b16 v[34:35], v10 offset:8704
    s_waitcnt lgkmcnt(6)
    v_mfma_f32_16x16x32_bf16 v[56:59], v[168:171], v[16:19], v[56:59]
    v_mfma_f32_16x16x32_bf16 v[60:63], v[248:251], v[16:19], v[60:63]
    ds_read_b64_tr_b16 v[36:37], v6 offset:18432
    ds_read_b64_tr_b16 v[38:39], v6 offset:19200
    v_mfma_f32_16x16x32_bf16 v[64:67], v[168:171], v[20:23], v[64:67]
    v_mfma_f32_16x16x32_bf16 v[68:71], v[248:251], v[20:23], v[68:71]
    ds_read_b64_tr_b16 v[40:41], v7 offset:18432
    ds_read_b64_tr_b16 v[42:43], v7 offset:19200
    s_waitcnt lgkmcnt(4)
    v_mfma_f32_16x16x32_bf16 v[72:75], v[168:171], v[24:27], v[72:75]
    v_mfma_f32_16x16x32_bf16 v[76:79], v[248:251], v[24:27], v[76:79]
    ds_read_b64_tr_b16 v[44:45], v8 offset:18432
    ds_read_b64_tr_b16 v[46:47], v8 offset:19200
    v_mfma_f32_16x16x32_bf16 v[80:83], v[168:171], v[28:31], v[80:83]
    v_mfma_f32_16x16x32_bf16 v[84:87], v[248:251], v[28:31], v[84:87]
    ds_read_b64_tr_b16 v[48:49], v9 offset:12288
    ds_read_b64_tr_b16 v[50:51], v9 offset:12800
    v_mfma_f32_16x16x32_bf16 v[88:91], v[168:171], v[32:35], v[88:91]
    v_mfma_f32_16x16x32_bf16 v[92:95], v[248:251], v[32:35], v[92:95]
    ds_read_b64_tr_b16 v[52:53], v10 offset:12288
    ds_read_b64_tr_b16 v[54:55], v10 offset:12800
    s_waitcnt lgkmcnt(0)
    s_waitcnt vmcnt(5)
    s_barrier
    v_bfe_u32 v16, v0, 2, 2
    v_and_b32 v17, 3, v0
    v_lshl_add_u32 v18, v12, 3, v16
    v_and_b32 v19, 1, v12
    v_mul_u32_u24 v21, 192, v18
    v_lshl_add_u32 v21, v17, 3, v21
    v_add_u32 v21, 81920, v21
    s_cmp_eq_u32 s38, 0
    s_cselect_b32 s50, 0, 1
    v_xor_b32 v20, s50, v19
    v_lshl_add_u32 v6, v20, 5, v21
    s_cmp_eq_u32 s38, 0
    s_cselect_b32 s50, 2, 4
    v_xor_b32 v20, s50, v19
    v_lshl_add_u32 v7, v20, 5, v21
    s_cmp_eq_u32 s38, 0
    s_cselect_b32 s50, 3, 5
    v_xor_b32 v20, s50, v19
    v_lshl_add_u32 v8, v20, 5, v21
    v_lshrrev_b32 v20, 1, v16
    v_lshl_or_b32 v19, v19, 1, v20
    v_lshlrev_b32 v21, 7, v18
    v_lshl_add_u32 v21, v17, 3, v21
    v_add_u32 v21, 106496, v21
    s_lshl_b32 s49, s38, 1
    s_add_u32 s50, s49, 0
    v_xor_b32 v20, s50, v19
    v_lshl_add_u32 v9, v20, 5, v21
    s_add_u32 s50, s49, 1
    v_xor_b32 v20, s50, v19
    v_lshl_add_u32 v10, v20, 5, v21
    v_mfma_f32_16x16x32_bf16 v[56:59], v[172:175], v[36:39], v[56:59]
    v_mfma_f32_16x16x32_bf16 v[60:63], v[252:255], v[36:39], v[60:63]
    ds_read_b64_tr_b16 v[16:17], v6 offset:0
    ds_read_b64_tr_b16 v[18:19], v6 offset:768
    v_mfma_f32_16x16x32_bf16 v[64:67], v[172:175], v[40:43], v[64:67]
    v_mfma_f32_16x16x32_bf16 v[68:71], v[252:255], v[40:43], v[68:71]
    ds_read_b64_tr_b16 v[20:21], v7 offset:0
    ds_read_b64_tr_b16 v[22:23], v7 offset:768
    s_mul_i32 s50, s46, 2
    s_add_u32 s51, s50, s56
    s_add_u32 s50, s50, 128
    s_add_u32 m0, s47, 40960
    s_nop 0
    buffer_load_dwordx4 v1, s[20:23], s50 offen lds
    v_mfma_f32_16x16x32_bf16 v[72:75], v[172:175], v[44:47], v[72:75]
    v_mfma_f32_16x16x32_bf16 v[76:79], v[252:255], v[44:47], v[76:79]
    ds_read_b64_tr_b16 v[24:25], v8 offset:0
    ds_read_b64_tr_b16 v[26:27], v8 offset:768
    v_mfma_f32_16x16x32_bf16 v[80:83], v[172:175], v[48:51], v[80:83]
    v_mfma_f32_16x16x32_bf16 v[84:87], v[252:255], v[48:51], v[84:87]
    ds_read_b64_tr_b16 v[28:29], v9 offset:0
    ds_read_b64_tr_b16 v[30:31], v9 offset:512
    s_add_u32 m0, s47, 41984
    s_nop 0
    buffer_load_dwordx4 v2, s[20:23], s50 offen lds
    v_mfma_f32_16x16x32_bf16 v[88:91], v[172:175], v[52:55], v[88:91]
    v_mfma_f32_16x16x32_bf16 v[92:95], v[252:255], v[52:55], v[92:95]
    ds_read_b64_tr_b16 v[32:33], v10 offset:0
    ds_read_b64_tr_b16 v[34:35], v10 offset:512
    s_sub_u32 s52, s35, 4
    s_mul_i32 s52, s52, 320
    s_mul_i32 s53, s39, 40
    s_add_u32 s53, s53, 8388608
    v_lshlrev_b32 v13, 8, v12
    v_lshlrev_b32 v14, 6, v12
    v_add_u32 v14, 1024, v14
    s_cmp_eq_u32 s38, 0
    s_cselect_b32 s54, 0, 2
    s_lshl_b32 s54, s54, 4
    s_add_u32 s54, s54, s52
    v_add_u32 v40, s54, v11
    v_mul_u32_u24 v41, 3277, v40
    v_lshrrev_b32 v41, 16, v41
    v_mul_u32_u24 v42, 20, v41
    v_sub_u32 v42, v40, v42
    v_cmp_le_u32 vcc, 16, v42
    s_nop 1
    v_cndmask_b32 v43, v13, v14, vcc
    v_and_b32 v42, 15, v42
    v_mul_u32_u24 v41, 81920, v41
    v_lshl_add_u32 v41, v42, 4, v41
    v_add_u32 v41, v41, v43
    v_cvt_pk_bf16_f32 v36, v56, v57
    v_cvt_pk_bf16_f32 v37, v58, v59
    v_cvt_pk_bf16_f32 v38, v60, v61
    v_cvt_pk_bf16_f32 v39, v62, v63
    buffer_store_dwordx4 v[36:39], v41, s[28:31], s53 offen
    s_cmp_eq_u32 s38, 0
    s_cselect_b32 s54, 1, 3
    s_lshl_b32 s54, s54, 4
    s_add_u32 s54, s54, s52
    v_add_u32 v48, s54, v11
    v_mul_u32_u24 v49, 3277, v48
    v_lshrrev_b32 v49, 16, v49
    v_mul_u32_u24 v50, 20, v49
    v_sub_u32 v50, v48, v50
    v_cmp_le_u32 vcc, 16, v50
    s_nop 1
    v_cndmask_b32 v51, v13, v14, vcc
    v_and_b32 v50, 15, v50
    v_mul_u32_u24 v49, 81920, v49
    v_lshl_add_u32 v49, v50, 4, v49
    v_add_u32 v49, v49, v51
    v_cvt_pk_bf16_f32 v44, v64, v65
    v_cvt_pk_bf16_f32 v45, v66, v67
    v_cvt_pk_bf16_f32 v46, v68, v69
    v_cvt_pk_bf16_f32 v47, v70, v71
    buffer_store_dwordx4 v[44:47], v49, s[28:31], s53 offen
    s_cmp_eq_u32 s38, 0
    s_cselect_b32 s54, 4, 5
    s_lshl_b32 s54, s54, 4
    s_add_u32 s54, s54, s52
    v_add_u32 v40, s54, v11
    v_mul_u32_u24 v41, 3277, v40
    v_lshrrev_b32 v41, 16, v41
    v_mul_u32_u24 v42, 20, v41
    v_sub_u32 v42, v40, v42
    v_cmp_le_u32 vcc, 16, v42
    s_nop 1
    v_cndmask_b32 v43, v13, v14, vcc
    v_and_b32 v42, 15, v42
    v_mul_u32_u24 v41, 81920, v41
    v_lshl_add_u32 v41, v42, 4, v41
    v_add_u32 v41, v41, v43
    v_cvt_pk_bf16_f32 v36, v72, v73
    v_cvt_pk_bf16_f32 v37, v74, v75
    v_cvt_pk_bf16_f32 v38, v76, v77
    v_cvt_pk_bf16_f32 v39, v78, v79
    buffer_store_dwordx4 v[36:39], v41, s[28:31], s53 offen
    s_cmp_eq_u32 s38, 0
    s_cselect_b32 s54, 6, 8
    s_lshl_b32 s54, s54, 4
    s_add_u32 s54, s54, s52
    v_add_u32 v48, s54, v11
    v_mul_u32_u24 v49, 3277, v48
    v_lshrrev_b32 v49, 16, v49
    v_mul_u32_u24 v50, 20, v49
    v_sub_u32 v50, v48, v50
    v_cmp_le_u32 vcc, 16, v50
    s_nop 1
    v_cndmask_b32 v51, v13, v14, vcc
    v_and_b32 v50, 15, v50
    v_mul_u32_u24 v49, 81920, v49
    v_lshl_add_u32 v49, v50, 4, v49
    v_add_u32 v49, v49, v51
    v_cvt_pk_bf16_f32 v44, v80, v81
    v_cvt_pk_bf16_f32 v45, v82, v83
    v_cvt_pk_bf16_f32 v46, v84, v85
    v_cvt_pk_bf16_f32 v47, v86, v87
    buffer_store_dwordx4 v[44:47], v49, s[28:31], s53 offen
    s_cmp_eq_u32 s38, 0
    s_cselect_b32 s54, 7, 9
    s_lshl_b32 s54, s54, 4
    s_add_u32 s54, s54, s52
    v_add_u32 v40, s54, v11
    v_mul_u32_u24 v41, 3277, v40
    v_lshrrev_b32 v41, 16, v41
    v_mul_u32_u24 v42, 20, v41
    v_sub_u32 v42, v40, v42
    v_cmp_le_u32 vcc, 16, v42
    s_nop 1
    v_cndmask_b32 v43, v13, v14, vcc
    v_and_b32 v42, 15, v42
    v_mul_u32_u24 v41, 81920, v41
    v_lshl_add_u32 v41, v42, 4, v41
    v_add_u32 v41, v41, v43
    v_cvt_pk_bf16_f32 v36, v88, v89
    v_cvt_pk_bf16_f32 v37, v90, v91
    v_cvt_pk_bf16_f32 v38, v92, v93
    v_cvt_pk_bf16_f32 v39, v94, v95
    buffer_store_dwordx4 v[36:39], v41, s[28:31], s53 offen
    s_waitcnt lgkmcnt(6)
    v_mfma_f32_16x16x32_bf16 v[56:59], v[96:99], v[16:19], 0
    v_mfma_f32_16x16x32_bf16 v[60:63], v[176:179], v[16:19], 0
    ds_read_b64_tr_b16 v[36:37], v6 offset:6144
    ds_read_b64_tr_b16 v[38:39], v6 offset:6912
    v_mfma_f32_16x16x32_bf16 v[64:67], v[96:99], v[20:23], 0
    v_mfma_f32_16x16x32_bf16 v[68:71], v[176:179], v[20:23], 0
    ds_read_b64_tr_b16 v[40:41], v7 offset:6144
    ds_read_b64_tr_b16 v[42:43], v7 offset:6912
    s_add_u32 m0, s47, 43008
    s_nop 0
    buffer_load_dwordx4 v3, s[20:23], s50 offen lds
    s_waitcnt lgkmcnt(4)
    v_mfma_f32_16x16x32_bf16 v[72:75], v[96:99], v[24:27], 0
    v_mfma_f32_16x16x32_bf16 v[76:79], v[176:179], v[24:27], 0
    ds_read_b64_tr_b16 v[44:45], v8 offset:6144
    ds_read_b64_tr_b16 v[46:47], v8 offset:6912
    v_mfma_f32_16x16x32_bf16 v[80:83], v[96:99], v[28:31], 0
    v_mfma_f32_16x16x32_bf16 v[84:87], v[176:179], v[28:31], 0
    ds_read_b64_tr_b16 v[48:49], v9 offset:4096
    ds_read_b64_tr_b16 v[50:51], v9 offset:4608
    s_add_u32 m0, s48, 40960
    s_nop 0
    buffer_load_dwordx4 v4, s[16:19], s51 offen lds
    v_mfma_f32_16x16x32_bf16 v[88:91], v[96:99], v[32:35], 0
    v_mfma_f32_16x16x32_bf16 v[92:95], v[176:179], v[32:35], 0
    ds_read_b64_tr_b16 v[52:53], v10 offset:4096
    ds_read_b64_tr_b16 v[54:55], v10 offset:4608
    s_waitcnt lgkmcnt(6)
    v_mfma_f32_16x16x32_bf16 v[56:59], v[100:103], v[36:39], v[56:59]
    v_mfma_f32_16x16x32_bf16 v[60:63], v[180:183], v[36:39], v[60:63]
    ds_read_b64_tr_b16 v[16:17], v6 offset:12288
    ds_read_b64_tr_b16 v[18:19], v6 offset:13056
    v_mfma_f32_16x16x32_bf16 v[64:67], v[100:103], v[40:43], v[64:67]
    v_mfma_f32_16x16x32_bf16 v[68:71], v[180:183], v[40:43], v[68:71]
    ds_read_b64_tr_b16 v[20:21], v7 offset:12288
    ds_read_b64_tr_b16 v[22:23], v7 offset:13056
    s_add_u32 m0, s48, 41984
    s_nop 0
    buffer_load_dwordx4 v5, s[16:19], s51 offen lds
    s_waitcnt lgkmcnt(4)
    v_mfma_f32_16x16x32_bf16 v[72:75], v[100:103], v[44:47], v[72:75]
    v_mfma_f32_16x16x32_bf16 v[76:79], v[180:183], v[44:47], v[76:79]
    ds_read_b64_tr_b16 v[24:25], v8 offset:12288
    ds_read_b64_tr_b16 v[26:27], v8 offset:13056
    v_mfma_f32_16x16x32_bf16 v[80:83], v[100:103], v[48:51], v[80:83]
    v_mfma_f32_16x16x32_bf16 v[84:87], v[180:183], v[48:51], v[84:87]
    ds_read_b64_tr_b16 v[28:29], v9 offset:8192
    ds_read_b64_tr_b16 v[30:31], v9 offset:8704
    v_mfma_f32_16x16x32_bf16 v[88:91], v[100:103], v[52:55], v[88:91]
    v_mfma_f32_16x16x32_bf16 v[92:95], v[180:183], v[52:55], v[92:95]
    ds_read_b64_tr_b16 v[32:33], v10 offset:8192
    ds_read_b64_tr_b16 v[34:35], v10 offset:8704
    s_waitcnt lgkmcnt(6)
    v_mfma_f32_16x16x32_bf16 v[56:59], v[104:107], v[16:19], v[56:59]
    v_mfma_f32_16x16x32_bf16 v[60:63], v[184:187], v[16:19], v[60:63]
    ds_read_b64_tr_b16 v[36:37], v6 offset:18432
    ds_read_b64_tr_b16 v[38:39], v6 offset:19200
    v_mfma_f32_16x16x32_bf16 v[64:67], v[104:107], v[20:23], v[64:67]
    v_mfma_f32_16x16x32_bf16 v[68:71], v[184:187], v[20:23], v[68:71]
    ds_read_b64_tr_b16 v[40:41], v7 offset:18432
    ds_read_b64_tr_b16 v[42:43], v7 offset:19200
    s_waitcnt lgkmcnt(4)
    v_mfma_f32_16x16x32_bf16 v[72:75], v[104:107], v[24:27], v[72:75]
    v_mfma_f32_16x16x32_bf16 v[76:79], v[184:187], v[24:27], v[76:79]
    ds_read_b64_tr_b16 v[44:45], v8 offset:18432
    ds_read_b64_tr_b16 v[46:47], v8 offset:19200
    v_mfma_f32_16x16x32_bf16 v[80:83], v[104:107], v[28:31], v[80:83]
    v_mfma_f32_16x16x32_bf16 v[84:87], v[184:187], v[28:31], v[84:87]
    ds_read_b64_tr_b16 v[48:49], v9 offset:12288
    ds_read_b64_tr_b16 v[50:51], v9 offset:12800
    v_mfma_f32_16x16x32_bf16 v[88:91], v[104:107], v[32:35], v[88:91]
    v_mfma_f32_16x16x32_bf16 v[92:95], v[184:187], v[32:35], v[92:95]
    ds_read_b64_tr_b16 v[52:53], v10 offset:12288
    ds_read_b64_tr_b16 v[54:55], v10 offset:12800
    s_waitcnt lgkmcnt(0)
    s_waitcnt vmcnt(10)
    s_barrier
    v_subrev_u32 v6, 81920, v6
    v_subrev_u32 v7, 81920, v7
    v_subrev_u32 v8, 81920, v8
    v_subrev_u32 v9, 81920, v9
    v_subrev_u32 v10, 81920, v10
    v_mfma_f32_16x16x32_bf16 v[56:59], v[108:111], v[36:39], v[56:59]
    v_mfma_f32_16x16x32_bf16 v[60:63], v[188:191], v[36:39], v[60:63]
    ds_read_b64_tr_b16 v[16:17], v6 offset:0
    ds_read_b64_tr_b16 v[18:19], v6 offset:768
    v_mfma_f32_16x16x32_bf16 v[64:67], v[108:111], v[40:43], v[64:67]
    v_mfma_f32_16x16x32_bf16 v[68:71], v[188:191], v[40:43], v[68:71]
    ds_read_b64_tr_b16 v[20:21], v7 offset:0
    ds_read_b64_tr_b16 v[22:23], v7 offset:768
    s_mul_i32 s50, s46, 3
    s_add_u32 s51, s50, s56
    s_add_u32 s50, s50, 128
    s_add_u32 m0, s47, 81920
    s_nop 0
    buffer_load_dwordx4 v1, s[20:23], s50 offen lds
    v_mfma_f32_16x16x32_bf16 v[72:75], v[108:111], v[44:47], v[72:75]
    v_mfma_f32_16x16x32_bf16 v[76:79], v[188:191], v[44:47], v[76:79]
    ds_read_b64_tr_b16 v[24:25], v8 offset:0
    ds_read_b64_tr_b16 v[26:27], v8 offset:768
    v_mfma_f32_16x16x32_bf16 v[80:83], v[108:111], v[48:51], v[80:83]
    v_mfma_f32_16x16x32_bf16 v[84:87], v[188:191], v[48:51], v[84:87]
    ds_read_b64_tr_b16 v[28:29], v9 offset:0
    ds_read_b64_tr_b16 v[30:31], v9 offset:512
    s_add_u32 m0, s47, 82944
    s_nop 0
    buffer_load_dwordx4 v2, s[20:23], s50 offen lds
    v_mfma_f32_16x16x32_bf16 v[88:91], v[108:111], v[52:55], v[88:91]
    v_mfma_f32_16x16x32_bf16 v[92:95], v[188:191], v[52:55], v[92:95]
    ds_read_b64_tr_b16 v[32:33], v10 offset:0
    ds_read_b64_tr_b16 v[34:35], v10 offset:512
    s_waitcnt lgkmcnt(6)
    v_mfma_f32_16x16x32_bf16 v[56:59], v[112:115], v[16:19], v[56:59]
    v_mfma_f32_16x16x32_bf16 v[60:63], v[192:195], v[16:19], v[60:63]
    ds_read_b64_tr_b16 v[36:37], v6 offset:6144
    ds_read_b64_tr_b16 v[38:39], v6 offset:6912
    v_mfma_f32_16x16x32_bf16 v[64:67], v[112:115], v[20:23], v[64:67]
    v_mfma_f32_16x16x32_bf16 v[68:71], v[192:195], v[20:23], v[68:71]
    ds_read_b64_tr_b16 v[40:41], v7 offset:6144
    ds_read_b64_tr_b16 v[42:43], v7 offset:6912
    s_add_u32 m0, s47, 83968
    s_nop 0
    buffer_load_dwordx4 v3, s[20:23], s50 offen lds
    s_waitcnt lgkmcnt(4)
    v_mfma_f32_16x16x32_bf16 v[72:75], v[112:115], v[24:27], v[72:75]
    v_mfma_f32_16x16x32_bf16 v[76:79], v[192:195], v[24:27], v[76:79]
    ds_read_b64_tr_b16 v[44:45], v8 offset:6144
    ds_read_b64_tr_b16 v[46:47], v8 offset:6912
    v_mfma_f32_16x16x32_bf16 v[80:83], v[112:115], v[28:31], v[80:83]
    v_mfma_f32_16x16x32_bf16 v[84:87], v[192:195], v[28:31], v[84:87]
    ds_read_b64_tr_b16 v[48:49], v9 offset:4096
    ds_read_b64_tr_b16 v[50:51], v9 offset:4608
    s_add_u32 m0, s48, 81920
    s_nop 0
    buffer_load_dwordx4 v4, s[16:19], s51 offen lds
    v_mfma_f32_16x16x32_bf16 v[88:91], v[112:115], v[32:35], v[88:91]
    v_mfma_f32_16x16x32_bf16 v[92:95], v[192:195], v[32:35], v[92:95]
    ds_read_b64_tr_b16 v[52:53], v10 offset:4096
    ds_read_b64_tr_b16 v[54:55], v10 offset:4608
    s_waitcnt lgkmcnt(6)
    v_mfma_f32_16x16x32_bf16 v[56:59], v[116:119], v[36:39], v[56:59]
    v_mfma_f32_16x16x32_bf16 v[60:63], v[196:199], v[36:39], v[60:63]
    ds_read_b64_tr_b16 v[16:17], v6 offset:12288
    ds_read_b64_tr_b16 v[18:19], v6 offset:13056
    v_mfma_f32_16x16x32_bf16 v[64:67], v[116:119], v[40:43], v[64:67]
    v_mfma_f32_16x16x32_bf16 v[68:71], v[196:199], v[40:43], v[68:71]
    ds_read_b64_tr_b16 v[20:21], v7 offset:12288
    ds_read_b64_tr_b16 v[22:23], v7 offset:13056
    s_add_u32 m0, s48, 82944
    s_nop 0
    buffer_load_dwordx4 v5, s[16:19], s51 offen lds
    s_waitcnt lgkmcnt(4)
    v_mfma_f32_16x16x32_bf16 v[72:75], v[116:119], v[44:47], v[72:75]
    v_mfma_f32_16x16x32_bf16 v[76:79], v[196:199], v[44:47], v[76:79]
    ds_read_b64_tr_b16 v[24:25], v8 offset:12288
    ds_read_b64_tr_b16 v[26:27], v8 offset:13056
    v_mfma_f32_16x16x32_bf16 v[80:83], v[116:119], v[48:51], v[80:83]
    v_mfma_f32_16x16x32_bf16 v[84:87], v[196:199], v[48:51], v[84:87]
    ds_read_b64_tr_b16 v[28:29], v9 offset:8192
    ds_read_b64_tr_b16 v[30:31], v9 offset:8704
    v_mfma_f32_16x16x32_bf16 v[88:91], v[116:119], v[52:55], v[88:91]
    v_mfma_f32_16x16x32_bf16 v[92:95], v[196:199], v[52:55], v[92:95]
    ds_read_b64_tr_b16 v[32:33], v10 offset:8192
    ds_read_b64_tr_b16 v[34:35], v10 offset:8704
    s_waitcnt lgkmcnt(6)
    v_mfma_f32_16x16x32_bf16 v[56:59], v[120:123], v[16:19], v[56:59]
    v_mfma_f32_16x16x32_bf16 v[60:63], v[200:203], v[16:19], v[60:63]
    ds_read_b64_tr_b16 v[36:37], v6 offset:18432
    ds_read_b64_tr_b16 v[38:39], v6 offset:19200
    v_mfma_f32_16x16x32_bf16 v[64:67], v[120:123], v[20:23], v[64:67]
    v_mfma_f32_16x16x32_bf16 v[68:71], v[200:203], v[20:23], v[68:71]
    ds_read_b64_tr_b16 v[40:41], v7 offset:18432
    ds_read_b64_tr_b16 v[42:43], v7 offset:19200
    s_waitcnt lgkmcnt(4)
    v_mfma_f32_16x16x32_bf16 v[72:75], v[120:123], v[24:27], v[72:75]
    v_mfma_f32_16x16x32_bf16 v[76:79], v[200:203], v[24:27], v[76:79]
    ds_read_b64_tr_b16 v[44:45], v8 offset:18432
    ds_read_b64_tr_b16 v[46:47], v8 offset:19200
    v_mfma_f32_16x16x32_bf16 v[80:83], v[120:123], v[28:31], v[80:83]
    v_mfma_f32_16x16x32_bf16 v[84:87], v[200:203], v[28:31], v[84:87]
    ds_read_b64_tr_b16 v[48:49], v9 offset:12288
    ds_read_b64_tr_b16 v[50:51], v9 offset:12800
    v_mfma_f32_16x16x32_bf16 v[88:91], v[120:123], v[32:35], v[88:91]
    v_mfma_f32_16x16x32_bf16 v[92:95], v[200:203], v[32:35], v[92:95]
    ds_read_b64_tr_b16 v[52:53], v10 offset:12288
    ds_read_b64_tr_b16 v[54:55], v10 offset:12800
    s_waitcnt lgkmcnt(0)
    s_waitcnt vmcnt(5)
    s_barrier
    v_add_u32 v6, 40960, v6
    v_add_u32 v7, 40960, v7
    v_add_u32 v8, 40960, v8
    v_add_u32 v9, 40960, v9
    v_add_u32 v10, 40960, v10
    v_mfma_f32_16x16x32_bf16 v[56:59], v[124:127], v[36:39], v[56:59]
    v_mfma_f32_16x16x32_bf16 v[60:63], v[204:207], v[36:39], v[60:63]
    ds_read_b64_tr_b16 v[16:17], v6 offset:0
    ds_read_b64_tr_b16 v[18:19], v6 offset:768
    v_mfma_f32_16x16x32_bf16 v[64:67], v[124:127], v[40:43], v[64:67]
    v_mfma_f32_16x16x32_bf16 v[68:71], v[204:207], v[40:43], v[68:71]
    ds_read_b64_tr_b16 v[20:21], v7 offset:0
    ds_read_b64_tr_b16 v[22:23], v7 offset:768
    s_mul_i32 s50, s46, 4
    s_add_u32 s51, s50, s56
    s_add_u32 s50, s50, 128
    s_add_u32 m0, s47, 0
    s_nop 0
    buffer_load_dwordx4 v1, s[20:23], s50 offen lds
    v_mfma_f32_16x16x32_bf16 v[72:75], v[124:127], v[44:47], v[72:75]
    v_mfma_f32_16x16x32_bf16 v[76:79], v[204:207], v[44:47], v[76:79]
    ds_read_b64_tr_b16 v[24:25], v8 offset:0
    ds_read_b64_tr_b16 v[26:27], v8 offset:768
    v_mfma_f32_16x16x32_bf16 v[80:83], v[124:127], v[48:51], v[80:83]
    v_mfma_f32_16x16x32_bf16 v[84:87], v[204:207], v[48:51], v[84:87]
    ds_read_b64_tr_b16 v[28:29], v9 offset:0
    ds_read_b64_tr_b16 v[30:31], v9 offset:512
    s_add_u32 m0, s47, 1024
    s_nop 0
    buffer_load_dwordx4 v2, s[20:23], s50 offen lds
    v_mfma_f32_16x16x32_bf16 v[88:91], v[124:127], v[52:55], v[88:91]
    v_mfma_f32_16x16x32_bf16 v[92:95], v[204:207], v[52:55], v[92:95]
    ds_read_b64_tr_b16 v[32:33], v10 offset:0
    ds_read_b64_tr_b16 v[34:35], v10 offset:512
    s_waitcnt lgkmcnt(6)
    v_mfma_f32_16x16x32_bf16 v[56:59], v[128:131], v[16:19], v[56:59]
    v_mfma_f32_16x16x32_bf16 v[60:63], v[208:211], v[16:19], v[60:63]
    ds_read_b64_tr_b16 v[36:37], v6 offset:6144
    ds_read_b64_tr_b16 v[38:39], v6 offset:6912
    v_mfma_f32_16x16x32_bf16 v[64:67], v[128:131], v[20:23], v[64:67]
    v_mfma_f32_16x16x32_bf16 v[68:71], v[208:211], v[20:23], v[68:71]
    ds_read_b64_tr_b16 v[40:41], v7 offset:6144
    ds_read_b64_tr_b16 v[42:43], v7 offset:6912
    s_add_u32 m0, s47, 2048
    s_nop 0
    buffer_load_dwordx4 v3, s[20:23], s50 offen lds
    s_waitcnt lgkmcnt(4)
    v_mfma_f32_16x16x32_bf16 v[72:75], v[128:131], v[24:27], v[72:75]
    v_mfma_f32_16x16x32_bf16 v[76:79], v[208:211], v[24:27], v[76:79]
    ds_read_b64_tr_b16 v[44:45], v8 offset:6144
    ds_read_b64_tr_b16 v[46:47], v8 offset:6912
    v_mfma_f32_16x16x32_bf16 v[80:83], v[128:131], v[28:31], v[80:83]
    v_mfma_f32_16x16x32_bf16 v[84:87], v[208:211], v[28:31], v[84:87]
    ds_read_b64_tr_b16 v[48:49], v9 offset:4096
    ds_read_b64_tr_b16 v[50:51], v9 offset:4608
    s_add_u32 m0, s48, 0
    s_nop 0
    buffer_load_dwordx4 v4, s[16:19], s51 offen lds
    v_mfma_f32_16x16x32_bf16 v[88:91], v[128:131], v[32:35], v[88:91]
    v_mfma_f32_16x16x32_bf16 v[92:95], v[208:211], v[32:35], v[92:95]
    ds_read_b64_tr_b16 v[52:53], v10 offset:4096
    ds_read_b64_tr_b16 v[54:55], v10 offset:4608
    s_waitcnt lgkmcnt(6)
    v_mfma_f32_16x16x32_bf16 v[56:59], v[132:135], v[36:39], v[56:59]
    v_mfma_f32_16x16x32_bf16 v[60:63], v[212:215], v[36:39], v[60:63]
    ds_read_b64_tr_b16 v[16:17], v6 offset:12288
    ds_read_b64_tr_b16 v[18:19], v6 offset:13056
    v_mfma_f32_16x16x32_bf16 v[64:67], v[132:135], v[40:43], v[64:67]
    v_mfma_f32_16x16x32_bf16 v[68:71], v[212:215], v[40:43], v[68:71]
    ds_read_b64_tr_b16 v[20:21], v7 offset:12288
    ds_read_b64_tr_b16 v[22:23], v7 offset:13056
    s_add_u32 m0, s48, 1024
    s_nop 0
    buffer_load_dwordx4 v5, s[16:19], s51 offen lds
    s_waitcnt lgkmcnt(4)
    v_mfma_f32_16x16x32_bf16 v[72:75], v[132:135], v[44:47], v[72:75]
    v_mfma_f32_16x16x32_bf16 v[76:79], v[212:215], v[44:47], v[76:79]
    ds_read_b64_tr_b16 v[24:25], v8 offset:12288
    ds_read_b64_tr_b16 v[26:27], v8 offset:13056
    v_mfma_f32_16x16x32_bf16 v[80:83], v[132:135], v[48:51], v[80:83]
    v_mfma_f32_16x16x32_bf16 v[84:87], v[212:215], v[48:51], v[84:87]
    ds_read_b64_tr_b16 v[28:29], v9 offset:8192
    ds_read_b64_tr_b16 v[30:31], v9 offset:8704
    v_mfma_f32_16x16x32_bf16 v[88:91], v[132:135], v[52:55], v[88:91]
    v_mfma_f32_16x16x32_bf16 v[92:95], v[212:215], v[52:55], v[92:95]
    ds_read_b64_tr_b16 v[32:33], v10 offset:8192
    ds_read_b64_tr_b16 v[34:35], v10 offset:8704
    s_waitcnt lgkmcnt(6)
    v_mfma_f32_16x16x32_bf16 v[56:59], v[136:139], v[16:19], v[56:59]
    v_mfma_f32_16x16x32_bf16 v[60:63], v[216:219], v[16:19], v[60:63]
    ds_read_b64_tr_b16 v[36:37], v6 offset:18432
    ds_read_b64_tr_b16 v[38:39], v6 offset:19200
    v_mfma_f32_16x16x32_bf16 v[64:67], v[136:139], v[20:23], v[64:67]
    v_mfma_f32_16x16x32_bf16 v[68:71], v[216:219], v[20:23], v[68:71]
    ds_read_b64_tr_b16 v[40:41], v7 offset:18432
    ds_read_b64_tr_b16 v[42:43], v7 offset:19200
    s_waitcnt lgkmcnt(4)
    v_mfma_f32_16x16x32_bf16 v[72:75], v[136:139], v[24:27], v[72:75]
    v_mfma_f32_16x16x32_bf16 v[76:79], v[216:219], v[24:27], v[76:79]
    ds_read_b64_tr_b16 v[44:45], v8 offset:18432
    ds_read_b64_tr_b16 v[46:47], v8 offset:19200
    v_mfma_f32_16x16x32_bf16 v[80:83], v[136:139], v[28:31], v[80:83]
    v_mfma_f32_16x16x32_bf16 v[84:87], v[216:219], v[28:31], v[84:87]
    ds_read_b64_tr_b16 v[48:49], v9 offset:12288
    ds_read_b64_tr_b16 v[50:51], v9 offset:12800
    v_mfma_f32_16x16x32_bf16 v[88:91], v[136:139], v[32:35], v[88:91]
    v_mfma_f32_16x16x32_bf16 v[92:95], v[216:219], v[32:35], v[92:95]
    ds_read_b64_tr_b16 v[52:53], v10 offset:12288
    ds_read_b64_tr_b16 v[54:55], v10 offset:12800
    s_waitcnt lgkmcnt(0)
    s_waitcnt vmcnt(5)
    s_barrier
    v_add_u32 v6, 40960, v6
    v_add_u32 v7, 40960, v7
    v_add_u32 v8, 40960, v8
    v_add_u32 v9, 40960, v9
    v_add_u32 v10, 40960, v10
    v_mfma_f32_16x16x32_bf16 v[56:59], v[140:143], v[36:39], v[56:59]
    v_mfma_f32_16x16x32_bf16 v[60:63], v[220:223], v[36:39], v[60:63]
    ds_read_b64_tr_b16 v[16:17], v6 offset:0
    ds_read_b64_tr_b16 v[18:19], v6 offset:768
    v_mfma_f32_16x16x32_bf16 v[64:67], v[140:143], v[40:43], v[64:67]
    v_mfma_f32_16x16x32_bf16 v[68:71], v[220:223], v[40:43], v[68:71]
    ds_read_b64_tr_b16 v[20:21], v7 offset:0
    ds_read_b64_tr_b16 v[22:23], v7 offset:768
    v_mfma_f32_16x16x32_bf16 v[72:75], v[140:143], v[44:47], v[72:75]
    v_mfma_f32_16x16x32_bf16 v[76:79], v[220:223], v[44:47], v[76:79]
    ds_read_b64_tr_b16 v[24:25], v8 offset:0
    ds_read_b64_tr_b16 v[26:27], v8 offset:768
    v_mfma_f32_16x16x32_bf16 v[80:83], v[140:143], v[48:51], v[80:83]
    v_mfma_f32_16x16x32_bf16 v[84:87], v[220:223], v[48:51], v[84:87]
    ds_read_b64_tr_b16 v[28:29], v9 offset:0
    ds_read_b64_tr_b16 v[30:31], v9 offset:512
    v_mfma_f32_16x16x32_bf16 v[88:91], v[140:143], v[52:55], v[88:91]
    v_mfma_f32_16x16x32_bf16 v[92:95], v[220:223], v[52:55], v[92:95]
    ds_read_b64_tr_b16 v[32:33], v10 offset:0
    ds_read_b64_tr_b16 v[34:35], v10 offset:512
    s_waitcnt lgkmcnt(6)
    v_mfma_f32_16x16x32_bf16 v[56:59], v[144:147], v[16:19], v[56:59]
    v_mfma_f32_16x16x32_bf16 v[60:63], v[224:227], v[16:19], v[60:63]
    ds_read_b64_tr_b16 v[36:37], v6 offset:6144
    ds_read_b64_tr_b16 v[38:39], v6 offset:6912
    v_mfma_f32_16x16x32_bf16 v[64:67], v[144:147], v[20:23], v[64:67]
    v_mfma_f32_16x16x32_bf16 v[68:71], v[224:227], v[20:23], v[68:71]
    ds_read_b64_tr_b16 v[40:41], v7 offset:6144
    ds_read_b64_tr_b16 v[42:43], v7 offset:6912
    s_waitcnt lgkmcnt(4)
    v_mfma_f32_16x16x32_bf16 v[72:75], v[144:147], v[24:27], v[72:75]
    v_mfma_f32_16x16x32_bf16 v[76:79], v[224:227], v[24:27], v[76:79]
    ds_read_b64_tr_b16 v[44:45], v8 offset:6144
    ds_read_b64_tr_b16 v[46:47], v8 offset:6912
    v_mfma_f32_16x16x32_bf16 v[80:83], v[144:147], v[28:31], v[80:83]
    v_mfma_f32_16x16x32_bf16 v[84:87], v[224:227], v[28:31], v[84:87]
    ds_read_b64_tr_b16 v[48:49], v9 offset:4096
    ds_read_b64_tr_b16 v[50:51], v9 offset:4608
    v_mfma_f32_16x16x32_bf16 v[88:91], v[144:147], v[32:35], v[88:91]
    v_mfma_f32_16x16x32_bf16 v[92:95], v[224:227], v[32:35], v[92:95]
    ds_read_b64_tr_b16 v[52:53], v10 offset:4096
    ds_read_b64_tr_b16 v[54:55], v10 offset:4608
    s_waitcnt lgkmcnt(6)
    v_mfma_f32_16x16x32_bf16 v[56:59], v[148:151], v[36:39], v[56:59]
    v_mfma_f32_16x16x32_bf16 v[60:63], v[228:231], v[36:39], v[60:63]
    ds_read_b64_tr_b16 v[16:17], v6 offset:12288
    ds_read_b64_tr_b16 v[18:19], v6 offset:13056
    v_mfma_f32_16x16x32_bf16 v[64:67], v[148:151], v[40:43], v[64:67]
    v_mfma_f32_16x16x32_bf16 v[68:71], v[228:231], v[40:43], v[68:71]
    ds_read_b64_tr_b16 v[20:21], v7 offset:12288
    ds_read_b64_tr_b16 v[22:23], v7 offset:13056
    s_waitcnt lgkmcnt(4)
    v_mfma_f32_16x16x32_bf16 v[72:75], v[148:151], v[44:47], v[72:75]
    v_mfma_f32_16x16x32_bf16 v[76:79], v[228:231], v[44:47], v[76:79]
    ds_read_b64_tr_b16 v[24:25], v8 offset:12288
    ds_read_b64_tr_b16 v[26:27], v8 offset:13056
    v_mfma_f32_16x16x32_bf16 v[80:83], v[148:151], v[48:51], v[80:83]
    v_mfma_f32_16x16x32_bf16 v[84:87], v[228:231], v[48:51], v[84:87]
    ds_read_b64_tr_b16 v[28:29], v9 offset:8192
    ds_read_b64_tr_b16 v[30:31], v9 offset:8704
    v_mfma_f32_16x16x32_bf16 v[88:91], v[148:151], v[52:55], v[88:91]
    v_mfma_f32_16x16x32_bf16 v[92:95], v[228:231], v[52:55], v[92:95]
    ds_read_b64_tr_b16 v[32:33], v10 offset:8192
    ds_read_b64_tr_b16 v[34:35], v10 offset:8704
    s_waitcnt lgkmcnt(6)
    v_mfma_f32_16x16x32_bf16 v[56:59], v[152:155], v[16:19], v[56:59]
    v_mfma_f32_16x16x32_bf16 v[60:63], v[232:235], v[16:19], v[60:63]
    ds_read_b64_tr_b16 v[36:37], v6 offset:18432
    ds_read_b64_tr_b16 v[38:39], v6 offset:19200
    v_mfma_f32_16x16x32_bf16 v[64:67], v[152:155], v[20:23], v[64:67]
    v_mfma_f32_16x16x32_bf16 v[68:71], v[232:235], v[20:23], v[68:71]
    ds_read_b64_tr_b16 v[40:41], v7 offset:18432
    ds_read_b64_tr_b16 v[42:43], v7 offset:19200
    s_waitcnt lgkmcnt(4)
    v_mfma_f32_16x16x32_bf16 v[72:75], v[152:155], v[24:27], v[72:75]
    v_mfma_f32_16x16x32_bf16 v[76:79], v[232:235], v[24:27], v[76:79]
    ds_read_b64_tr_b16 v[44:45], v8 offset:18432
    ds_read_b64_tr_b16 v[46:47], v8 offset:19200
    v_mfma_f32_16x16x32_bf16 v[80:83], v[152:155], v[28:31], v[80:83]
    v_mfma_f32_16x16x32_bf16 v[84:87], v[232:235], v[28:31], v[84:87]
    ds_read_b64_tr_b16 v[48:49], v9 offset:12288
    ds_read_b64_tr_b16 v[50:51], v9 offset:12800
    v_mfma_f32_16x16x32_bf16 v[88:91], v[152:155], v[32:35], v[88:91]
    v_mfma_f32_16x16x32_bf16 v[92:95], v[232:235], v[32:35], v[92:95]
    ds_read_b64_tr_b16 v[52:53], v10 offset:12288
    ds_read_b64_tr_b16 v[54:55], v10 offset:12800
    s_waitcnt lgkmcnt(0)
    s_waitcnt vmcnt(0)
    s_barrier
    v_subrev_u32 v6, 81920, v6
    v_subrev_u32 v7, 81920, v7
    v_subrev_u32 v8, 81920, v8
    v_subrev_u32 v9, 81920, v9
    v_subrev_u32 v10, 81920, v10
    v_mfma_f32_16x16x32_bf16 v[56:59], v[156:159], v[36:39], v[56:59]
    v_mfma_f32_16x16x32_bf16 v[60:63], v[236:239], v[36:39], v[60:63]
    ds_read_b64_tr_b16 v[16:17], v6 offset:0
    ds_read_b64_tr_b16 v[18:19], v6 offset:768
    v_mfma_f32_16x16x32_bf16 v[64:67], v[156:159], v[40:43], v[64:67]
    v_mfma_f32_16x16x32_bf16 v[68:71], v[236:239], v[40:43], v[68:71]
    ds_read_b64_tr_b16 v[20:21], v7 offset:0
    ds_read_b64_tr_b16 v[22:23], v7 offset:768
    v_mfma_f32_16x16x32_bf16 v[72:75], v[156:159], v[44:47], v[72:75]
    v_mfma_f32_16x16x32_bf16 v[76:79], v[236:239], v[44:47], v[76:79]
    ds_read_b64_tr_b16 v[24:25], v8 offset:0
    ds_read_b64_tr_b16 v[26:27], v8 offset:768
    v_mfma_f32_16x16x32_bf16 v[80:83], v[156:159], v[48:51], v[80:83]
    v_mfma_f32_16x16x32_bf16 v[84:87], v[236:239], v[48:51], v[84:87]
    ds_read_b64_tr_b16 v[28:29], v9 offset:0
    ds_read_b64_tr_b16 v[30:31], v9 offset:512
    v_mfma_f32_16x16x32_bf16 v[88:91], v[156:159], v[52:55], v[88:91]
    v_mfma_f32_16x16x32_bf16 v[92:95], v[236:239], v[52:55], v[92:95]
    ds_read_b64_tr_b16 v[32:33], v10 offset:0
    ds_read_b64_tr_b16 v[34:35], v10 offset:512
    s_waitcnt lgkmcnt(6)
    v_mfma_f32_16x16x32_bf16 v[56:59], v[160:163], v[16:19], v[56:59]
    v_mfma_f32_16x16x32_bf16 v[60:63], v[240:243], v[16:19], v[60:63]
    ds_read_b64_tr_b16 v[36:37], v6 offset:6144
    ds_read_b64_tr_b16 v[38:39], v6 offset:6912
    v_mfma_f32_16x16x32_bf16 v[64:67], v[160:163], v[20:23], v[64:67]
    v_mfma_f32_16x16x32_bf16 v[68:71], v[240:243], v[20:23], v[68:71]
    ds_read_b64_tr_b16 v[40:41], v7 offset:6144
    ds_read_b64_tr_b16 v[42:43], v7 offset:6912
    s_waitcnt lgkmcnt(4)
    v_mfma_f32_16x16x32_bf16 v[72:75], v[160:163], v[24:27], v[72:75]
    v_mfma_f32_16x16x32_bf16 v[76:79], v[240:243], v[24:27], v[76:79]
    ds_read_b64_tr_b16 v[44:45], v8 offset:6144
    ds_read_b64_tr_b16 v[46:47], v8 offset:6912
    v_mfma_f32_16x16x32_bf16 v[80:83], v[160:163], v[28:31], v[80:83]
    v_mfma_f32_16x16x32_bf16 v[84:87], v[240:243], v[28:31], v[84:87]
    ds_read_b64_tr_b16 v[48:49], v9 offset:4096
    ds_read_b64_tr_b16 v[50:51], v9 offset:4608
    v_mfma_f32_16x16x32_bf16 v[88:91], v[160:163], v[32:35], v[88:91]
    v_mfma_f32_16x16x32_bf16 v[92:95], v[240:243], v[32:35], v[92:95]
    ds_read_b64_tr_b16 v[52:53], v10 offset:4096
    ds_read_b64_tr_b16 v[54:55], v10 offset:4608
    s_waitcnt lgkmcnt(6)
    v_mfma_f32_16x16x32_bf16 v[56:59], v[164:167], v[36:39], v[56:59]
    v_mfma_f32_16x16x32_bf16 v[60:63], v[244:247], v[36:39], v[60:63]
    ds_read_b64_tr_b16 v[16:17], v6 offset:12288
    ds_read_b64_tr_b16 v[18:19], v6 offset:13056
    v_mfma_f32_16x16x32_bf16 v[64:67], v[164:167], v[40:43], v[64:67]
    v_mfma_f32_16x16x32_bf16 v[68:71], v[244:247], v[40:43], v[68:71]
    ds_read_b64_tr_b16 v[20:21], v7 offset:12288
    ds_read_b64_tr_b16 v[22:23], v7 offset:13056
    s_waitcnt lgkmcnt(4)
    v_mfma_f32_16x16x32_bf16 v[72:75], v[164:167], v[44:47], v[72:75]
    v_mfma_f32_16x16x32_bf16 v[76:79], v[244:247], v[44:47], v[76:79]
    ds_read_b64_tr_b16 v[24:25], v8 offset:12288
    ds_read_b64_tr_b16 v[26:27], v8 offset:13056
    v_mfma_f32_16x16x32_bf16 v[80:83], v[164:167], v[48:51], v[80:83]
    v_mfma_f32_16x16x32_bf16 v[84:87], v[244:247], v[48:51], v[84:87]
    ds_read_b64_tr_b16 v[28:29], v9 offset:8192
    ds_read_b64_tr_b16 v[30:31], v9 offset:8704
    v_mfma_f32_16x16x32_bf16 v[88:91], v[164:167], v[52:55], v[88:91]
    v_mfma_f32_16x16x32_bf16 v[92:95], v[244:247], v[52:55], v[92:95]
    ds_read_b64_tr_b16 v[32:33], v10 offset:8192
    ds_read_b64_tr_b16 v[34:35], v10 offset:8704
    s_waitcnt lgkmcnt(6)
    v_mfma_f32_16x16x32_bf16 v[56:59], v[168:171], v[16:19], v[56:59]
    v_mfma_f32_16x16x32_bf16 v[60:63], v[248:251], v[16:19], v[60:63]
    ds_read_b64_tr_b16 v[36:37], v6 offset:18432
    ds_read_b64_tr_b16 v[38:39], v6 offset:19200
    v_mfma_f32_16x16x32_bf16 v[64:67], v[168:171], v[20:23], v[64:67]
    v_mfma_f32_16x16x32_bf16 v[68:71], v[248:251], v[20:23], v[68:71]
    ds_read_b64_tr_b16 v[40:41], v7 offset:18432
    ds_read_b64_tr_b16 v[42:43], v7 offset:19200
    s_waitcnt lgkmcnt(4)
    v_mfma_f32_16x16x32_bf16 v[72:75], v[168:171], v[24:27], v[72:75]
    v_mfma_f32_16x16x32_bf16 v[76:79], v[248:251], v[24:27], v[76:79]
    ds_read_b64_tr_b16 v[44:45], v8 offset:18432
    ds_read_b64_tr_b16 v[46:47], v8 offset:19200
    v_mfma_f32_16x16x32_bf16 v[80:83], v[168:171], v[28:31], v[80:83]
    v_mfma_f32_16x16x32_bf16 v[84:87], v[248:251], v[28:31], v[84:87]
    ds_read_b64_tr_b16 v[48:49], v9 offset:12288
    ds_read_b64_tr_b16 v[50:51], v9 offset:12800
    v_mfma_f32_16x16x32_bf16 v[88:91], v[168:171], v[32:35], v[88:91]
    v_mfma_f32_16x16x32_bf16 v[92:95], v[248:251], v[32:35], v[92:95]
    ds_read_b64_tr_b16 v[52:53], v10 offset:12288
    ds_read_b64_tr_b16 v[54:55], v10 offset:12800
    s_waitcnt lgkmcnt(6)
    v_mfma_f32_16x16x32_bf16 v[56:59], v[172:175], v[36:39], v[56:59]
    v_mfma_f32_16x16x32_bf16 v[60:63], v[252:255], v[36:39], v[60:63]
    v_mfma_f32_16x16x32_bf16 v[64:67], v[172:175], v[40:43], v[64:67]
    v_mfma_f32_16x16x32_bf16 v[68:71], v[252:255], v[40:43], v[68:71]
    s_waitcnt lgkmcnt(0)
    v_mfma_f32_16x16x32_bf16 v[72:75], v[172:175], v[44:47], v[72:75]
    v_mfma_f32_16x16x32_bf16 v[76:79], v[252:255], v[44:47], v[76:79]
    v_mfma_f32_16x16x32_bf16 v[80:83], v[172:175], v[48:51], v[80:83]
    v_mfma_f32_16x16x32_bf16 v[84:87], v[252:255], v[48:51], v[84:87]
    v_mfma_f32_16x16x32_bf16 v[88:91], v[172:175], v[52:55], v[88:91]
    v_mfma_f32_16x16x32_bf16 v[92:95], v[252:255], v[52:55], v[92:95]
    s_sub_u32 s52, s35, 4
    s_mul_i32 s52, s52, 320
    s_mul_i32 s53, s39, 40
    s_add_u32 s53, s53, 8388608
    v_lshlrev_b32 v13, 8, v12
    v_lshlrev_b32 v14, 6, v12
    v_add_u32 v14, 1024, v14
    s_cmp_eq_u32 s38, 0
    s_cselect_b32 s54, 10, 11
    s_lshl_b32 s54, s54, 4
    s_add_u32 s54, s54, s52
    v_add_u32 v40, s54, v11
    v_mul_u32_u24 v41, 3277, v40
    v_lshrrev_b32 v41, 16, v41
    v_mul_u32_u24 v42, 20, v41
    v_sub_u32 v42, v40, v42
    v_cmp_le_u32 vcc, 16, v42
    s_nop 1
    v_cndmask_b32 v43, v13, v14, vcc
    v_and_b32 v42, 15, v42
    v_mul_u32_u24 v41, 81920, v41
    v_lshl_add_u32 v41, v42, 4, v41
    v_add_u32 v41, v41, v43
    v_cvt_pk_bf16_f32 v36, v56, v57
    v_cvt_pk_bf16_f32 v37, v58, v59
    v_cvt_pk_bf16_f32 v38, v60, v61
    v_cvt_pk_bf16_f32 v39, v62, v63
    buffer_store_dwordx4 v[36:39], v41, s[28:31], s53 offen
    s_cmp_eq_u32 s38, 0
    s_cselect_b32 s54, 12, 14
    s_lshl_b32 s54, s54, 4
    s_add_u32 s54, s54, s52
    v_add_u32 v48, s54, v11
    v_mul_u32_u24 v49, 3277, v48
    v_lshrrev_b32 v49, 16, v49
    v_mul_u32_u24 v50, 20, v49
    v_sub_u32 v50, v48, v50
    v_cmp_le_u32 vcc, 16, v50
    s_nop 1
    v_cndmask_b32 v51, v13, v14, vcc
    v_and_b32 v50, 15, v50
    v_mul_u32_u24 v49, 81920, v49
    v_lshl_add_u32 v49, v50, 4, v49
    v_add_u32 v49, v49, v51
    v_cvt_pk_bf16_f32 v44, v64, v65
    v_cvt_pk_bf16_f32 v45, v66, v67
    v_cvt_pk_bf16_f32 v46, v68, v69
    v_cvt_pk_bf16_f32 v47, v70, v71
    buffer_store_dwordx4 v[44:47], v49, s[28:31], s53 offen
    s_cmp_eq_u32 s38, 0
    s_cselect_b32 s54, 13, 15
    s_lshl_b32 s54, s54, 4
    s_add_u32 s54, s54, s52
    v_add_u32 v40, s54, v11
    v_mul_u32_u24 v41, 3277, v40
    v_lshrrev_b32 v41, 16, v41
    v_mul_u32_u24 v42, 20, v41
    v_sub_u32 v42, v40, v42
    v_cmp_le_u32 vcc, 16, v42
    s_nop 1
    v_cndmask_b32 v43, v13, v14, vcc
    v_and_b32 v42, 15, v42
    v_mul_u32_u24 v41, 81920, v41
    v_lshl_add_u32 v41, v42, 4, v41
    v_add_u32 v41, v41, v43
    v_cvt_pk_bf16_f32 v36, v72, v73
    v_cvt_pk_bf16_f32 v37, v74, v75
    v_cvt_pk_bf16_f32 v38, v76, v77
    v_cvt_pk_bf16_f32 v39, v78, v79
    buffer_store_dwordx4 v[36:39], v41, s[28:31], s53 offen
    s_cmp_eq_u32 s38, 0
    s_cselect_b32 s54, 16, 18
    s_lshl_b32 s54, s54, 4
    s_add_u32 s54, s54, s52
    v_add_u32 v48, s54, v11
    v_mul_u32_u24 v49, 3277, v48
    v_lshrrev_b32 v49, 16, v49
    v_mul_u32_u24 v50, 20, v49
    v_sub_u32 v50, v48, v50
    v_cmp_le_u32 vcc, 16, v50
    s_nop 1
    v_cndmask_b32 v51, v13, v14, vcc
    v_and_b32 v50, 15, v50
    v_mul_u32_u24 v49, 81920, v49
    v_lshl_add_u32 v49, v50, 4, v49
    v_add_u32 v49, v49, v51
    v_cvt_pk_bf16_f32 v44, v80, v81
    v_cvt_pk_bf16_f32 v45, v82, v83
    v_cvt_pk_bf16_f32 v46, v84, v85
    v_cvt_pk_bf16_f32 v47, v86, v87
    buffer_store_dwordx4 v[44:47], v49, s[28:31], s53 offen
    s_cmp_eq_u32 s38, 0
    s_cselect_b32 s54, 17, 19
    s_lshl_b32 s54, s54, 4
    s_add_u32 s54, s54, s52
    v_add_u32 v40, s54, v11
    v_mul_u32_u24 v41, 3277, v40
    v_lshrrev_b32 v41, 16, v41
    v_mul_u32_u24 v42, 20, v41
    v_sub_u32 v42, v40, v42
    v_cmp_le_u32 vcc, 16, v42
    s_nop 1
    v_cndmask_b32 v43, v13, v14, vcc
    v_and_b32 v42, 15, v42
    v_mul_u32_u24 v41, 81920, v41
    v_lshl_add_u32 v41, v42, 4, v41
    v_add_u32 v41, v41, v43
    v_cvt_pk_bf16_f32 v36, v88, v89
    v_cvt_pk_bf16_f32 v37, v90, v91
    v_cvt_pk_bf16_f32 v38, v92, v93
    v_cvt_pk_bf16_f32 v39, v94, v95
    buffer_store_dwordx4 v[36:39], v41, s[28:31], s53 offen
    s_nop 3
    s_branch .k1_end
.k1g_5:
    v_and_b32 v11, 15, v0
    v_lshrrev_b32 v12, 4, v0
    s_waitcnt lgkmcnt(0)
    s_barrier
    v_bfe_u32 v16, v0, 2, 2
    v_and_b32 v17, 3, v0
    v_lshl_add_u32 v18, v12, 3, v16
    v_and_b32 v19, 1, v12
    v_mul_u32_u24 v21, 192, v18
    v_lshl_add_u32 v21, v17, 3, v21
    s_cmp_eq_u32 s38, 0
    s_cselect_b32 s50, 0, 2
    v_xor_b32 v20, s50, v19
    v_lshl_add_u32 v6, v20, 5, v21
    s_cmp_eq_u32 s38, 0
    s_cselect_b32 s50, 1, 3
    v_xor_b32 v20, s50, v19
    v_lshl_add_u32 v7, v20, 5, v21
    s_cmp_eq_u32 s38, 0
    s_cselect_b32 s50, 4, 5
    v_xor_b32 v20, s50, v19
    v_lshl_add_u32 v8, v20, 5, v21
    v_lshrrev_b32 v20, 1, v16
    v_lshl_or_b32 v19, v19, 1, v20
    v_lshlrev_b32 v21, 7, v18
    v_lshl_add_u32 v21, v17, 3, v21
    v_add_u32 v21, 24576, v21
    s_lshl_b32 s49, s38, 1
    s_add_u32 s50, s49, 0
    v_xor_b32 v20, s50, v19
    v_lshl_add_u32 v9, v20, 5, v21
    s_add_u32 s50, s49, 1
    v_xor_b32 v20, s50, v19
    v_lshl_add_u32 v10, v20, 5, v21
    ds_read_b64_tr_b16 v[16:17], v6 offset:0
    ds_read_b64_tr_b16 v[18:19], v6 offset:768
    ds_read_b64_tr_b16 v[20:21], v7 offset:0
    ds_read_b64_tr_b16 v[22:23], v7 offset:768
    ds_read_b64_tr_b16 v[24:25], v8 offset:0
    ds_read_b64_tr_b16 v[26:27], v8 offset:768
    ds_read_b64_tr_b16 v[28:29], v9 offset:0
    ds_read_b64_tr_b16 v[30:31], v9 offset:512
    ds_read_b64_tr_b16 v[32:33], v10 offset:0
    ds_read_b64_tr_b16 v[34:35], v10 offset:512
    s_waitcnt lgkmcnt(6)
    v_mfma_f32_16x16x32_bf16 v[56:59], v[16:19], v[96:99], 0
    v_mfma_f32_16x16x32_bf16 v[60:63], v[16:19], v[176:179], 0
    ds_read_b64_tr_b16 v[36:37], v6 offset:6144
    ds_read_b64_tr_b16 v[38:39], v6 offset:6912
    v_mfma_f32_16x16x32_bf16 v[64:67], v[20:23], v[96:99], 0
    v_mfma_f32_16x16x32_bf16 v[68:71], v[20:23], v[176:179], 0
    ds_read_b64_tr_b16 v[40:41], v7 offset:6144
    ds_read_b64_tr_b16 v[42:43], v7 offset:6912
    s_mul_i32 s50, s46, 2
    s_mov_b32 s51, s50
    s_add_u32 m0, s47, 81920
    s_nop 0
    buffer_load_dwordx4 v1, s[16:19], s50 offen lds
    s_waitcnt lgkmcnt(4)
    v_mfma_f32_16x16x32_bf16 v[72:75], v[24:27], v[96:99], 0
    v_mfma_f32_16x16x32_bf16 v[76:79], v[24:27], v[176:179], 0
    ds_read_b64_tr_b16 v[44:45], v8 offset:6144
    ds_read_b64_tr_b16 v[46:47], v8 offset:6912
    v_mfma_f32_16x16x32_bf16 v[80:83], v[28:31], v[96:99], 0
    v_mfma_f32_16x16x32_bf16 v[84:87], v[28:31], v[176:179], 0
    ds_read_b64_tr_b16 v[48:49], v9 offset:4096
    ds_read_b64_tr_b16 v[50:51], v9 offset:4608
    s_add_u32 m0, s47, 82944
    s_nop 0
    buffer_load_dwordx4 v2, s[16:19], s50 offen lds
    v_mfma_f32_16x16x32_bf16 v[88:91], v[32:35], v[96:99], 0
    v_mfma_f32_16x16x32_bf16 v[92:95], v[32:35], v[176:179], 0
    ds_read_b64_tr_b16 v[52:53], v10 offset:4096
    ds_read_b64_tr_b16 v[54:55], v10 offset:4608
    s_waitcnt lgkmcnt(6)
    v_mfma_f32_16x16x32_bf16 v[56:59], v[36:39], v[100:103], v[56:59]
    v_mfma_f32_16x16x32_bf16 v[60:63], v[36:39], v[180:183], v[60:63]
    ds_read_b64_tr_b16 v[16:17], v6 offset:12288
    ds_read_b64_tr_b16 v[18:19], v6 offset:13056
    v_mfma_f32_16x16x32_bf16 v[64:67], v[40:43], v[100:103], v[64:67]
    v_mfma_f32_16x16x32_bf16 v[68:71], v[40:43], v[180:183], v[68:71]
    ds_read_b64_tr_b16 v[20:21], v7 offset:12288
    ds_read_b64_tr_b16 v[22:23], v7 offset:13056
    s_add_u32 m0, s47, 83968
    s_nop 0
    buffer_load_dwordx4 v3, s[16:19], s50 offen lds
    s_waitcnt lgkmcnt(4)
    v_mfma_f32_16x16x32_bf16 v[72:75], v[44:47], v[100:103], v[72:75]
    v_mfma_f32_16x16x32_bf16 v[76:79], v[44:47], v[180:183], v[76:79]
    ds_read_b64_tr_b16 v[24:25], v8 offset:12288
    ds_read_b64_tr_b16 v[26:27], v8 offset:13056
    v_mfma_f32_16x16x32_bf16 v[80:83], v[48:51], v[100:103], v[80:83]
    v_mfma_f32_16x16x32_bf16 v[84:87], v[48:51], v[180:183], v[84:87]
    ds_read_b64_tr_b16 v[28:29], v9 offset:8192
    ds_read_b64_tr_b16 v[30:31], v9 offset:8704
    s_add_u32 m0, s48, 81920
    s_nop 0
    buffer_load_dwordx4 v4, s[20:23], s51 offen lds
    v_mfma_f32_16x16x32_bf16 v[88:91], v[52:55], v[100:103], v[88:91]
    v_mfma_f32_16x16x32_bf16 v[92:95], v[52:55], v[180:183], v[92:95]
    ds_read_b64_tr_b16 v[32:33], v10 offset:8192
    ds_read_b64_tr_b16 v[34:35], v10 offset:8704
    s_waitcnt lgkmcnt(6)
    v_mfma_f32_16x16x32_bf16 v[56:59], v[16:19], v[104:107], v[56:59]
    v_mfma_f32_16x16x32_bf16 v[60:63], v[16:19], v[184:187], v[60:63]
    ds_read_b64_tr_b16 v[36:37], v6 offset:18432
    ds_read_b64_tr_b16 v[38:39], v6 offset:19200
    v_mfma_f32_16x16x32_bf16 v[64:67], v[20:23], v[104:107], v[64:67]
    v_mfma_f32_16x16x32_bf16 v[68:71], v[20:23], v[184:187], v[68:71]
    ds_read_b64_tr_b16 v[40:41], v7 offset:18432
    ds_read_b64_tr_b16 v[42:43], v7 offset:19200
    s_add_u32 m0, s48, 82944
    s_nop 0
    buffer_load_dwordx4 v5, s[20:23], s51 offen lds
    s_waitcnt lgkmcnt(4)
    v_mfma_f32_16x16x32_bf16 v[72:75], v[24:27], v[104:107], v[72:75]
    v_mfma_f32_16x16x32_bf16 v[76:79], v[24:27], v[184:187], v[76:79]
    ds_read_b64_tr_b16 v[44:45], v8 offset:18432
    ds_read_b64_tr_b16 v[46:47], v8 offset:19200
    v_mfma_f32_16x16x32_bf16 v[80:83], v[28:31], v[104:107], v[80:83]
    v_mfma_f32_16x16x32_bf16 v[84:87], v[28:31], v[184:187], v[84:87]
    ds_read_b64_tr_b16 v[48:49], v9 offset:12288
    ds_read_b64_tr_b16 v[50:51], v9 offset:12800
    v_mfma_f32_16x16x32_bf16 v[88:91], v[32:35], v[104:107], v[88:91]
    v_mfma_f32_16x16x32_bf16 v[92:95], v[32:35], v[184:187], v[92:95]
    ds_read_b64_tr_b16 v[52:53], v10 offset:12288
    ds_read_b64_tr_b16 v[54:55], v10 offset:12800
    s_waitcnt lgkmcnt(0)
    s_barrier
    v_add_u32 v6, 40960, v6
    v_add_u32 v7, 40960, v7
    v_add_u32 v8, 40960, v8
    v_add_u32 v9, 40960, v9
    v_add_u32 v10, 40960, v10
    v_mfma_f32_16x16x32_bf16 v[56:59], v[36:39], v[108:111], v[56:59]
    v_mfma_f32_16x16x32_bf16 v[60:63], v[36:39], v[188:191], v[60:63]
    ds_read_b64_tr_b16 v[16:17], v6 offset:0
    ds_read_b64_tr_b16 v[18:19], v6 offset:768
    v_mfma_f32_16x16x32_bf16 v[64:67], v[40:43], v[108:111], v[64:67]
    v_mfma_f32_16x16x32_bf16 v[68:71], v[40:43], v[188:191], v[68:71]
    ds_read_b64_tr_b16 v[20:21], v7 offset:0
    ds_read_b64_tr_b16 v[22:23], v7 offset:768
    s_mul_i32 s50, s46, 3
    s_mov_b32 s51, s50
    s_add_u32 m0, s47, 0
    s_nop 0
    buffer_load_dwordx4 v1, s[16:19], s50 offen lds
    v_mfma_f32_16x16x32_bf16 v[72:75], v[44:47], v[108:111], v[72:75]
    v_mfma_f32_16x16x32_bf16 v[76:79], v[44:47], v[188:191], v[76:79]
    ds_read_b64_tr_b16 v[24:25], v8 offset:0
    ds_read_b64_tr_b16 v[26:27], v8 offset:768
    v_mfma_f32_16x16x32_bf16 v[80:83], v[48:51], v[108:111], v[80:83]
    v_mfma_f32_16x16x32_bf16 v[84:87], v[48:51], v[188:191], v[84:87]
    ds_read_b64_tr_b16 v[28:29], v9 offset:0
    ds_read_b64_tr_b16 v[30:31], v9 offset:512
    s_add_u32 m0, s47, 1024
    s_nop 0
    buffer_load_dwordx4 v2, s[16:19], s50 offen lds
    v_mfma_f32_16x16x32_bf16 v[88:91], v[52:55], v[108:111], v[88:91]
    v_mfma_f32_16x16x32_bf16 v[92:95], v[52:55], v[188:191], v[92:95]
    ds_read_b64_tr_b16 v[32:33], v10 offset:0
    ds_read_b64_tr_b16 v[34:35], v10 offset:512
    s_waitcnt lgkmcnt(6)
    v_mfma_f32_16x16x32_bf16 v[56:59], v[16:19], v[112:115], v[56:59]
    v_mfma_f32_16x16x32_bf16 v[60:63], v[16:19], v[192:195], v[60:63]
    ds_read_b64_tr_b16 v[36:37], v6 offset:6144
    ds_read_b64_tr_b16 v[38:39], v6 offset:6912
    v_mfma_f32_16x16x32_bf16 v[64:67], v[20:23], v[112:115], v[64:67]
    v_mfma_f32_16x16x32_bf16 v[68:71], v[20:23], v[192:195], v[68:71]
    ds_read_b64_tr_b16 v[40:41], v7 offset:6144
    ds_read_b64_tr_b16 v[42:43], v7 offset:6912
    s_add_u32 m0, s47, 2048
    s_nop 0
    buffer_load_dwordx4 v3, s[16:19], s50 offen lds
    s_waitcnt lgkmcnt(4)
    v_mfma_f32_16x16x32_bf16 v[72:75], v[24:27], v[112:115], v[72:75]
    v_mfma_f32_16x16x32_bf16 v[76:79], v[24:27], v[192:195], v[76:79]
    ds_read_b64_tr_b16 v[44:45], v8 offset:6144
    ds_read_b64_tr_b16 v[46:47], v8 offset:6912
    v_mfma_f32_16x16x32_bf16 v[80:83], v[28:31], v[112:115], v[80:83]
    v_mfma_f32_16x16x32_bf16 v[84:87], v[28:31], v[192:195], v[84:87]
    ds_read_b64_tr_b16 v[48:49], v9 offset:4096
    ds_read_b64_tr_b16 v[50:51], v9 offset:4608
    s_add_u32 m0, s48, 0
    s_nop 0
    buffer_load_dwordx4 v4, s[20:23], s51 offen lds
    v_mfma_f32_16x16x32_bf16 v[88:91], v[32:35], v[112:115], v[88:91]
    v_mfma_f32_16x16x32_bf16 v[92:95], v[32:35], v[192:195], v[92:95]
    ds_read_b64_tr_b16 v[52:53], v10 offset:4096
    ds_read_b64_tr_b16 v[54:55], v10 offset:4608
    s_waitcnt lgkmcnt(6)
    v_mfma_f32_16x16x32_bf16 v[56:59], v[36:39], v[116:119], v[56:59]
    v_mfma_f32_16x16x32_bf16 v[60:63], v[36:39], v[196:199], v[60:63]
    ds_read_b64_tr_b16 v[16:17], v6 offset:12288
    ds_read_b64_tr_b16 v[18:19], v6 offset:13056
    v_mfma_f32_16x16x32_bf16 v[64:67], v[40:43], v[116:119], v[64:67]
    v_mfma_f32_16x16x32_bf16 v[68:71], v[40:43], v[196:199], v[68:71]
    ds_read_b64_tr_b16 v[20:21], v7 offset:12288
    ds_read_b64_tr_b16 v[22:23], v7 offset:13056
    s_add_u32 m0, s48, 1024
    s_nop 0
    buffer_load_dwordx4 v5, s[20:23], s51 offen lds
    s_waitcnt lgkmcnt(4)
    v_mfma_f32_16x16x32_bf16 v[72:75], v[44:47], v[116:119], v[72:75]
    v_mfma_f32_16x16x32_bf16 v[76:79], v[44:47], v[196:199], v[76:79]
    ds_read_b64_tr_b16 v[24:25], v8 offset:12288
    ds_read_b64_tr_b16 v[26:27], v8 offset:13056
    v_mfma_f32_16x16x32_bf16 v[80:83], v[48:51], v[116:119], v[80:83]
    v_mfma_f32_16x16x32_bf16 v[84:87], v[48:51], v[196:199], v[84:87]
    ds_read_b64_tr_b16 v[28:29], v9 offset:8192
    ds_read_b64_tr_b16 v[30:31], v9 offset:8704
    v_mfma_f32_16x16x32_bf16 v[88:91], v[52:55], v[116:119], v[88:91]
    v_mfma_f32_16x16x32_bf16 v[92:95], v[52:55], v[196:199], v[92:95]
    ds_read_b64_tr_b16 v[32:33], v10 offset:8192
    ds_read_b64_tr_b16 v[34:35], v10 offset:8704
    s_waitcnt lgkmcnt(6)
    v_mfma_f32_16x16x32_bf16 v[56:59], v[16:19], v[120:123], v[56:59]
    v_mfma_f32_16x16x32_bf16 v[60:63], v[16:19], v[200:203], v[60:63]
    ds_read_b64_tr_b16 v[36:37], v6 offset:18432
    ds_read_b64_tr_b16 v[38:39], v6 offset:19200
    v_mfma_f32_16x16x32_bf16 v[64:67], v[20:23], v[120:123], v[64:67]
    v_mfma_f32_16x16x32_bf16 v[68:71], v[20:23], v[200:203], v[68:71]
    ds_read_b64_tr_b16 v[40:41], v7 offset:18432
    ds_read_b64_tr_b16 v[42:43], v7 offset:19200
    s_waitcnt lgkmcnt(4)
    v_mfma_f32_16x16x32_bf16 v[72:75], v[24:27], v[120:123], v[72:75]
    v_mfma_f32_16x16x32_bf16 v[76:79], v[24:27], v[200:203], v[76:79]
    ds_read_b64_tr_b16 v[44:45], v8 offset:18432
    ds_read_b64_tr_b16 v[46:47], v8 offset:19200
    v_mfma_f32_16x16x32_bf16 v[80:83], v[28:31], v[120:123], v[80:83]
    v_mfma_f32_16x16x32_bf16 v[84:87], v[28:31], v[200:203], v[84:87]
    ds_read_b64_tr_b16 v[48:49], v9 offset:12288
    ds_read_b64_tr_b16 v[50:51], v9 offset:12800
    v_mfma_f32_16x16x32_bf16 v[88:91], v[32:35], v[120:123], v[88:91]
    v_mfma_f32_16x16x32_bf16 v[92:95], v[32:35], v[200:203], v[92:95]
    ds_read_b64_tr_b16 v[52:53], v10 offset:12288
    ds_read_b64_tr_b16 v[54:55], v10 offset:12800
    s_waitcnt lgkmcnt(0)
    s_waitcnt vmcnt(5)
    s_barrier
    v_add_u32 v6, 40960, v6
    v_add_u32 v7, 40960, v7
    v_add_u32 v8, 40960, v8
    v_add_u32 v9, 40960, v9
    v_add_u32 v10, 40960, v10
    v_mfma_f32_16x16x32_bf16 v[56:59], v[36:39], v[124:127], v[56:59]
    v_mfma_f32_16x16x32_bf16 v[60:63], v[36:39], v[204:207], v[60:63]
    ds_read_b64_tr_b16 v[16:17], v6 offset:0
    ds_read_b64_tr_b16 v[18:19], v6 offset:768
    v_mfma_f32_16x16x32_bf16 v[64:67], v[40:43], v[124:127], v[64:67]
    v_mfma_f32_16x16x32_bf16 v[68:71], v[40:43], v[204:207], v[68:71]
    ds_read_b64_tr_b16 v[20:21], v7 offset:0
    ds_read_b64_tr_b16 v[22:23], v7 offset:768
    s_mul_i32 s50, s46, 4
    s_mov_b32 s51, s50
    s_add_u32 m0, s47, 40960
    s_nop 0
    buffer_load_dwordx4 v1, s[16:19], s50 offen lds
    v_mfma_f32_16x16x32_bf16 v[72:75], v[44:47], v[124:127], v[72:75]
    v_mfma_f32_16x16x32_bf16 v[76:79], v[44:47], v[204:207], v[76:79]
    ds_read_b64_tr_b16 v[24:25], v8 offset:0
    ds_read_b64_tr_b16 v[26:27], v8 offset:768
    v_mfma_f32_16x16x32_bf16 v[80:83], v[48:51], v[124:127], v[80:83]
    v_mfma_f32_16x16x32_bf16 v[84:87], v[48:51], v[204:207], v[84:87]
    ds_read_b64_tr_b16 v[28:29], v9 offset:0
    ds_read_b64_tr_b16 v[30:31], v9 offset:512
    s_add_u32 m0, s47, 41984
    s_nop 0
    buffer_load_dwordx4 v2, s[16:19], s50 offen lds
    v_mfma_f32_16x16x32_bf16 v[88:91], v[52:55], v[124:127], v[88:91]
    v_mfma_f32_16x16x32_bf16 v[92:95], v[52:55], v[204:207], v[92:95]
    ds_read_b64_tr_b16 v[32:33], v10 offset:0
    ds_read_b64_tr_b16 v[34:35], v10 offset:512
    s_waitcnt lgkmcnt(6)
    v_mfma_f32_16x16x32_bf16 v[56:59], v[16:19], v[128:131], v[56:59]
    v_mfma_f32_16x16x32_bf16 v[60:63], v[16:19], v[208:211], v[60:63]
    ds_read_b64_tr_b16 v[36:37], v6 offset:6144
    ds_read_b64_tr_b16 v[38:39], v6 offset:6912
    v_mfma_f32_16x16x32_bf16 v[64:67], v[20:23], v[128:131], v[64:67]
    v_mfma_f32_16x16x32_bf16 v[68:71], v[20:23], v[208:211], v[68:71]
    ds_read_b64_tr_b16 v[40:41], v7 offset:6144
    ds_read_b64_tr_b16 v[42:43], v7 offset:6912
    s_add_u32 m0, s47, 43008
    s_nop 0
    buffer_load_dwordx4 v3, s[16:19], s50 offen lds
    s_waitcnt lgkmcnt(4)
    v_mfma_f32_16x16x32_bf16 v[72:75], v[24:27], v[128:131], v[72:75]
    v_mfma_f32_16x16x32_bf16 v[76:79], v[24:27], v[208:211], v[76:79]
    ds_read_b64_tr_b16 v[44:45], v8 offset:6144
    ds_read_b64_tr_b16 v[46:47], v8 offset:6912
    v_mfma_f32_16x16x32_bf16 v[80:83], v[28:31], v[128:131], v[80:83]
    v_mfma_f32_16x16x32_bf16 v[84:87], v[28:31], v[208:211], v[84:87]
    ds_read_b64_tr_b16 v[48:49], v9 offset:4096
    ds_read_b64_tr_b16 v[50:51], v9 offset:4608
    s_add_u32 m0, s48, 40960
    s_nop 0
    buffer_load_dwordx4 v4, s[20:23], s51 offen lds
    v_mfma_f32_16x16x32_bf16 v[88:91], v[32:35], v[128:131], v[88:91]
    v_mfma_f32_16x16x32_bf16 v[92:95], v[32:35], v[208:211], v[92:95]
    ds_read_b64_tr_b16 v[52:53], v10 offset:4096
    ds_read_b64_tr_b16 v[54:55], v10 offset:4608
    s_waitcnt lgkmcnt(6)
    v_mfma_f32_16x16x32_bf16 v[56:59], v[36:39], v[132:135], v[56:59]
    v_mfma_f32_16x16x32_bf16 v[60:63], v[36:39], v[212:215], v[60:63]
    ds_read_b64_tr_b16 v[16:17], v6 offset:12288
    ds_read_b64_tr_b16 v[18:19], v6 offset:13056
    v_mfma_f32_16x16x32_bf16 v[64:67], v[40:43], v[132:135], v[64:67]
    v_mfma_f32_16x16x32_bf16 v[68:71], v[40:43], v[212:215], v[68:71]
    ds_read_b64_tr_b16 v[20:21], v7 offset:12288
    ds_read_b64_tr_b16 v[22:23], v7 offset:13056
    s_add_u32 m0, s48, 41984
    s_nop 0
    buffer_load_dwordx4 v5, s[20:23], s51 offen lds
    s_waitcnt lgkmcnt(4)
    v_mfma_f32_16x16x32_bf16 v[72:75], v[44:47], v[132:135], v[72:75]
    v_mfma_f32_16x16x32_bf16 v[76:79], v[44:47], v[212:215], v[76:79]
    ds_read_b64_tr_b16 v[24:25], v8 offset:12288
    ds_read_b64_tr_b16 v[26:27], v8 offset:13056
    v_mfma_f32_16x16x32_bf16 v[80:83], v[48:51], v[132:135], v[80:83]
    v_mfma_f32_16x16x32_bf16 v[84:87], v[48:51], v[212:215], v[84:87]
    ds_read_b64_tr_b16 v[28:29], v9 offset:8192
    ds_read_b64_tr_b16 v[30:31], v9 offset:8704
    v_mfma_f32_16x16x32_bf16 v[88:91], v[52:55], v[132:135], v[88:91]
    v_mfma_f32_16x16x32_bf16 v[92:95], v[52:55], v[212:215], v[92:95]
    ds_read_b64_tr_b16 v[32:33], v10 offset:8192
    ds_read_b64_tr_b16 v[34:35], v10 offset:8704
    s_waitcnt lgkmcnt(6)
    v_mfma_f32_16x16x32_bf16 v[56:59], v[16:19], v[136:139], v[56:59]
    v_mfma_f32_16x16x32_bf16 v[60:63], v[16:19], v[216:219], v[60:63]
    ds_read_b64_tr_b16 v[36:37], v6 offset:18432
    ds_read_b64_tr_b16 v[38:39], v6 offset:19200
    v_mfma_f32_16x16x32_bf16 v[64:67], v[20:23], v[136:139], v[64:67]
    v_mfma_f32_16x16x32_bf16 v[68:71], v[20:23], v[216:219], v[68:71]
    ds_read_b64_tr_b16 v[40:41], v7 offset:18432
    ds_read_b64_tr_b16 v[42:43], v7 offset:19200
    s_waitcnt lgkmcnt(4)
    v_mfma_f32_16x16x32_bf16 v[72:75], v[24:27], v[136:139], v[72:75]
    v_mfma_f32_16x16x32_bf16 v[76:79], v[24:27], v[216:219], v[76:79]
    ds_read_b64_tr_b16 v[44:45], v8 offset:18432
    ds_read_b64_tr_b16 v[46:47], v8 offset:19200
    v_mfma_f32_16x16x32_bf16 v[80:83], v[28:31], v[136:139], v[80:83]
    v_mfma_f32_16x16x32_bf16 v[84:87], v[28:31], v[216:219], v[84:87]
    ds_read_b64_tr_b16 v[48:49], v9 offset:12288
    ds_read_b64_tr_b16 v[50:51], v9 offset:12800
    v_mfma_f32_16x16x32_bf16 v[88:91], v[32:35], v[136:139], v[88:91]
    v_mfma_f32_16x16x32_bf16 v[92:95], v[32:35], v[216:219], v[92:95]
    ds_read_b64_tr_b16 v[52:53], v10 offset:12288
    ds_read_b64_tr_b16 v[54:55], v10 offset:12800
    s_waitcnt lgkmcnt(0)
    s_waitcnt vmcnt(5)
    s_barrier
    v_subrev_u32 v6, 81920, v6
    v_subrev_u32 v7, 81920, v7
    v_subrev_u32 v8, 81920, v8
    v_subrev_u32 v9, 81920, v9
    v_subrev_u32 v10, 81920, v10
    v_mfma_f32_16x16x32_bf16 v[56:59], v[36:39], v[140:143], v[56:59]
    v_mfma_f32_16x16x32_bf16 v[60:63], v[36:39], v[220:223], v[60:63]
    ds_read_b64_tr_b16 v[16:17], v6 offset:0
    ds_read_b64_tr_b16 v[18:19], v6 offset:768
    v_mfma_f32_16x16x32_bf16 v[64:67], v[40:43], v[140:143], v[64:67]
    v_mfma_f32_16x16x32_bf16 v[68:71], v[40:43], v[220:223], v[68:71]
    ds_read_b64_tr_b16 v[20:21], v7 offset:0
    ds_read_b64_tr_b16 v[22:23], v7 offset:768
    s_mul_i32 s50, s46, 0
    s_add_u32 s51, s50, s56
    s_add_u32 s50, s50, 128
    s_add_u32 m0, s47, 81920
    s_nop 0
    buffer_load_dwordx4 v1, s[20:23], s50 offen lds
    v_mfma_f32_16x16x32_bf16 v[72:75], v[44:47], v[140:143], v[72:75]
    v_mfma_f32_16x16x32_bf16 v[76:79], v[44:47], v[220:223], v[76:79]
    ds_read_b64_tr_b16 v[24:25], v8 offset:0
    ds_read_b64_tr_b16 v[26:27], v8 offset:768
    v_mfma_f32_16x16x32_bf16 v[80:83], v[48:51], v[140:143], v[80:83]
    v_mfma_f32_16x16x32_bf16 v[84:87], v[48:51], v[220:223], v[84:87]
    ds_read_b64_tr_b16 v[28:29], v9 offset:0
    ds_read_b64_tr_b16 v[30:31], v9 offset:512
    s_add_u32 m0, s47, 82944
    s_nop 0
    buffer_load_dwordx4 v2, s[20:23], s50 offen lds
    v_mfma_f32_16x16x32_bf16 v[88:91], v[52:55], v[140:143], v[88:91]
    v_mfma_f32_16x16x32_bf16 v[92:95], v[52:55], v[220:223], v[92:95]
    ds_read_b64_tr_b16 v[32:33], v10 offset:0
    ds_read_b64_tr_b16 v[34:35], v10 offset:512
    s_waitcnt lgkmcnt(6)
    v_mfma_f32_16x16x32_bf16 v[56:59], v[16:19], v[144:147], v[56:59]
    v_mfma_f32_16x16x32_bf16 v[60:63], v[16:19], v[224:227], v[60:63]
    ds_read_b64_tr_b16 v[36:37], v6 offset:6144
    ds_read_b64_tr_b16 v[38:39], v6 offset:6912
    v_mfma_f32_16x16x32_bf16 v[64:67], v[20:23], v[144:147], v[64:67]
    v_mfma_f32_16x16x32_bf16 v[68:71], v[20:23], v[224:227], v[68:71]
    ds_read_b64_tr_b16 v[40:41], v7 offset:6144
    ds_read_b64_tr_b16 v[42:43], v7 offset:6912
    s_add_u32 m0, s47, 83968
    s_nop 0
    buffer_load_dwordx4 v3, s[20:23], s50 offen lds
    s_waitcnt lgkmcnt(4)
    v_mfma_f32_16x16x32_bf16 v[72:75], v[24:27], v[144:147], v[72:75]
    v_mfma_f32_16x16x32_bf16 v[76:79], v[24:27], v[224:227], v[76:79]
    ds_read_b64_tr_b16 v[44:45], v8 offset:6144
    ds_read_b64_tr_b16 v[46:47], v8 offset:6912
    v_mfma_f32_16x16x32_bf16 v[80:83], v[28:31], v[144:147], v[80:83]
    v_mfma_f32_16x16x32_bf16 v[84:87], v[28:31], v[224:227], v[84:87]
    ds_read_b64_tr_b16 v[48:49], v9 offset:4096
    ds_read_b64_tr_b16 v[50:51], v9 offset:4608
    s_add_u32 m0, s48, 81920
    s_nop 0
    buffer_load_dwordx4 v4, s[16:19], s51 offen lds
    v_mfma_f32_16x16x32_bf16 v[88:91], v[32:35], v[144:147], v[88:91]
    v_mfma_f32_16x16x32_bf16 v[92:95], v[32:35], v[224:227], v[92:95]
    ds_read_b64_tr_b16 v[52:53], v10 offset:4096
    ds_read_b64_tr_b16 v[54:55], v10 offset:4608
    s_waitcnt lgkmcnt(6)
    v_mfma_f32_16x16x32_bf16 v[56:59], v[36:39], v[148:151], v[56:59]
    v_mfma_f32_16x16x32_bf16 v[60:63], v[36:39], v[228:231], v[60:63]
    ds_read_b64_tr_b16 v[16:17], v6 offset:12288
    ds_read_b64_tr_b16 v[18:19], v6 offset:13056
    v_mfma_f32_16x16x32_bf16 v[64:67], v[40:43], v[148:151], v[64:67]
    v_mfma_f32_16x16x32_bf16 v[68:71], v[40:43], v[228:231], v[68:71]
    ds_read_b64_tr_b16 v[20:21], v7 offset:12288
    ds_read_b64_tr_b16 v[22:23], v7 offset:13056
    s_add_u32 m0, s48, 82944
    s_nop 0
    buffer_load_dwordx4 v5, s[16:19], s51 offen lds
    s_waitcnt lgkmcnt(4)
    v_mfma_f32_16x16x32_bf16 v[72:75], v[44:47], v[148:151], v[72:75]
    v_mfma_f32_16x16x32_bf16 v[76:79], v[44:47], v[228:231], v[76:79]
    ds_read_b64_tr_b16 v[24:25], v8 offset:12288
    ds_read_b64_tr_b16 v[26:27], v8 offset:13056
    v_mfma_f32_16x16x32_bf16 v[80:83], v[48:51], v[148:151], v[80:83]
    v_mfma_f32_16x16x32_bf16 v[84:87], v[48:51], v[228:231], v[84:87]
    ds_read_b64_tr_b16 v[28:29], v9 offset:8192
    ds_read_b64_tr_b16 v[30:31], v9 offset:8704
    v_mfma_f32_16x16x32_bf16 v[88:91], v[52:55], v[148:151], v[88:91]
    v_mfma_f32_16x16x32_bf16 v[92:95], v[52:55], v[228:231], v[92:95]
    ds_read_b64_tr_b16 v[32:33], v10 offset:8192
    ds_read_b64_tr_b16 v[34:35], v10 offset:8704
    s_waitcnt lgkmcnt(6)
    v_mfma_f32_16x16x32_bf16 v[56:59], v[16:19], v[152:155], v[56:59]
    v_mfma_f32_16x16x32_bf16 v[60:63], v[16:19], v[232:235], v[60:63]
    ds_read_b64_tr_b16 v[36:37], v6 offset:18432
    ds_read_b64_tr_b16 v[38:39], v6 offset:19200
    v_mfma_f32_16x16x32_bf16 v[64:67], v[20:23], v[152:155], v[64:67]
    v_mfma_f32_16x16x32_bf16 v[68:71], v[20:23], v[232:235], v[68:71]
    ds_read_b64_tr_b16 v[40:41], v7 offset:18432
    ds_read_b64_tr_b16 v[42:43], v7 offset:19200
    s_waitcnt lgkmcnt(4)
    v_mfma_f32_16x16x32_bf16 v[72:75], v[24:27], v[152:155], v[72:75]
    v_mfma_f32_16x16x32_bf16 v[76:79], v[24:27], v[232:235], v[76:79]
    ds_read_b64_tr_b16 v[44:45], v8 offset:18432
    ds_read_b64_tr_b16 v[46:47], v8 offset:19200
    v_mfma_f32_16x16x32_bf16 v[80:83], v[28:31], v[152:155], v[80:83]
    v_mfma_f32_16x16x32_bf16 v[84:87], v[28:31], v[232:235], v[84:87]
    ds_read_b64_tr_b16 v[48:49], v9 offset:12288
    ds_read_b64_tr_b16 v[50:51], v9 offset:12800
    v_mfma_f32_16x16x32_bf16 v[88:91], v[32:35], v[152:155], v[88:91]
    v_mfma_f32_16x16x32_bf16 v[92:95], v[32:35], v[232:235], v[92:95]
    ds_read_b64_tr_b16 v[52:53], v10 offset:12288
    ds_read_b64_tr_b16 v[54:55], v10 offset:12800
    s_waitcnt lgkmcnt(0)
    s_waitcnt vmcnt(5)
    s_barrier
    v_add_u32 v6, 40960, v6
    v_add_u32 v7, 40960, v7
    v_add_u32 v8, 40960, v8
    v_add_u32 v9, 40960, v9
    v_add_u32 v10, 40960, v10
    v_mfma_f32_16x16x32_bf16 v[56:59], v[36:39], v[156:159], v[56:59]
    v_mfma_f32_16x16x32_bf16 v[60:63], v[36:39], v[236:239], v[60:63]
    ds_read_b64_tr_b16 v[16:17], v6 offset:0
    ds_read_b64_tr_b16 v[18:19], v6 offset:768
    v_mfma_f32_16x16x32_bf16 v[64:67], v[40:43], v[156:159], v[64:67]
    v_mfma_f32_16x16x32_bf16 v[68:71], v[40:43], v[236:239], v[68:71]
    ds_read_b64_tr_b16 v[20:21], v7 offset:0
    ds_read_b64_tr_b16 v[22:23], v7 offset:768
    s_mul_i32 s50, s46, 1
    s_add_u32 s51, s50, s56
    s_add_u32 s50, s50, 128
    s_add_u32 m0, s47, 0
    s_nop 0
    buffer_load_dwordx4 v1, s[20:23], s50 offen lds
    v_mfma_f32_16x16x32_bf16 v[72:75], v[44:47], v[156:159], v[72:75]
    v_mfma_f32_16x16x32_bf16 v[76:79], v[44:47], v[236:239], v[76:79]
    ds_read_b64_tr_b16 v[24:25], v8 offset:0
    ds_read_b64_tr_b16 v[26:27], v8 offset:768
    v_mfma_f32_16x16x32_bf16 v[80:83], v[48:51], v[156:159], v[80:83]
    v_mfma_f32_16x16x32_bf16 v[84:87], v[48:51], v[236:239], v[84:87]
    ds_read_b64_tr_b16 v[28:29], v9 offset:0
    ds_read_b64_tr_b16 v[30:31], v9 offset:512
    s_add_u32 m0, s47, 1024
    s_nop 0
    buffer_load_dwordx4 v2, s[20:23], s50 offen lds
    v_mfma_f32_16x16x32_bf16 v[88:91], v[52:55], v[156:159], v[88:91]
    v_mfma_f32_16x16x32_bf16 v[92:95], v[52:55], v[236:239], v[92:95]
    ds_read_b64_tr_b16 v[32:33], v10 offset:0
    ds_read_b64_tr_b16 v[34:35], v10 offset:512
    s_waitcnt lgkmcnt(6)
    v_mfma_f32_16x16x32_bf16 v[56:59], v[16:19], v[160:163], v[56:59]
    v_mfma_f32_16x16x32_bf16 v[60:63], v[16:19], v[240:243], v[60:63]
    ds_read_b64_tr_b16 v[36:37], v6 offset:6144
    ds_read_b64_tr_b16 v[38:39], v6 offset:6912
    v_mfma_f32_16x16x32_bf16 v[64:67], v[20:23], v[160:163], v[64:67]
    v_mfma_f32_16x16x32_bf16 v[68:71], v[20:23], v[240:243], v[68:71]
    ds_read_b64_tr_b16 v[40:41], v7 offset:6144
    ds_read_b64_tr_b16 v[42:43], v7 offset:6912
    s_add_u32 m0, s47, 2048
    s_nop 0
    buffer_load_dwordx4 v3, s[20:23], s50 offen lds
    s_waitcnt lgkmcnt(4)
    v_mfma_f32_16x16x32_bf16 v[72:75], v[24:27], v[160:163], v[72:75]
    v_mfma_f32_16x16x32_bf16 v[76:79], v[24:27], v[240:243], v[76:79]
    ds_read_b64_tr_b16 v[44:45], v8 offset:6144
    ds_read_b64_tr_b16 v[46:47], v8 offset:6912
    v_mfma_f32_16x16x32_bf16 v[80:83], v[28:31], v[160:163], v[80:83]
    v_mfma_f32_16x16x32_bf16 v[84:87], v[28:31], v[240:243], v[84:87]
    ds_read_b64_tr_b16 v[48:49], v9 offset:4096
    ds_read_b64_tr_b16 v[50:51], v9 offset:4608
    s_add_u32 m0, s48, 0
    s_nop 0
    buffer_load_dwordx4 v4, s[16:19], s51 offen lds
    v_mfma_f32_16x16x32_bf16 v[88:91], v[32:35], v[160:163], v[88:91]
    v_mfma_f32_16x16x32_bf16 v[92:95], v[32:35], v[240:243], v[92:95]
    ds_read_b64_tr_b16 v[52:53], v10 offset:4096
    ds_read_b64_tr_b16 v[54:55], v10 offset:4608
    s_waitcnt lgkmcnt(6)
    v_mfma_f32_16x16x32_bf16 v[56:59], v[36:39], v[164:167], v[56:59]
    v_mfma_f32_16x16x32_bf16 v[60:63], v[36:39], v[244:247], v[60:63]
    ds_read_b64_tr_b16 v[16:17], v6 offset:12288
    ds_read_b64_tr_b16 v[18:19], v6 offset:13056
    v_mfma_f32_16x16x32_bf16 v[64:67], v[40:43], v[164:167], v[64:67]
    v_mfma_f32_16x16x32_bf16 v[68:71], v[40:43], v[244:247], v[68:71]
    ds_read_b64_tr_b16 v[20:21], v7 offset:12288
    ds_read_b64_tr_b16 v[22:23], v7 offset:13056
    s_add_u32 m0, s48, 1024
    s_nop 0
    buffer_load_dwordx4 v5, s[16:19], s51 offen lds
    s_waitcnt lgkmcnt(4)
    v_mfma_f32_16x16x32_bf16 v[72:75], v[44:47], v[164:167], v[72:75]
    v_mfma_f32_16x16x32_bf16 v[76:79], v[44:47], v[244:247], v[76:79]
    ds_read_b64_tr_b16 v[24:25], v8 offset:12288
    ds_read_b64_tr_b16 v[26:27], v8 offset:13056
    v_mfma_f32_16x16x32_bf16 v[80:83], v[48:51], v[164:167], v[80:83]
    v_mfma_f32_16x16x32_bf16 v[84:87], v[48:51], v[244:247], v[84:87]
    ds_read_b64_tr_b16 v[28:29], v9 offset:8192
    ds_read_b64_tr_b16 v[30:31], v9 offset:8704
    v_mfma_f32_16x16x32_bf16 v[88:91], v[52:55], v[164:167], v[88:91]
    v_mfma_f32_16x16x32_bf16 v[92:95], v[52:55], v[244:247], v[92:95]
    ds_read_b64_tr_b16 v[32:33], v10 offset:8192
    ds_read_b64_tr_b16 v[34:35], v10 offset:8704
    s_waitcnt lgkmcnt(6)
    v_mfma_f32_16x16x32_bf16 v[56:59], v[16:19], v[168:171], v[56:59]
    v_mfma_f32_16x16x32_bf16 v[60:63], v[16:19], v[248:251], v[60:63]
    ds_read_b64_tr_b16 v[36:37], v6 offset:18432
    ds_read_b64_tr_b16 v[38:39], v6 offset:19200
    v_mfma_f32_16x16x32_bf16 v[64:67], v[20:23], v[168:171], v[64:67]
    v_mfma_f32_16x16x32_bf16 v[68:71], v[20:23], v[248:251], v[68:71]
    ds_read_b64_tr_b16 v[40:41], v7 offset:18432
    ds_read_b64_tr_b16 v[42:43], v7 offset:19200
    s_waitcnt lgkmcnt(4)
    v_mfma_f32_16x16x32_bf16 v[72:75], v[24:27], v[168:171], v[72:75]
    v_mfma_f32_16x16x32_bf16 v[76:79], v[24:27], v[248:251], v[76:79]
    ds_read_b64_tr_b16 v[44:45], v8 offset:18432
    ds_read_b64_tr_b16 v[46:47], v8 offset:19200
    v_mfma_f32_16x16x32_bf16 v[80:83], v[28:31], v[168:171], v[80:83]
    v_mfma_f32_16x16x32_bf16 v[84:87], v[28:31], v[248:251], v[84:87]
    ds_read_b64_tr_b16 v[48:49], v9 offset:12288
    ds_read_b64_tr_b16 v[50:51], v9 offset:12800
    v_mfma_f32_16x16x32_bf16 v[88:91], v[32:35], v[168:171], v[88:91]
    v_mfma_f32_16x16x32_bf16 v[92:95], v[32:35], v[248:251], v[92:95]
    ds_read_b64_tr_b16 v[52:53], v10 offset:12288
    ds_read_b64_tr_b16 v[54:55], v10 offset:12800
    s_waitcnt lgkmcnt(0)
    s_waitcnt vmcnt(5)
    s_barrier
    v_bfe_u32 v16, v0, 2, 2
    v_and_b32 v17, 3, v0
    v_lshl_add_u32 v18, v12, 3, v16
    v_and_b32 v19, 1, v12
    v_mul_u32_u24 v21, 192, v18
    v_lshl_add_u32 v21, v17, 3, v21
    v_add_u32 v21, 81920, v21
    s_cmp_eq_u32 s38, 0
    s_cselect_b32 s50, 0, 1
    v_xor_b32 v20, s50, v19
    v_lshl_add_u32 v6, v20, 5, v21
    s_cmp_eq_u32 s38, 0
    s_cselect_b32 s50, 2, 4
    v_xor_b32 v20, s50, v19
    v_lshl_add_u32 v7, v20, 5, v21
    s_cmp_eq_u32 s38, 0
    s_cselect_b32 s50, 3, 5
    v_xor_b32 v20, s50, v19
    v_lshl_add_u32 v8, v20, 5, v21
    v_lshrrev_b32 v20, 1, v16
    v_lshl_or_b32 v19, v19, 1, v20
    v_lshlrev_b32 v21, 7, v18
    v_lshl_add_u32 v21, v17, 3, v21
    v_add_u32 v21, 106496, v21
    s_lshl_b32 s49, s38, 1
    s_add_u32 s50, s49, 0
    v_xor_b32 v20, s50, v19
    v_lshl_add_u32 v9, v20, 5, v21
    s_add_u32 s50, s49, 1
    v_xor_b32 v20, s50, v19
    v_lshl_add_u32 v10, v20, 5, v21
    v_mfma_f32_16x16x32_bf16 v[56:59], v[36:39], v[172:175], v[56:59]
    v_mfma_f32_16x16x32_bf16 v[60:63], v[36:39], v[252:255], v[60:63]
    ds_read_b64_tr_b16 v[16:17], v6 offset:0
    ds_read_b64_tr_b16 v[18:19], v6 offset:768
    v_mfma_f32_16x16x32_bf16 v[64:67], v[40:43], v[172:175], v[64:67]
    v_mfma_f32_16x16x32_bf16 v[68:71], v[40:43], v[252:255], v[68:71]
    ds_read_b64_tr_b16 v[20:21], v7 offset:0
    ds_read_b64_tr_b16 v[22:23], v7 offset:768
    s_mul_i32 s50, s46, 2
    s_add_u32 s51, s50, s56
    s_add_u32 s50, s50, 128
    s_add_u32 m0, s47, 40960
    s_nop 0
    buffer_load_dwordx4 v1, s[20:23], s50 offen lds
    v_mfma_f32_16x16x32_bf16 v[72:75], v[44:47], v[172:175], v[72:75]
    v_mfma_f32_16x16x32_bf16 v[76:79], v[44:47], v[252:255], v[76:79]
    ds_read_b64_tr_b16 v[24:25], v8 offset:0
    ds_read_b64_tr_b16 v[26:27], v8 offset:768
    v_mfma_f32_16x16x32_bf16 v[80:83], v[48:51], v[172:175], v[80:83]
    v_mfma_f32_16x16x32_bf16 v[84:87], v[48:51], v[252:255], v[84:87]
    ds_read_b64_tr_b16 v[28:29], v9 offset:0
    ds_read_b64_tr_b16 v[30:31], v9 offset:512
    s_add_u32 m0, s47, 41984
    s_nop 0
    buffer_load_dwordx4 v2, s[20:23], s50 offen lds
    v_mfma_f32_16x16x32_bf16 v[88:91], v[52:55], v[172:175], v[88:91]
    v_mfma_f32_16x16x32_bf16 v[92:95], v[52:55], v[252:255], v[92:95]
    ds_read_b64_tr_b16 v[32:33], v10 offset:0
    ds_read_b64_tr_b16 v[34:35], v10 offset:512
    v_lshlrev_b32 v13, 4, v0
    s_lshr_b32 s52, s39, 4
    s_mul_i32 s52, s52, 49152
    s_add_u32 s52, s52, 12582912
    s_lshl_b32 s55, s36, 11
    s_add_u32 s55, s55, 122880
    v_add_u32 v14, s55, v13
    ds_write_b128 v14, v[72:75] offset:0
    ds_write_b128 v14, v[76:79] offset:1024
    s_lshl_b32 s54, s38, 1
    s_add_u32 s54, s54, s44
    s_add_u32 s54, s54, 0
    s_lshl_b32 s54, s54, 9
    s_add_u32 s54, s54, s52
    s_add_u32 s55, s54, 49152
    v_cvt_pk_bf16_f32 v44, v56, v57
    v_lshlrev_b32 v36, 16, v44
    v_and_b32 v37, 0xffff0000, v44
    v_cvt_pk_bf16_f32 v45, v58, v59
    v_lshlrev_b32 v38, 16, v45
    v_and_b32 v39, 0xffff0000, v45
    v_cvt_pk_bf16_f32 v46, v80, v81
    v_lshlrev_b32 v40, 16, v46
    v_and_b32 v41, 0xffff0000, v46
    v_cvt_pk_bf16_f32 v47, v82, v83
    v_lshlrev_b32 v42, 16, v47
    v_and_b32 v43, 0xffff0000, v47
    v_mul_f32 v44, 0xbfb8aa3b, v36
    v_mul_f32 v45, 0xbfb8aa3b, v37
    v_mul_f32 v46, 0xbfb8aa3b, v38
    v_mul_f32 v47, 0xbfb8aa3b, v39
    v_exp_f32 v44, v44
    v_exp_f32 v45, v45
    v_exp_f32 v46, v46
    v_exp_f32 v47, v47
    v_add_f32 v44, 1.0, v44
    v_add_f32 v45, 1.0, v45
    v_add_f32 v46, 1.0, v46
    v_add_f32 v47, 1.0, v47
    v_rcp_f32 v44, v44
    v_rcp_f32 v45, v45
    v_rcp_f32 v46, v46
    v_rcp_f32 v47, v47
    v_mul_f32 v36, v36, v44
    v_mul_f32 v37, v37, v45
    v_mul_f32 v38, v38, v46
    v_mul_f32 v39, v39, v47
    v_cvt_pk_bf16_f32 v44, v36, v37
    v_lshlrev_b32 v36, 16, v44
    v_and_b32 v37, 0xffff0000, v44
    v_cvt_pk_bf16_f32 v45, v38, v39
    v_lshlrev_b32 v38, 16, v45
    v_and_b32 v39, 0xffff0000, v45
    v_mul_f32 v36, v36, v40
    v_mul_f32 v37, v37, v41
    v_mul_f32 v38, v38, v42
    v_mul_f32 v39, v39, v43
    v_cvt_pk_bf16_f32 v48, v36, v37
    v_cvt_pk_bf16_f32 v49, v38, v39
    v_cvt_pk_bf16_f32 v44, v64, v65
    v_lshlrev_b32 v36, 16, v44
    v_and_b32 v37, 0xffff0000, v44
    v_cvt_pk_bf16_f32 v45, v66, v67
    v_lshlrev_b32 v38, 16, v45
    v_and_b32 v39, 0xffff0000, v45
    v_cvt_pk_bf16_f32 v46, v88, v89
    v_lshlrev_b32 v40, 16, v46
    v_and_b32 v41, 0xffff0000, v46
    v_cvt_pk_bf16_f32 v47, v90, v91
    v_lshlrev_b32 v42, 16, v47
    v_and_b32 v43, 0xffff0000, v47
    v_mul_f32 v44, 0xbfb8aa3b, v36
    v_mul_f32 v45, 0xbfb8aa3b, v37
    v_mul_f32 v46, 0xbfb8aa3b, v38
    v_mul_f32 v47, 0xbfb8aa3b, v39
    v_exp_f32 v44, v44
    v_exp_f32 v45, v45
    v_exp_f32 v46, v46
    v_exp_f32 v47, v47
    v_add_f32 v44, 1.0, v44
    v_add_f32 v45, 1.0, v45
    v_add_f32 v46, 1.0, v46
    v_add_f32 v47, 1.0, v47
    v_rcp_f32 v44, v44
    v_rcp_f32 v45, v45
    v_rcp_f32 v46, v46
    v_rcp_f32 v47, v47
    v_mul_f32 v36, v36, v44
    v_mul_f32 v37, v37, v45
    v_mul_f32 v38, v38, v46
    v_mul_f32 v39, v39, v47
    v_cvt_pk_bf16_f32 v44, v36, v37
    v_lshlrev_b32 v36, 16, v44
    v_and_b32 v37, 0xffff0000, v44
    v_cvt_pk_bf16_f32 v45, v38, v39
    v_lshlrev_b32 v38, 16, v45
    v_and_b32 v39, 0xffff0000, v45
    v_mul_f32 v36, v36, v40
    v_mul_f32 v37, v37, v41
    v_mul_f32 v38, v38, v42
    v_mul_f32 v39, v39, v43
    v_cvt_pk_bf16_f32 v50, v36, v37
    v_cvt_pk_bf16_f32 v51, v38, v39
    buffer_store_dwordx4 v[48:51], v13, s[28:31], s54 offen
    v_cvt_pk_bf16_f32 v44, v60, v61
    v_lshlrev_b32 v36, 16, v44
    v_and_b32 v37, 0xffff0000, v44
    v_cvt_pk_bf16_f32 v45, v62, v63
    v_lshlrev_b32 v38, 16, v45
    v_and_b32 v39, 0xffff0000, v45
    v_cvt_pk_bf16_f32 v46, v84, v85
    v_lshlrev_b32 v40, 16, v46
    v_and_b32 v41, 0xffff0000, v46
    v_cvt_pk_bf16_f32 v47, v86, v87
    v_lshlrev_b32 v42, 16, v47
    v_and_b32 v43, 0xffff0000, v47
    v_mul_f32 v44, 0xbfb8aa3b, v36
    v_mul_f32 v45, 0xbfb8aa3b, v37
    v_mul_f32 v46, 0xbfb8aa3b, v38
    v_mul_f32 v47, 0xbfb8aa3b, v39
    v_exp_f32 v44, v44
    v_exp_f32 v45, v45
    v_exp_f32 v46, v46
    v_exp_f32 v47, v47
    v_add_f32 v44, 1.0, v44
    v_add_f32 v45, 1.0, v45
    v_add_f32 v46, 1.0, v46
    v_add_f32 v47, 1.0, v47
    v_rcp_f32 v44, v44
    v_rcp_f32 v45, v45
    v_rcp_f32 v46, v46
    v_rcp_f32 v47, v47
    v_mul_f32 v36, v36, v44
    v_mul_f32 v37, v37, v45
    v_mul_f32 v38, v38, v46
    v_mul_f32 v39, v39, v47
    v_cvt_pk_bf16_f32 v44, v36, v37
    v_lshlrev_b32 v36, 16, v44
    v_and_b32 v37, 0xffff0000, v44
    v_cvt_pk_bf16_f32 v45, v38, v39
    v_lshlrev_b32 v38, 16, v45
    v_and_b32 v39, 0xffff0000, v45
    v_mul_f32 v36, v36, v40
    v_mul_f32 v37, v37, v41
    v_mul_f32 v38, v38, v42
    v_mul_f32 v39, v39, v43
    v_cvt_pk_bf16_f32 v52, v36, v37
    v_cvt_pk_bf16_f32 v53, v38, v39
    v_cvt_pk_bf16_f32 v44, v68, v69
    v_lshlrev_b32 v36, 16, v44
    v_and_b32 v37, 0xffff0000, v44
    v_cvt_pk_bf16_f32 v45, v70, v71
    v_lshlrev_b32 v38, 16, v45
    v_and_b32 v39, 0xffff0000, v45
    v_cvt_pk_bf16_f32 v46, v92, v93
    v_lshlrev_b32 v40, 16, v46
    v_and_b32 v41, 0xffff0000, v46
    v_cvt_pk_bf16_f32 v47, v94, v95
    v_lshlrev_b32 v42, 16, v47
    v_and_b32 v43, 0xffff0000, v47
    v_mul_f32 v44, 0xbfb8aa3b, v36
    v_mul_f32 v45, 0xbfb8aa3b, v37
    v_mul_f32 v46, 0xbfb8aa3b, v38
    v_mul_f32 v47, 0xbfb8aa3b, v39
    v_exp_f32 v44, v44
    v_exp_f32 v45, v45
    v_exp_f32 v46, v46
    v_exp_f32 v47, v47
    v_add_f32 v44, 1.0, v44
    v_add_f32 v45, 1.0, v45
    v_add_f32 v46, 1.0, v46
    v_add_f32 v47, 1.0, v47
    v_rcp_f32 v44, v44
    v_rcp_f32 v45, v45
    v_rcp_f32 v46, v46
    v_rcp_f32 v47, v47
    v_mul_f32 v36, v36, v44
    v_mul_f32 v37, v37, v45
    v_mul_f32 v38, v38, v46
    v_mul_f32 v39, v39, v47
    v_cvt_pk_bf16_f32 v44, v36, v37
    v_lshlrev_b32 v36, 16, v44
    v_and_b32 v37, 0xffff0000, v44
    v_cvt_pk_bf16_f32 v45, v38, v39
    v_lshlrev_b32 v38, 16, v45
    v_and_b32 v39, 0xffff0000, v45
    v_mul_f32 v36, v36, v40
    v_mul_f32 v37, v37, v41
    v_mul_f32 v38, v38, v42
    v_mul_f32 v39, v39, v43
    v_cvt_pk_bf16_f32 v54, v36, v37
    v_cvt_pk_bf16_f32 v55, v38, v39
    buffer_store_dwordx4 v[52:55], v13, s[28:31], s55 offen
    s_waitcnt lgkmcnt(8)
    v_mfma_f32_16x16x32_bf16 v[56:59], v[16:19], v[96:99], 0
    v_mfma_f32_16x16x32_bf16 v[60:63], v[16:19], v[176:179], 0
    ds_read_b64_tr_b16 v[36:37], v6 offset:6144
    ds_read_b64_tr_b16 v[38:39], v6 offset:6912
    v_mfma_f32_16x16x32_bf16 v[64:67], v[20:23], v[96:99], 0
    v_mfma_f32_16x16x32_bf16 v[68:71], v[20:23], v[176:179], 0
    ds_read_b64_tr_b16 v[40:41], v7 offset:6144
    ds_read_b64_tr_b16 v[42:43], v7 offset:6912
    s_add_u32 m0, s47, 43008
    s_nop 0
    buffer_load_dwordx4 v3, s[20:23], s50 offen lds
    s_waitcnt lgkmcnt(6)
    v_mfma_f32_16x16x32_bf16 v[72:75], v[24:27], v[96:99], 0
    v_mfma_f32_16x16x32_bf16 v[76:79], v[24:27], v[176:179], 0
    ds_read_b64_tr_b16 v[44:45], v8 offset:6144
    ds_read_b64_tr_b16 v[46:47], v8 offset:6912
    v_mfma_f32_16x16x32_bf16 v[80:83], v[28:31], v[96:99], 0
    v_mfma_f32_16x16x32_bf16 v[84:87], v[28:31], v[176:179], 0
    ds_read_b64_tr_b16 v[48:49], v9 offset:4096
    ds_read_b64_tr_b16 v[50:51], v9 offset:4608
    s_add_u32 m0, s48, 40960
    s_nop 0
    buffer_load_dwordx4 v4, s[16:19], s51 offen lds
    v_mfma_f32_16x16x32_bf16 v[88:91], v[32:35], v[96:99], 0
    v_mfma_f32_16x16x32_bf16 v[92:95], v[32:35], v[176:179], 0
    ds_read_b64_tr_b16 v[52:53], v10 offset:4096
    ds_read_b64_tr_b16 v[54:55], v10 offset:4608
    s_waitcnt lgkmcnt(6)
    v_mfma_f32_16x16x32_bf16 v[56:59], v[36:39], v[100:103], v[56:59]
    v_mfma_f32_16x16x32_bf16 v[60:63], v[36:39], v[180:183], v[60:63]
    ds_read_b64_tr_b16 v[16:17], v6 offset:12288
    ds_read_b64_tr_b16 v[18:19], v6 offset:13056
    v_mfma_f32_16x16x32_bf16 v[64:67], v[40:43], v[100:103], v[64:67]
    v_mfma_f32_16x16x32_bf16 v[68:71], v[40:43], v[180:183], v[68:71]
    ds_read_b64_tr_b16 v[20:21], v7 offset:12288
    ds_read_b64_tr_b16 v[22:23], v7 offset:13056
    s_add_u32 m0, s48, 41984
    s_nop 0
    buffer_load_dwordx4 v5, s[16:19], s51 offen lds
    s_waitcnt lgkmcnt(4)
    v_mfma_f32_16x16x32_bf16 v[72:75], v[44:47], v[100:103], v[72:75]
    v_mfma_f32_16x16x32_bf16 v[76:79], v[44:47], v[180:183], v[76:79]
    ds_read_b64_tr_b16 v[24:25], v8 offset:12288
    ds_read_b64_tr_b16 v[26:27], v8 offset:13056
    v_mfma_f32_16x16x32_bf16 v[80:83], v[48:51], v[100:103], v[80:83]
    v_mfma_f32_16x16x32_bf16 v[84:87], v[48:51], v[180:183], v[84:87]
    ds_read_b64_tr_b16 v[28:29], v9 offset:8192
    ds_read_b64_tr_b16 v[30:31], v9 offset:8704
    v_mfma_f32_16x16x32_bf16 v[88:91], v[52:55], v[100:103], v[88:91]
    v_mfma_f32_16x16x32_bf16 v[92:95], v[52:55], v[180:183], v[92:95]
    ds_read_b64_tr_b16 v[32:33], v10 offset:8192
    ds_read_b64_tr_b16 v[34:35], v10 offset:8704
    s_waitcnt lgkmcnt(6)
    v_mfma_f32_16x16x32_bf16 v[56:59], v[16:19], v[104:107], v[56:59]
    v_mfma_f32_16x16x32_bf16 v[60:63], v[16:19], v[184:187], v[60:63]
    ds_read_b64_tr_b16 v[36:37], v6 offset:18432
    ds_read_b64_tr_b16 v[38:39], v6 offset:19200
    v_mfma_f32_16x16x32_bf16 v[64:67], v[20:23], v[104:107], v[64:67]
    v_mfma_f32_16x16x32_bf16 v[68:71], v[20:23], v[184:187], v[68:71]
    ds_read_b64_tr_b16 v[40:41], v7 offset:18432
    ds_read_b64_tr_b16 v[42:43], v7 offset:19200
    s_waitcnt lgkmcnt(4)
    v_mfma_f32_16x16x32_bf16 v[72:75], v[24:27], v[104:107], v[72:75]
    v_mfma_f32_16x16x32_bf16 v[76:79], v[24:27], v[184:187], v[76:79]
    ds_read_b64_tr_b16 v[44:45], v8 offset:18432
    ds_read_b64_tr_b16 v[46:47], v8 offset:19200
    v_mfma_f32_16x16x32_bf16 v[80:83], v[28:31], v[104:107], v[80:83]
    v_mfma_f32_16x16x32_bf16 v[84:87], v[28:31], v[184:187], v[84:87]
    ds_read_b64_tr_b16 v[48:49], v9 offset:12288
    ds_read_b64_tr_b16 v[50:51], v9 offset:12800
    v_mfma_f32_16x16x32_bf16 v[88:91], v[32:35], v[104:107], v[88:91]
    v_mfma_f32_16x16x32_bf16 v[92:95], v[32:35], v[184:187], v[92:95]
    ds_read_b64_tr_b16 v[52:53], v10 offset:12288
    ds_read_b64_tr_b16 v[54:55], v10 offset:12800
    s_waitcnt lgkmcnt(0)
    s_waitcnt vmcnt(7)
    s_barrier
    v_subrev_u32 v6, 81920, v6
    v_subrev_u32 v7, 81920, v7
    v_subrev_u32 v8, 81920, v8
    v_subrev_u32 v9, 81920, v9
    v_subrev_u32 v10, 81920, v10
    v_mfma_f32_16x16x32_bf16 v[56:59], v[36:39], v[108:111], v[56:59]
    v_mfma_f32_16x16x32_bf16 v[60:63], v[36:39], v[188:191], v[60:63]
    ds_read_b64_tr_b16 v[16:17], v6 offset:0
    ds_read_b64_tr_b16 v[18:19], v6 offset:768
    v_mfma_f32_16x16x32_bf16 v[64:67], v[40:43], v[108:111], v[64:67]
    v_mfma_f32_16x16x32_bf16 v[68:71], v[40:43], v[188:191], v[68:71]
    ds_read_b64_tr_b16 v[20:21], v7 offset:0
    ds_read_b64_tr_b16 v[22:23], v7 offset:768
    s_mul_i32 s50, s46, 3
    s_add_u32 s51, s50, s56
    s_add_u32 s50, s50, 128
    s_add_u32 m0, s47, 81920
    s_nop 0
    buffer_load_dwordx4 v1, s[20:23], s50 offen lds
    v_mfma_f32_16x16x32_bf16 v[72:75], v[44:47], v[108:111], v[72:75]
    v_mfma_f32_16x16x32_bf16 v[76:79], v[44:47], v[188:191], v[76:79]
    ds_read_b64_tr_b16 v[24:25], v8 offset:0
    ds_read_b64_tr_b16 v[26:27], v8 offset:768
    v_mfma_f32_16x16x32_bf16 v[80:83], v[48:51], v[108:111], v[80:83]
    v_mfma_f32_16x16x32_bf16 v[84:87], v[48:51], v[188:191], v[84:87]
    ds_read_b64_tr_b16 v[28:29], v9 offset:0
    ds_read_b64_tr_b16 v[30:31], v9 offset:512
    s_add_u32 m0, s47, 82944
    s_nop 0
    buffer_load_dwordx4 v2, s[20:23], s50 offen lds
    v_mfma_f32_16x16x32_bf16 v[88:91], v[52:55], v[108:111], v[88:91]
    v_mfma_f32_16x16x32_bf16 v[92:95], v[52:55], v[188:191], v[92:95]
    ds_read_b64_tr_b16 v[32:33], v10 offset:0
    ds_read_b64_tr_b16 v[34:35], v10 offset:512
    s_waitcnt lgkmcnt(6)
    v_mfma_f32_16x16x32_bf16 v[56:59], v[16:19], v[112:115], v[56:59]
    v_mfma_f32_16x16x32_bf16 v[60:63], v[16:19], v[192:195], v[60:63]
    ds_read_b64_tr_b16 v[36:37], v6 offset:6144
    ds_read_b64_tr_b16 v[38:39], v6 offset:6912
    v_mfma_f32_16x16x32_bf16 v[64:67], v[20:23], v[112:115], v[64:67]
    v_mfma_f32_16x16x32_bf16 v[68:71], v[20:23], v[192:195], v[68:71]
    ds_read_b64_tr_b16 v[40:41], v7 offset:6144
    ds_read_b64_tr_b16 v[42:43], v7 offset:6912
    s_add_u32 m0, s47, 83968
    s_nop 0
    buffer_load_dwordx4 v3, s[20:23], s50 offen lds
    s_waitcnt lgkmcnt(4)
    v_mfma_f32_16x16x32_bf16 v[72:75], v[24:27], v[112:115], v[72:75]
    v_mfma_f32_16x16x32_bf16 v[76:79], v[24:27], v[192:195], v[76:79]
    ds_read_b64_tr_b16 v[44:45], v8 offset:6144
    ds_read_b64_tr_b16 v[46:47], v8 offset:6912
    v_mfma_f32_16x16x32_bf16 v[80:83], v[28:31], v[112:115], v[80:83]
    v_mfma_f32_16x16x32_bf16 v[84:87], v[28:31], v[192:195], v[84:87]
    ds_read_b64_tr_b16 v[48:49], v9 offset:4096
    ds_read_b64_tr_b16 v[50:51], v9 offset:4608
    s_add_u32 m0, s48, 81920
    s_nop 0
    buffer_load_dwordx4 v4, s[16:19], s51 offen lds
    v_mfma_f32_16x16x32_bf16 v[88:91], v[32:35], v[112:115], v[88:91]
    v_mfma_f32_16x16x32_bf16 v[92:95], v[32:35], v[192:195], v[92:95]
    ds_read_b64_tr_b16 v[52:53], v10 offset:4096
    ds_read_b64_tr_b16 v[54:55], v10 offset:4608
    s_waitcnt lgkmcnt(6)
    v_mfma_f32_16x16x32_bf16 v[56:59], v[36:39], v[116:119], v[56:59]
    v_mfma_f32_16x16x32_bf16 v[60:63], v[36:39], v[196:199], v[60:63]
    ds_read_b64_tr_b16 v[16:17], v6 offset:12288
    ds_read_b64_tr_b16 v[18:19], v6 offset:13056
    v_mfma_f32_16x16x32_bf16 v[64:67], v[40:43], v[116:119], v[64:67]
    v_mfma_f32_16x16x32_bf16 v[68:71], v[40:43], v[196:199], v[68:71]
    ds_read_b64_tr_b16 v[20:21], v7 offset:12288
    ds_read_b64_tr_b16 v[22:23], v7 offset:13056
    s_add_u32 m0, s48, 82944
    s_nop 0
    buffer_load_dwordx4 v5, s[16:19], s51 offen lds
    s_waitcnt lgkmcnt(4)
    v_mfma_f32_16x16x32_bf16 v[72:75], v[44:47], v[116:119], v[72:75]
    v_mfma_f32_16x16x32_bf16 v[76:79], v[44:47], v[196:199], v[76:79]
    ds_read_b64_tr_b16 v[24:25], v8 offset:12288
    ds_read_b64_tr_b16 v[26:27], v8 offset:13056
    v_mfma_f32_16x16x32_bf16 v[80:83], v[48:51], v[116:119], v[80:83]
    v_mfma_f32_16x16x32_bf16 v[84:87], v[48:51], v[196:199], v[84:87]
    ds_read_b64_tr_b16 v[28:29], v9 offset:8192
    ds_read_b64_tr_b16 v[30:31], v9 offset:8704
    v_mfma_f32_16x16x32_bf16 v[88:91], v[52:55], v[116:119], v[88:91]
    v_mfma_f32_16x16x32_bf16 v[92:95], v[52:55], v[196:199], v[92:95]
    ds_read_b64_tr_b16 v[32:33], v10 offset:8192
    ds_read_b64_tr_b16 v[34:35], v10 offset:8704
    s_waitcnt lgkmcnt(6)
    v_mfma_f32_16x16x32_bf16 v[56:59], v[16:19], v[120:123], v[56:59]
    v_mfma_f32_16x16x32_bf16 v[60:63], v[16:19], v[200:203], v[60:63]
    ds_read_b64_tr_b16 v[36:37], v6 offset:18432
    ds_read_b64_tr_b16 v[38:39], v6 offset:19200
    v_mfma_f32_16x16x32_bf16 v[64:67], v[20:23], v[120:123], v[64:67]
    v_mfma_f32_16x16x32_bf16 v[68:71], v[20:23], v[200:203], v[68:71]
    ds_read_b64_tr_b16 v[40:41], v7 offset:18432
    ds_read_b64_tr_b16 v[42:43], v7 offset:19200
    s_waitcnt lgkmcnt(4)
    v_mfma_f32_16x16x32_bf16 v[72:75], v[24:27], v[120:123], v[72:75]
    v_mfma_f32_16x16x32_bf16 v[76:79], v[24:27], v[200:203], v[76:79]
    ds_read_b64_tr_b16 v[44:45], v8 offset:18432
    ds_read_b64_tr_b16 v[46:47], v8 offset:19200
    v_mfma_f32_16x16x32_bf16 v[80:83], v[28:31], v[120:123], v[80:83]
    v_mfma_f32_16x16x32_bf16 v[84:87], v[28:31], v[200:203], v[84:87]
    ds_read_b64_tr_b16 v[48:49], v9 offset:12288
    ds_read_b64_tr_b16 v[50:51], v9 offset:12800
    v_mfma_f32_16x16x32_bf16 v[88:91], v[32:35], v[120:123], v[88:91]
    v_mfma_f32_16x16x32_bf16 v[92:95], v[32:35], v[200:203], v[92:95]
    ds_read_b64_tr_b16 v[52:53], v10 offset:12288
    ds_read_b64_tr_b16 v[54:55], v10 offset:12800
    s_waitcnt lgkmcnt(0)
    s_waitcnt vmcnt(5)
    s_barrier
    v_add_u32 v6, 40960, v6
    v_add_u32 v7, 40960, v7
    v_add_u32 v8, 40960, v8
    v_add_u32 v9, 40960, v9
    v_add_u32 v10, 40960, v10
    v_mfma_f32_16x16x32_bf16 v[56:59], v[36:39], v[124:127], v[56:59]
    v_mfma_f32_16x16x32_bf16 v[60:63], v[36:39], v[204:207], v[60:63]
    ds_read_b64_tr_b16 v[16:17], v6 offset:0
    ds_read_b64_tr_b16 v[18:19], v6 offset:768
    v_mfma_f32_16x16x32_bf16 v[64:67], v[40:43], v[124:127], v[64:67]
    v_mfma_f32_16x16x32_bf16 v[68:71], v[40:43], v[204:207], v[68:71]
    ds_read_b64_tr_b16 v[20:21], v7 offset:0
    ds_read_b64_tr_b16 v[22:23], v7 offset:768
    s_mul_i32 s50, s46, 4
    s_add_u32 s51, s50, s56
    s_add_u32 s50, s50, 128
    s_add_u32 m0, s47, 0
    s_nop 0
    buffer_load_dwordx4 v1, s[20:23], s50 offen lds
    v_mfma_f32_16x16x32_bf16 v[72:75], v[44:47], v[124:127], v[72:75]
    v_mfma_f32_16x16x32_bf16 v[76:79], v[44:47], v[204:207], v[76:79]
    ds_read_b64_tr_b16 v[24:25], v8 offset:0
    ds_read_b64_tr_b16 v[26:27], v8 offset:768
    v_mfma_f32_16x16x32_bf16 v[80:83], v[48:51], v[124:127], v[80:83]
    v_mfma_f32_16x16x32_bf16 v[84:87], v[48:51], v[204:207], v[84:87]
    ds_read_b64_tr_b16 v[28:29], v9 offset:0
    ds_read_b64_tr_b16 v[30:31], v9 offset:512
    s_add_u32 m0, s47, 1024
    s_nop 0
    buffer_load_dwordx4 v2, s[20:23], s50 offen lds
    v_mfma_f32_16x16x32_bf16 v[88:91], v[52:55], v[124:127], v[88:91]
    v_mfma_f32_16x16x32_bf16 v[92:95], v[52:55], v[204:207], v[92:95]
    ds_read_b64_tr_b16 v[32:33], v10 offset:0
    ds_read_b64_tr_b16 v[34:35], v10 offset:512
    s_waitcnt lgkmcnt(6)
    v_mfma_f32_16x16x32_bf16 v[56:59], v[16:19], v[128:131], v[56:59]
    v_mfma_f32_16x16x32_bf16 v[60:63], v[16:19], v[208:211], v[60:63]
    ds_read_b64_tr_b16 v[36:37], v6 offset:6144
    ds_read_b64_tr_b16 v[38:39], v6 offset:6912
    v_mfma_f32_16x16x32_bf16 v[64:67], v[20:23], v[128:131], v[64:67]
    v_mfma_f32_16x16x32_bf16 v[68:71], v[20:23], v[208:211], v[68:71]
    ds_read_b64_tr_b16 v[40:41], v7 offset:6144
    ds_read_b64_tr_b16 v[42:43], v7 offset:6912
    s_add_u32 m0, s47, 2048
    s_nop 0
    buffer_load_dwordx4 v3, s[20:23], s50 offen lds
    s_waitcnt lgkmcnt(4)
    v_mfma_f32_16x16x32_bf16 v[72:75], v[24:27], v[128:131], v[72:75]
    v_mfma_f32_16x16x32_bf16 v[76:79], v[24:27], v[208:211], v[76:79]
    ds_read_b64_tr_b16 v[44:45], v8 offset:6144
    ds_read_b64_tr_b16 v[46:47], v8 offset:6912
    v_mfma_f32_16x16x32_bf16 v[80:83], v[28:31], v[128:131], v[80:83]
    v_mfma_f32_16x16x32_bf16 v[84:87], v[28:31], v[208:211], v[84:87]
    ds_read_b64_tr_b16 v[48:49], v9 offset:4096
    ds_read_b64_tr_b16 v[50:51], v9 offset:4608
    s_add_u32 m0, s48, 0
    s_nop 0
    buffer_load_dwordx4 v4, s[16:19], s51 offen lds
    v_mfma_f32_16x16x32_bf16 v[88:91], v[32:35], v[128:131], v[88:91]
    v_mfma_f32_16x16x32_bf16 v[92:95], v[32:35], v[208:211], v[92:95]
    ds_read_b64_tr_b16 v[52:53], v10 offset:4096
    ds_read_b64_tr_b16 v[54:55], v10 offset:4608
    s_waitcnt lgkmcnt(6)
    v_mfma_f32_16x16x32_bf16 v[56:59], v[36:39], v[132:135], v[56:59]
    v_mfma_f32_16x16x32_bf16 v[60:63], v[36:39], v[212:215], v[60:63]
    ds_read_b64_tr_b16 v[16:17], v6 offset:12288
    ds_read_b64_tr_b16 v[18:19], v6 offset:13056
    v_mfma_f32_16x16x32_bf16 v[64:67], v[40:43], v[132:135], v[64:67]
    v_mfma_f32_16x16x32_bf16 v[68:71], v[40:43], v[212:215], v[68:71]
    ds_read_b64_tr_b16 v[20:21], v7 offset:12288
    ds_read_b64_tr_b16 v[22:23], v7 offset:13056
    s_add_u32 m0, s48, 1024
    s_nop 0
    buffer_load_dwordx4 v5, s[16:19], s51 offen lds
    s_waitcnt lgkmcnt(4)
    v_mfma_f32_16x16x32_bf16 v[72:75], v[44:47], v[132:135], v[72:75]
    v_mfma_f32_16x16x32_bf16 v[76:79], v[44:47], v[212:215], v[76:79]
    ds_read_b64_tr_b16 v[24:25], v8 offset:12288
    ds_read_b64_tr_b16 v[26:27], v8 offset:13056
    v_mfma_f32_16x16x32_bf16 v[80:83], v[48:51], v[132:135], v[80:83]
    v_mfma_f32_16x16x32_bf16 v[84:87], v[48:51], v[212:215], v[84:87]
    ds_read_b64_tr_b16 v[28:29], v9 offset:8192
    ds_read_b64_tr_b16 v[30:31], v9 offset:8704
    v_mfma_f32_16x16x32_bf16 v[88:91], v[52:55], v[132:135], v[88:91]
    v_mfma_f32_16x16x32_bf16 v[92:95], v[52:55], v[212:215], v[92:95]
    ds_read_b64_tr_b16 v[32:33], v10 offset:8192
    ds_read_b64_tr_b16 v[34:35], v10 offset:8704
    s_waitcnt lgkmcnt(6)
    v_mfma_f32_16x16x32_bf16 v[56:59], v[16:19], v[136:139], v[56:59]
    v_mfma_f32_16x16x32_bf16 v[60:63], v[16:19], v[216:219], v[60:63]
    ds_read_b64_tr_b16 v[36:37], v6 offset:18432
    ds_read_b64_tr_b16 v[38:39], v6 offset:19200
    v_mfma_f32_16x16x32_bf16 v[64:67], v[20:23], v[136:139], v[64:67]
    v_mfma_f32_16x16x32_bf16 v[68:71], v[20:23], v[216:219], v[68:71]
    ds_read_b64_tr_b16 v[40:41], v7 offset:18432
    ds_read_b64_tr_b16 v[42:43], v7 offset:19200
    s_waitcnt lgkmcnt(4)
    v_mfma_f32_16x16x32_bf16 v[72:75], v[24:27], v[136:139], v[72:75]
    v_mfma_f32_16x16x32_bf16 v[76:79], v[24:27], v[216:219], v[76:79]
    ds_read_b64_tr_b16 v[44:45], v8 offset:18432
    ds_read_b64_tr_b16 v[46:47], v8 offset:19200
    v_mfma_f32_16x16x32_bf16 v[80:83], v[28:31], v[136:139], v[80:83]
    v_mfma_f32_16x16x32_bf16 v[84:87], v[28:31], v[216:219], v[84:87]
    ds_read_b64_tr_b16 v[48:49], v9 offset:12288
    ds_read_b64_tr_b16 v[50:51], v9 offset:12800
    v_mfma_f32_16x16x32_bf16 v[88:91], v[32:35], v[136:139], v[88:91]
    v_mfma_f32_16x16x32_bf16 v[92:95], v[32:35], v[216:219], v[92:95]
    ds_read_b64_tr_b16 v[52:53], v10 offset:12288
    ds_read_b64_tr_b16 v[54:55], v10 offset:12800
    s_waitcnt lgkmcnt(0)
    s_waitcnt vmcnt(5)
    s_barrier
    v_add_u32 v6, 40960, v6
    v_add_u32 v7, 40960, v7
    v_add_u32 v8, 40960, v8
    v_add_u32 v9, 40960, v9
    v_add_u32 v10, 40960, v10
    v_mfma_f32_16x16x32_bf16 v[56:59], v[36:39], v[140:143], v[56:59]
    v_mfma_f32_16x16x32_bf16 v[60:63], v[36:39], v[220:223], v[60:63]
    ds_read_b64_tr_b16 v[16:17], v6 offset:0
    ds_read_b64_tr_b16 v[18:19], v6 offset:768
    v_mfma_f32_16x16x32_bf16 v[64:67], v[40:43], v[140:143], v[64:67]
    v_mfma_f32_16x16x32_bf16 v[68:71], v[40:43], v[220:223], v[68:71]
    ds_read_b64_tr_b16 v[20:21], v7 offset:0
    ds_read_b64_tr_b16 v[22:23], v7 offset:768
    v_mfma_f32_16x16x32_bf16 v[72:75], v[44:47], v[140:143], v[72:75]
    v_mfma_f32_16x16x32_bf16 v[76:79], v[44:47], v[220:223], v[76:79]
    ds_read_b64_tr_b16 v[24:25], v8 offset:0
    ds_read_b64_tr_b16 v[26:27], v8 offset:768
    v_mfma_f32_16x16x32_bf16 v[80:83], v[48:51], v[140:143], v[80:83]
    v_mfma_f32_16x16x32_bf16 v[84:87], v[48:51], v[220:223], v[84:87]
    ds_read_b64_tr_b16 v[28:29], v9 offset:0
    ds_read_b64_tr_b16 v[30:31], v9 offset:512
    v_mfma_f32_16x16x32_bf16 v[88:91], v[52:55], v[140:143], v[88:91]
    v_mfma_f32_16x16x32_bf16 v[92:95], v[52:55], v[220:223], v[92:95]
    ds_read_b64_tr_b16 v[32:33], v10 offset:0
    ds_read_b64_tr_b16 v[34:35], v10 offset:512
    s_waitcnt lgkmcnt(6)
    v_mfma_f32_16x16x32_bf16 v[56:59], v[16:19], v[144:147], v[56:59]
    v_mfma_f32_16x16x32_bf16 v[60:63], v[16:19], v[224:227], v[60:63]
    ds_read_b64_tr_b16 v[36:37], v6 offset:6144
    ds_read_b64_tr_b16 v[38:39], v6 offset:6912
    v_mfma_f32_16x16x32_bf16 v[64:67], v[20:23], v[144:147], v[64:67]
    v_mfma_f32_16x16x32_bf16 v[68:71], v[20:23], v[224:227], v[68:71]
    ds_read_b64_tr_b16 v[40:41], v7 offset:6144
    ds_read_b64_tr_b16 v[42:43], v7 offset:6912
    s_waitcnt lgkmcnt(4)
    v_mfma_f32_16x16x32_bf16 v[72:75], v[24:27], v[144:147], v[72:75]
    v_mfma_f32_16x16x32_bf16 v[76:79], v[24:27], v[224:227], v[76:79]
    ds_read_b64_tr_b16 v[44:45], v8 offset:6144
    ds_read_b64_tr_b16 v[46:47], v8 offset:6912
    v_mfma_f32_16x16x32_bf16 v[80:83], v[28:31], v[144:147], v[80:83]
    v_mfma_f32_16x16x32_bf16 v[84:87], v[28:31], v[224:227], v[84:87]
    ds_read_b64_tr_b16 v[48:49], v9 offset:4096
    ds_read_b64_tr_b16 v[50:51], v9 offset:4608
    v_mfma_f32_16x16x32_bf16 v[88:91], v[32:35], v[144:147], v[88:91]
    v_mfma_f32_16x16x32_bf16 v[92:95], v[32:35], v[224:227], v[92:95]
    ds_read_b64_tr_b16 v[52:53], v10 offset:4096
    ds_read_b64_tr_b16 v[54:55], v10 offset:4608
    s_waitcnt lgkmcnt(6)
    v_mfma_f32_16x16x32_bf16 v[56:59], v[36:39], v[148:151], v[56:59]
    v_mfma_f32_16x16x32_bf16 v[60:63], v[36:39], v[228:231], v[60:63]
    ds_read_b64_tr_b16 v[16:17], v6 offset:12288
    ds_read_b64_tr_b16 v[18:19], v6 offset:13056
    v_mfma_f32_16x16x32_bf16 v[64:67], v[40:43], v[148:151], v[64:67]
    v_mfma_f32_16x16x32_bf16 v[68:71], v[40:43], v[228:231], v[68:71]
    ds_read_b64_tr_b16 v[20:21], v7 offset:12288
    ds_read_b64_tr_b16 v[22:23], v7 offset:13056
    s_waitcnt lgkmcnt(4)
    v_mfma_f32_16x16x32_bf16 v[72:75], v[44:47], v[148:151], v[72:75]
    v_mfma_f32_16x16x32_bf16 v[76:79], v[44:47], v[228:231], v[76:79]
    ds_read_b64_tr_b16 v[24:25], v8 offset:12288
    ds_read_b64_tr_b16 v[26:27], v8 offset:13056
    v_mfma_f32_16x16x32_bf16 v[80:83], v[48:51], v[148:151], v[80:83]
    v_mfma_f32_16x16x32_bf16 v[84:87], v[48:51], v[228:231], v[84:87]
    ds_read_b64_tr_b16 v[28:29], v9 offset:8192
    ds_read_b64_tr_b16 v[30:31], v9 offset:8704
    v_mfma_f32_16x16x32_bf16 v[88:91], v[52:55], v[148:151], v[88:91]
    v_mfma_f32_16x16x32_bf16 v[92:95], v[52:55], v[228:231], v[92:95]
    ds_read_b64_tr_b16 v[32:33], v10 offset:8192
    ds_read_b64_tr_b16 v[34:35], v10 offset:8704
    s_waitcnt lgkmcnt(6)
    v_mfma_f32_16x16x32_bf16 v[56:59], v[16:19], v[152:155], v[56:59]
    v_mfma_f32_16x16x32_bf16 v[60:63], v[16:19], v[232:235], v[60:63]
    ds_read_b64_tr_b16 v[36:37], v6 offset:18432
    ds_read_b64_tr_b16 v[38:39], v6 offset:19200
    v_mfma_f32_16x16x32_bf16 v[64:67], v[20:23], v[152:155], v[64:67]
    v_mfma_f32_16x16x32_bf16 v[68:71], v[20:23], v[232:235], v[68:71]
    ds_read_b64_tr_b16 v[40:41], v7 offset:18432
    ds_read_b64_tr_b16 v[42:43], v7 offset:19200
    s_waitcnt lgkmcnt(4)
    v_mfma_f32_16x16x32_bf16 v[72:75], v[24:27], v[152:155], v[72:75]
    v_mfma_f32_16x16x32_bf16 v[76:79], v[24:27], v[232:235], v[76:79]
    ds_read_b64_tr_b16 v[44:45], v8 offset:18432
    ds_read_b64_tr_b16 v[46:47], v8 offset:19200
    v_mfma_f32_16x16x32_bf16 v[80:83], v[28:31], v[152:155], v[80:83]
    v_mfma_f32_16x16x32_bf16 v[84:87], v[28:31], v[232:235], v[84:87]
    ds_read_b64_tr_b16 v[48:49], v9 offset:12288
    ds_read_b64_tr_b16 v[50:51], v9 offset:12800
    v_mfma_f32_16x16x32_bf16 v[88:91], v[32:35], v[152:155], v[88:91]
    v_mfma_f32_16x16x32_bf16 v[92:95], v[32:35], v[232:235], v[92:95]
    ds_read_b64_tr_b16 v[52:53], v10 offset:12288
    ds_read_b64_tr_b16 v[54:55], v10 offset:12800
    s_waitcnt lgkmcnt(0)
    s_waitcnt vmcnt(0)
    s_barrier
    v_subrev_u32 v6, 81920, v6
    v_subrev_u32 v7, 81920, v7
    v_subrev_u32 v8, 81920, v8
    v_subrev_u32 v9, 81920, v9
    v_subrev_u32 v10, 81920, v10
    v_mfma_f32_16x16x32_bf16 v[56:59], v[36:39], v[156:159], v[56:59]
    v_mfma_f32_16x16x32_bf16 v[60:63], v[36:39], v[236:239], v[60:63]
    ds_read_b64_tr_b16 v[16:17], v6 offset:0
    ds_read_b64_tr_b16 v[18:19], v6 offset:768
    v_mfma_f32_16x16x32_bf16 v[64:67], v[40:43], v[156:159], v[64:67]
    v_mfma_f32_16x16x32_bf16 v[68:71], v[40:43], v[236:239], v[68:71]
    ds_read_b64_tr_b16 v[20:21], v7 offset:0
    ds_read_b64_tr_b16 v[22:23], v7 offset:768
    v_mfma_f32_16x16x32_bf16 v[72:75], v[44:47], v[156:159], v[72:75]
    v_mfma_f32_16x16x32_bf16 v[76:79], v[44:47], v[236:239], v[76:79]
    ds_read_b64_tr_b16 v[24:25], v8 offset:0
    ds_read_b64_tr_b16 v[26:27], v8 offset:768
    v_mfma_f32_16x16x32_bf16 v[80:83], v[48:51], v[156:159], v[80:83]
    v_mfma_f32_16x16x32_bf16 v[84:87], v[48:51], v[236:239], v[84:87]
    ds_read_b64_tr_b16 v[28:29], v9 offset:0
    ds_read_b64_tr_b16 v[30:31], v9 offset:512
    v_mfma_f32_16x16x32_bf16 v[88:91], v[52:55], v[156:159], v[88:91]
    v_mfma_f32_16x16x32_bf16 v[92:95], v[52:55], v[236:239], v[92:95]
    ds_read_b64_tr_b16 v[32:33], v10 offset:0
    ds_read_b64_tr_b16 v[34:35], v10 offset:512
    s_waitcnt lgkmcnt(6)
    v_mfma_f32_16x16x32_bf16 v[56:59], v[16:19], v[160:163], v[56:59]
    v_mfma_f32_16x16x32_bf16 v[60:63], v[16:19], v[240:243], v[60:63]
    ds_read_b64_tr_b16 v[36:37], v6 offset:6144
    ds_read_b64_tr_b16 v[38:39], v6 offset:6912
    v_mfma_f32_16x16x32_bf16 v[64:67], v[20:23], v[160:163], v[64:67]
    v_mfma_f32_16x16x32_bf16 v[68:71], v[20:23], v[240:243], v[68:71]
    ds_read_b64_tr_b16 v[40:41], v7 offset:6144
    ds_read_b64_tr_b16 v[42:43], v7 offset:6912
    s_waitcnt lgkmcnt(4)
    v_mfma_f32_16x16x32_bf16 v[72:75], v[24:27], v[160:163], v[72:75]
    v_mfma_f32_16x16x32_bf16 v[76:79], v[24:27], v[240:243], v[76:79]
    ds_read_b64_tr_b16 v[44:45], v8 offset:6144
    ds_read_b64_tr_b16 v[46:47], v8 offset:6912
    v_mfma_f32_16x16x32_bf16 v[80:83], v[28:31], v[160:163], v[80:83]
    v_mfma_f32_16x16x32_bf16 v[84:87], v[28:31], v[240:243], v[84:87]
    ds_read_b64_tr_b16 v[48:49], v9 offset:4096
    ds_read_b64_tr_b16 v[50:51], v9 offset:4608
    v_mfma_f32_16x16x32_bf16 v[88:91], v[32:35], v[160:163], v[88:91]
    v_mfma_f32_16x16x32_bf16 v[92:95], v[32:35], v[240:243], v[92:95]
    ds_read_b64_tr_b16 v[52:53], v10 offset:4096
    ds_read_b64_tr_b16 v[54:55], v10 offset:4608
    s_waitcnt lgkmcnt(6)
    v_mfma_f32_16x16x32_bf16 v[56:59], v[36:39], v[164:167], v[56:59]
    v_mfma_f32_16x16x32_bf16 v[60:63], v[36:39], v[244:247], v[60:63]
    ds_read_b64_tr_b16 v[16:17], v6 offset:12288
    ds_read_b64_tr_b16 v[18:19], v6 offset:13056
    v_mfma_f32_16x16x32_bf16 v[64:67], v[40:43], v[164:167], v[64:67]
    v_mfma_f32_16x16x32_bf16 v[68:71], v[40:43], v[244:247], v[68:71]
    ds_read_b64_tr_b16 v[20:21], v7 offset:12288
    ds_read_b64_tr_b16 v[22:23], v7 offset:13056
    s_waitcnt lgkmcnt(4)
    v_mfma_f32_16x16x32_bf16 v[72:75], v[44:47], v[164:167], v[72:75]
    v_mfma_f32_16x16x32_bf16 v[76:79], v[44:47], v[244:247], v[76:79]
    ds_read_b64_tr_b16 v[24:25], v8 offset:12288
    ds_read_b64_tr_b16 v[26:27], v8 offset:13056
    v_mfma_f32_16x16x32_bf16 v[80:83], v[48:51], v[164:167], v[80:83]
    v_mfma_f32_16x16x32_bf16 v[84:87], v[48:51], v[244:247], v[84:87]
    ds_read_b64_tr_b16 v[28:29], v9 offset:8192
    ds_read_b64_tr_b16 v[30:31], v9 offset:8704
    v_mfma_f32_16x16x32_bf16 v[88:91], v[52:55], v[164:167], v[88:91]
    v_mfma_f32_16x16x32_bf16 v[92:95], v[52:55], v[244:247], v[92:95]
    ds_read_b64_tr_b16 v[32:33], v10 offset:8192
    ds_read_b64_tr_b16 v[34:35], v10 offset:8704
    s_waitcnt lgkmcnt(6)
    v_mfma_f32_16x16x32_bf16 v[56:59], v[16:19], v[168:171], v[56:59]
    v_mfma_f32_16x16x32_bf16 v[60:63], v[16:19], v[248:251], v[60:63]
    ds_read_b64_tr_b16 v[36:37], v6 offset:18432
    ds_read_b64_tr_b16 v[38:39], v6 offset:19200
    v_mfma_f32_16x16x32_bf16 v[64:67], v[20:23], v[168:171], v[64:67]
    v_mfma_f32_16x16x32_bf16 v[68:71], v[20:23], v[248:251], v[68:71]
    ds_read_b64_tr_b16 v[40:41], v7 offset:18432
    ds_read_b64_tr_b16 v[42:43], v7 offset:19200
    s_waitcnt lgkmcnt(4)
    v_mfma_f32_16x16x32_bf16 v[72:75], v[24:27], v[168:171], v[72:75]
    v_mfma_f32_16x16x32_bf16 v[76:79], v[24:27], v[248:251], v[76:79]
    ds_read_b64_tr_b16 v[44:45], v8 offset:18432
    ds_read_b64_tr_b16 v[46:47], v8 offset:19200
    v_mfma_f32_16x16x32_bf16 v[80:83], v[28:31], v[168:171], v[80:83]
    v_mfma_f32_16x16x32_bf16 v[84:87], v[28:31], v[248:251], v[84:87]
    ds_read_b64_tr_b16 v[48:49], v9 offset:12288
    ds_read_b64_tr_b16 v[50:51], v9 offset:12800
    v_mfma_f32_16x16x32_bf16 v[88:91], v[32:35], v[168:171], v[88:91]
    v_mfma_f32_16x16x32_bf16 v[92:95], v[32:35], v[248:251], v[92:95]
    ds_read_b64_tr_b16 v[52:53], v10 offset:12288
    ds_read_b64_tr_b16 v[54:55], v10 offset:12800
    s_waitcnt lgkmcnt(6)
    v_mfma_f32_16x16x32_bf16 v[56:59], v[36:39], v[172:175], v[56:59]
    v_mfma_f32_16x16x32_bf16 v[60:63], v[36:39], v[252:255], v[60:63]
    v_mfma_f32_16x16x32_bf16 v[64:67], v[40:43], v[172:175], v[64:67]
    v_mfma_f32_16x16x32_bf16 v[68:71], v[40:43], v[252:255], v[68:71]
    s_waitcnt lgkmcnt(0)
    v_mfma_f32_16x16x32_bf16 v[72:75], v[44:47], v[172:175], v[72:75]
    v_mfma_f32_16x16x32_bf16 v[76:79], v[44:47], v[252:255], v[76:79]
    v_mfma_f32_16x16x32_bf16 v[80:83], v[48:51], v[172:175], v[80:83]
    v_mfma_f32_16x16x32_bf16 v[84:87], v[48:51], v[252:255], v[84:87]
    v_mfma_f32_16x16x32_bf16 v[88:91], v[52:55], v[172:175], v[88:91]
    v_mfma_f32_16x16x32_bf16 v[92:95], v[52:55], v[252:255], v[92:95]
    v_lshlrev_b32 v13, 4, v0
    s_lshr_b32 s52, s39, 4
    s_mul_i32 s52, s52, 49152
    s_add_u32 s52, s52, 12582912
    s_lshl_b32 s55, s36, 11
    s_add_u32 s55, s55, 122880
    v_add_u32 v14, s55, v13
    ds_read_b128 v[48:51], v14 offset:0
    ds_read_b128 v[52:55], v14 offset:1024
    s_waitcnt lgkmcnt(0)
    s_add_u32 s54, s44, s38
    s_add_u32 s54, s54, 4
    s_lshr_b32 s55, s54, 1
    s_lshl_b32 s55, s55, 10
    s_and_b32 s54, s54, 1
    s_lshl_b32 s54, s54, 3
    s_add_u32 s54, s54, s55
    s_add_u32 s54, s54, s52
    s_add_u32 s55, s54, 49152
    v_cvt_pk_bf16_f32 v44, v48, v49
    v_lshlrev_b32 v36, 16, v44
    v_and_b32 v37, 0xffff0000, v44
    v_cvt_pk_bf16_f32 v45, v50, v51
    v_lshlrev_b32 v38, 16, v45
    v_and_b32 v39, 0xffff0000, v45
    v_cvt_pk_bf16_f32 v46, v56, v57
    v_lshlrev_b32 v40, 16, v46
    v_and_b32 v41, 0xffff0000, v46
    v_cvt_pk_bf16_f32 v47, v58, v59
    v_lshlrev_b32 v42, 16, v47
    v_and_b32 v43, 0xffff0000, v47
    v_mul_f32 v44, 0xbfb8aa3b, v36
    v_mul_f32 v45, 0xbfb8aa3b, v37
    v_mul_f32 v46, 0xbfb8aa3b, v38
    v_mul_f32 v47, 0xbfb8aa3b, v39
    v_exp_f32 v44, v44
    v_exp_f32 v45, v45
    v_exp_f32 v46, v46
    v_exp_f32 v47, v47
    v_add_f32 v44, 1.0, v44
    v_add_f32 v45, 1.0, v45
    v_add_f32 v46, 1.0, v46
    v_add_f32 v47, 1.0, v47
    v_rcp_f32 v44, v44
    v_rcp_f32 v45, v45
    v_rcp_f32 v46, v46
    v_rcp_f32 v47, v47
    v_mul_f32 v36, v36, v44
    v_mul_f32 v37, v37, v45
    v_mul_f32 v38, v38, v46
    v_mul_f32 v39, v39, v47
    v_cvt_pk_bf16_f32 v44, v36, v37
    v_lshlrev_b32 v36, 16, v44
    v_and_b32 v37, 0xffff0000, v44
    v_cvt_pk_bf16_f32 v45, v38, v39
    v_lshlrev_b32 v38, 16, v45
    v_and_b32 v39, 0xffff0000, v45
    v_mul_f32 v36, v36, v40
    v_mul_f32 v37, v37, v41
    v_mul_f32 v38, v38, v42
    v_mul_f32 v39, v39, v43
    v_cvt_pk_bf16_f32 v56, v36, v37
    v_cvt_pk_bf16_f32 v57, v38, v39
    buffer_store_dwordx2 v[56:57], v13, s[28:31], s54 offen
    v_cvt_pk_bf16_f32 v44, v52, v53
    v_lshlrev_b32 v36, 16, v44
    v_and_b32 v37, 0xffff0000, v44
    v_cvt_pk_bf16_f32 v45, v54, v55
    v_lshlrev_b32 v38, 16, v45
    v_and_b32 v39, 0xffff0000, v45
    v_cvt_pk_bf16_f32 v46, v60, v61
    v_lshlrev_b32 v40, 16, v46
    v_and_b32 v41, 0xffff0000, v46
    v_cvt_pk_bf16_f32 v47, v62, v63
    v_lshlrev_b32 v42, 16, v47
    v_and_b32 v43, 0xffff0000, v47
    v_mul_f32 v44, 0xbfb8aa3b, v36
    v_mul_f32 v45, 0xbfb8aa3b, v37
    v_mul_f32 v46, 0xbfb8aa3b, v38
    v_mul_f32 v47, 0xbfb8aa3b, v39
    v_exp_f32 v44, v44
    v_exp_f32 v45, v45
    v_exp_f32 v46, v46
    v_exp_f32 v47, v47
    v_add_f32 v44, 1.0, v44
    v_add_f32 v45, 1.0, v45
    v_add_f32 v46, 1.0, v46
    v_add_f32 v47, 1.0, v47
    v_rcp_f32 v44, v44
    v_rcp_f32 v45, v45
    v_rcp_f32 v46, v46
    v_rcp_f32 v47, v47
    v_mul_f32 v36, v36, v44
    v_mul_f32 v37, v37, v45
    v_mul_f32 v38, v38, v46
    v_mul_f32 v39, v39, v47
    v_cvt_pk_bf16_f32 v44, v36, v37
    v_lshlrev_b32 v36, 16, v44
    v_and_b32 v37, 0xffff0000, v44
    v_cvt_pk_bf16_f32 v45, v38, v39
    v_lshlrev_b32 v38, 16, v45
    v_and_b32 v39, 0xffff0000, v45
    v_mul_f32 v36, v36, v40
    v_mul_f32 v37, v37, v41
    v_mul_f32 v38, v38, v42
    v_mul_f32 v39, v39, v43
    v_cvt_pk_bf16_f32 v60, v36, v37
    v_cvt_pk_bf16_f32 v61, v38, v39
    buffer_store_dwordx2 v[60:61], v13, s[28:31], s55 offen
    s_cmp_lt_u32 s45, 10
    s_nop 2
    s_cbranch_scc1 .k1skip_6
    s_lshl_b32 s54, s38, 1
    s_add_u32 s54, s54, s44
    s_add_u32 s54, s54, 6
    s_lshl_b32 s54, s54, 9
    s_add_u32 s54, s54, s52
    s_add_u32 s55, s54, 49152
    v_cvt_pk_bf16_f32 v44, v80, v81
    v_lshlrev_b32 v36, 16, v44
    v_and_b32 v37, 0xffff0000, v44
    v_cvt_pk_bf16_f32 v45, v82, v83
    v_lshlrev_b32 v38, 16, v45
    v_and_b32 v39, 0xffff0000, v45
    v_cvt_pk_bf16_f32 v46, v64, v65
    v_lshlrev_b32 v40, 16, v46
    v_and_b32 v41, 0xffff0000, v46
    v_cvt_pk_bf16_f32 v47, v66, v67
    v_lshlrev_b32 v42, 16, v47
    v_and_b32 v43, 0xffff0000, v47
    v_mul_f32 v44, 0xbfb8aa3b, v36
    v_mul_f32 v45, 0xbfb8aa3b, v37
    v_mul_f32 v46, 0xbfb8aa3b, v38
    v_mul_f32 v47, 0xbfb8aa3b, v39
    v_exp_f32 v44, v44
    v_exp_f32 v45, v45
    v_exp_f32 v46, v46
    v_exp_f32 v47, v47
    v_add_f32 v44, 1.0, v44
    v_add_f32 v45, 1.0, v45
    v_add_f32 v46, 1.0, v46
    v_add_f32 v47, 1.0, v47
    v_rcp_f32 v44, v44
    v_rcp_f32 v45, v45
    v_rcp_f32 v46, v46
    v_rcp_f32 v47, v47
    v_mul_f32 v36, v36, v44
    v_mul_f32 v37, v37, v45
    v_mul_f32 v38, v38, v46
    v_mul_f32 v39, v39, v47
    v_cvt_pk_bf16_f32 v44, v36, v37
    v_lshlrev_b32 v36, 16, v44
    v_and_b32 v37, 0xffff0000, v44
    v_cvt_pk_bf16_f32 v45, v38, v39
    v_lshlrev_b32 v38, 16, v45
    v_and_b32 v39, 0xffff0000, v45
    v_mul_f32 v36, v36, v40
    v_mul_f32 v37, v37, v41
    v_mul_f32 v38, v38, v42
    v_mul_f32 v39, v39, v43
    v_cvt_pk_bf16_f32 v48, v36, v37
    v_cvt_pk_bf16_f32 v49, v38, v39
    v_cvt_pk_bf16_f32 v44, v88, v89
    v_lshlrev_b32 v36, 16, v44
    v_and_b32 v37, 0xffff0000, v44
    v_cvt_pk_bf16_f32 v45, v90, v91
    v_lshlrev_b32 v38, 16, v45
    v_and_b32 v39, 0xffff0000, v45
    v_cvt_pk_bf16_f32 v46, v72, v73
    v_lshlrev_b32 v40, 16, v46
    v_and_b32 v41, 0xffff0000, v46
    v_cvt_pk_bf16_f32 v47, v74, v75
    v_lshlrev_b32 v42, 16, v47
    v_and_b32 v43, 0xffff0000, v47
    v_mul_f32 v44, 0xbfb8aa3b, v36
    v_mul_f32 v45, 0xbfb8aa3b, v37
    v_mul_f32 v46, 0xbfb8aa3b, v38
    v_mul_f32 v47, 0xbfb8aa3b, v39
    v_exp_f32 v44, v44
    v_exp_f32 v45, v45
    v_exp_f32 v46, v46
    v_exp_f32 v47, v47
    v_add_f32 v44, 1.0, v44
    v_add_f32 v45, 1.0, v45
    v_add_f32 v46, 1.0, v46
    v_add_f32 v47, 1.0, v47
    v_rcp_f32 v44, v44
    v_rcp_f32 v45, v45
    v_rcp_f32 v46, v46
    v_rcp_f32 v47, v47
    v_mul_f32 v36, v36, v44
    v_mul_f32 v37, v37, v45
    v_mul_f32 v38, v38, v46
    v_mul_f32 v39, v39, v47
    v_cvt_pk_bf16_f32 v44, v36, v37
    v_lshlrev_b32 v36, 16, v44
    v_and_b32 v37, 0xffff0000, v44
    v_cvt_pk_bf16_f32 v45, v38, v39
    v_lshlrev_b32 v38, 16, v45
    v_and_b32 v39, 0xffff0000, v45
    v_mul_f32 v36, v36, v40
    v_mul_f32 v37, v37, v41
    v_mul_f32 v38, v38, v42
    v_mul_f32 v39, v39, v43
    v_cvt_pk_bf16_f32 v50, v36, v37
    v_cvt_pk_bf16_f32 v51, v38, v39
    buffer_store_dwordx4 v[48:51], v13, s[28:31], s54 offen
    v_cvt_pk_bf16_f32 v44, v84, v85
    v_lshlrev_b32 v36, 16, v44
    v_and_b32 v37, 0xffff0000, v44
    v_cvt_pk_bf16_f32 v45, v86, v87
    v_lshlrev_b32 v38, 16, v45
    v_and_b32 v39, 0xffff0000, v45
    v_cvt_pk_bf16_f32 v46, v68, v69
    v_lshlrev_b32 v40, 16, v46
    v_and_b32 v41, 0xffff0000, v46
    v_cvt_pk_bf16_f32 v47, v70, v71
    v_lshlrev_b32 v42, 16, v47
    v_and_b32 v43, 0xffff0000, v47
    v_mul_f32 v44, 0xbfb8aa3b, v36
    v_mul_f32 v45, 0xbfb8aa3b, v37
    v_mul_f32 v46, 0xbfb8aa3b, v38
    v_mul_f32 v47, 0xbfb8aa3b, v39
    v_exp_f32 v44, v44
    v_exp_f32 v45, v45
    v_exp_f32 v46, v46
    v_exp_f32 v47, v47
    v_add_f32 v44, 1.0, v44
    v_add_f32 v45, 1.0, v45
    v_add_f32 v46, 1.0, v46
    v_add_f32 v47, 1.0, v47
    v_rcp_f32 v44, v44
    v_rcp_f32 v45, v45
    v_rcp_f32 v46, v46
    v_rcp_f32 v47, v47
    v_mul_f32 v36, v36, v44
    v_mul_f32 v37, v37, v45
    v_mul_f32 v38, v38, v46
    v_mul_f32 v39, v39, v47
    v_cvt_pk_bf16_f32 v44, v36, v37
    v_lshlrev_b32 v36, 16, v44
    v_and_b32 v37, 0xffff0000, v44
    v_cvt_pk_bf16_f32 v45, v38, v39
    v_lshlrev_b32 v38, 16, v45
    v_and_b32 v39, 0xffff0000, v45
    v_mul_f32 v36, v36, v40
    v_mul_f32 v37, v37, v41
    v_mul_f32 v38, v38, v42
    v_mul_f32 v39, v39, v43
    v_cvt_pk_bf16_f32 v52, v36, v37
    v_cvt_pk_bf16_f32 v53, v38, v39
    v_cvt_pk_bf16_f32 v44, v92, v93
    v_lshlrev_b32 v36, 16, v44
    v_and_b32 v37, 0xffff0000, v44
    v_cvt_pk_bf16_f32 v45, v94, v95
    v_lshlrev_b32 v38, 16, v45
    v_and_b32 v39, 0xffff0000, v45
    v_cvt_pk_bf16_f32 v46, v76, v77
    v_lshlrev_b32 v40, 16, v46
    v_and_b32 v41, 0xffff0000, v46
    v_cvt_pk_bf16_f32 v47, v78, v79
    v_lshlrev_b32 v42, 16, v47
    v_and_b32 v43, 0xffff0000, v47
    v_mul_f32 v44, 0xbfb8aa3b, v36
    v_mul_f32 v45, 0xbfb8aa3b, v37
    v_mul_f32 v46, 0xbfb8aa3b, v38
    v_mul_f32 v47, 0xbfb8aa3b, v39
    v_exp_f32 v44, v44
    v_exp_f32 v45, v45
    v_exp_f32 v46, v46
    v_exp_f32 v47, v47
    v_add_f32 v44, 1.0, v44
    v_add_f32 v45, 1.0, v45
    v_add_f32 v46, 1.0, v46
    v_add_f32 v47, 1.0, v47
    v_rcp_f32 v44, v44
    v_rcp_f32 v45, v45
    v_rcp_f32 v46, v46
    v_rcp_f32 v47, v47
    v_mul_f32 v36, v36, v44
    v_mul_f32 v37, v37, v45
    v_mul_f32 v38, v38, v46
    v_mul_f32 v39, v39, v47
    v_cvt_pk_bf16_f32 v44, v36, v37
    v_lshlrev_b32 v36, 16, v44
    v_and_b32 v37, 0xffff0000, v44
    v_cvt_pk_bf16_f32 v45, v38, v39
    v_lshlrev_b32 v38, 16, v45
    v_and_b32 v39, 0xffff0000, v45
    v_mul_f32 v36, v36, v40
    v_mul_f32 v37, v37, v41
    v_mul_f32 v38, v38, v42
    v_mul_f32 v39, v39, v43
    v_cvt_pk_bf16_f32 v54, v36, v37
    v_cvt_pk_bf16_f32 v55, v38, v39
    buffer_store_dwordx4 v[52:55], v13, s[28:31], s55 offen
    s_nop 3
.k1skip_6:
.k1_end:
    s_endpgm
.globl k2_kernel
.p2align 8
.type k2_kernel,@function
k2_kernel:
    s_cmp_ge_u32 s2, 512
    s_nop 0
    s_cbranch_scc1 .k2_end
    s_cmp_ge_u32 s2, 256
    s_nop 0
    s_cbranch_scc1 .k2_gemm
    s_setprio 3
    s_load_dwordx2 s[12:13], s[0:1], 72
    s_load_dwordx2 s[10:11], s[0:1], 64
    s_and_b32 s32, s2, 7
    s_lshr_b32 s33, s2, 3
    s_lshl_b32 s34, s32, 2
    s_and_b32 s35, s33, 3
    s_add_u32 s34, s34, s35
    s_lshr_b32 s35, s33, 2
    v_lshrrev_b32 v1, 6, v0
    s_nop 0
    v_readfirstlane_b32 s36, v1
    v_and_b32 v0, 63, v0
    v_and_b32 v1, 15, v0
    v_lshrrev_b32 v2, 4, v0
    v_lshlrev_b32 v3, 4, v0
    s_lshl_b32 s37, s35, 3
    s_add_u32 s37, s37, s36
    s_lshl_b32 s37, s37, 5
    s_waitcnt lgkmcnt(0)
    s_mul_i32 s38, s34, 81920
    s_add_u32 s39, s38, 0
    s_add_u32 s16, s12, s39
    s_addc_u32 s17, s13, 0
    s_and_b32 s17, s17, 0xffff
    s_mov_b32 s18, 81920
    s_mov_b32 s19, 0x00020000
    s_add_u32 s39, s38, 4194304
    s_add_u32 s20, s12, s39
    s_addc_u32 s21, s13, 0
    s_and_b32 s21, s21, 0xffff
    s_mov_b32 s22, 81920
    s_mov_b32 s23, 0x00020000
    s_add_u32 s39, s38, 8388608
    s_add_u32 s24, s12, s39
    s_addc_u32 s25, s13, 0
    s_and_b32 s25, s25, 0xffff
    s_mov_b32 s26, 81920
    s_mov_b32 s27, 0x00020000
    s_mov_b32 s28, s12
    s_and_b32 s29, s13, 0xffff
    s_mov_b32 s30, 0x19b1000
    s_mov_b32 s31, 0x00020000
    s_mul_i32 s43, s35, 10240
    s_mul_i32 s44, s36, 1280
    s_add_u32 s45, s43, s44
    v_add_u32 v10, s45, v3
    v_add_u32 v11, 1024, v10
    s_mov_b32 m0, s44
    s_nop 0
    buffer_load_dwordx4 v10, s[16:19], 0 offen lds
    s_add_u32 m0, s44, 1024
    s_mov_b64 exec, 0xffff
    buffer_load_dwordx4 v11, s[16:19], 0 offen lds
    s_mov_b64 exec, -1
    s_mul_i32 s44, s36, 2560
    s_sub_u32 s45, s43, 10240
    s_add_u32 s45, s45, s44
    v_add_u32 v10, s45, v3
    v_add_u32 v11, 0, v10
    s_add_u32 m0, s44, 10240
    s_nop 0
    buffer_load_dwordx4 v11, s[20:23], 0 offen lds
    s_add_u32 m0, s44, 30720
    s_nop 0
    buffer_load_dwordx4 v11, s[24:27], 0 offen lds
    v_add_u32 v11, 1024, v10
    s_add_u32 m0, s44, 11264
    s_nop 0
    buffer_load_dwordx4 v11, s[20:23], 0 offen lds
    s_add_u32 m0, s44, 31744
    s_nop 0
    buffer_load_dwordx4 v11, s[24:27], 0 offen lds
    v_add_u32 v11, 2048, v10
    s_mov_b64 exec, 0xffffffff
    s_add_u32 m0, s44, 12288
    s_nop 0
    buffer_load_dwordx4 v11, s[20:23], 0 offen lds
    s_add_u32 m0, s44, 32768
    s_nop 0
    buffer_load_dwordx4 v11, s[24:27], 0 offen lds
    s_mov_b64 exec, -1
    v_lshlrev_b32 v4, 2, v2
    v_add_u32 v5, 0, v4
    v_cmp_gt_u32 s[48:49], v5, v1
    v_cmp_le_u32 s[56:57], v5, v1
    v_add_u32 v5, 1, v4
    v_cmp_gt_u32 s[50:51], v5, v1
    v_cmp_le_u32 s[58:59], v5, v1
    v_add_u32 v5, 2, v4
    v_cmp_gt_u32 s[52:53], v5, v1
    v_cmp_le_u32 s[60:61], v5, v1
    v_add_u32 v5, 3, v4
    v_cmp_gt_u32 s[54:55], v5, v1
    v_cmp_le_u32 s[62:63], v5, v1
    v_mov_b32 v15, 0xf149f2ca
    v_cmp_eq_u32 s[66:67], 4, v1
    v_mov_b32 v14, 0x3f803f80
    v_cmp_eq_u32 s[64:65], 0, v2
    v_xor_b32 v5, 16, v0
    v_lshlrev_b32 v5, 2, v5
    v_xor_b32 v6, 32, v0
    v_lshlrev_b32 v6, 2, v6
    v_add_u32 v7, 16, v1
    v_lshlrev_b32 v7, 2, v7
    s_mul_i32 s39, s34, 5
    v_add_u32 v8, s39, v2
    v_lshrrev_b32 v10, 3, v8
    v_lshlrev_b32 v10, 10, v10
    v_and_b32 v11, 3, v8
    v_lshl_add_u32 v10, v11, 8, v10
    v_bfe_u32 v11, v8, 2, 1
    v_lshl_add_u32 v8, v11, 3, v10
    s_add_u32 s39, s39, 4
    v_mov_b32 v9, s39
    v_lshrrev_b32 v10, 3, v9
    v_lshlrev_b32 v10, 10, v10
    v_and_b32 v11, 3, v9
    v_lshl_add_u32 v10, v11, 8, v10
    v_bfe_u32 v11, v9, 2, 1
    v_lshl_add_u32 v9, v11, 3, v10
    v_mov_b32 v10, 0x40000000
    v_cndmask_b32 v9, v10, v9, s[64:65]
    v_lshlrev_b32 v10, 4, v1
    v_add_u32 v8, v8, v10
    v_add_u32 v9, v9, v10
    s_mov_b32 s40, 0x3ea52b5c
    s_mul_i32 s46, s36, 1280
    v_lshlrev_b32 v4, 3, v0
    v_add_u32 v4, s46, v4
    v_lshlrev_b32 v13, 3, v1
    v_add_u32 v13, s46, v13
    v_add_u32 v13, 512, v13
    v_add_u32 v12, s46, v3
    v_add_u32 v12, 30720, v12
    v_and_b32 v3, 3, v1
    v_lshl_add_u32 v3, v2, 2, v3
    v_lshlrev_b32 v3, 4, v3
    v_add_u32 v3, s46, v3
    v_add_u32 v3, 31744, v3
    v_mov_b32 v2, v12
    s_mul_i32 s43, s37, 1280
    s_add_u32 s43, s43, 18874368
    s_sub_u32 s47, 256, s37
    s_lshr_b32 s47, s47, 4
    s_waitcnt vmcnt(0)
    s_barrier
    s_mov_b32 s42, 0
    s_mov_b32 s41, 0
    s_nop 0
.aloop_7:
    v_add_u32 v10, s41, v4
    v_add_u32 v11, s41, v13
    ds_read_b64 v[16:17], v10
    ds_read_b64 v[18:19], v11
    ds_read_b64 v[100:101], v4 offset:10240
    ds_read_b64 v[102:103], v13 offset:10240
    ds_read_b64 v[104:105], v4 offset:10880
    ds_read_b64 v[106:107], v13 offset:10880
    ds_read_b64 v[108:109], v4 offset:11520
    ds_read_b64 v[110:111], v13 offset:11520
    ds_read_b64 v[112:113], v4 offset:12160
    ds_read_b64 v[114:115], v13 offset:12160
    ds_read_b64 v[116:117], v4 offset:12800
    ds_read_b64 v[118:119], v13 offset:12800
    s_waitcnt lgkmcnt(10)
    v_cndmask_b32 v18, 0, v18, s[64:65]
    v_cndmask_b32 v19, 0, v19, s[64:65]
    s_waitcnt lgkmcnt(8)
    s_nop 0
    v_mfma_f32_16x16x32_bf16 v[28:31], v[100:103], v[16:19], 0
    ds_read_b64 v[120:121], v4 offset:13440
    ds_read_b64 v[122:123], v13 offset:13440
    s_waitcnt lgkmcnt(8)
    v_mfma_f32_16x16x32_bf16 v[32:35], v[104:107], v[16:19], 0
    ds_read_b64 v[100:101], v4 offset:14080
    ds_read_b64 v[102:103], v13 offset:14080
    s_waitcnt lgkmcnt(8)
    v_mfma_f32_16x16x32_bf16 v[36:39], v[108:111], v[16:19], 0
    ds_read_b64 v[104:105], v4 offset:14720
    ds_read_b64 v[106:107], v13 offset:14720
    s_waitcnt lgkmcnt(8)
    v_mfma_f32_16x16x32_bf16 v[40:43], v[112:115], v[16:19], 0
    ds_read_b64 v[108:109], v4 offset:15360
    ds_read_b64 v[110:111], v13 offset:15360
    s_waitcnt lgkmcnt(8)
    v_mfma_f32_16x16x32_bf16 v[44:47], v[116:119], v[16:19], 0
    ds_read_b64 v[112:113], v4 offset:16000
    ds_read_b64 v[114:115], v13 offset:16000
    s_waitcnt lgkmcnt(8)
    v_mfma_f32_16x16x32_bf16 v[48:51], v[120:123], v[16:19], 0
    ds_read_b64 v[116:117], v4 offset:16640
    ds_read_b64 v[118:119], v13 offset:16640
    s_waitcnt lgkmcnt(8)
    v_mfma_f32_16x16x32_bf16 v[52:55], v[100:103], v[16:19], 0
    ds_read_b64 v[120:121], v4 offset:17280
    ds_read_b64 v[122:123], v13 offset:17280
    s_waitcnt lgkmcnt(8)
    v_mfma_f32_16x16x32_bf16 v[56:59], v[104:107], v[16:19], 0
    ds_read_b64 v[100:101], v4 offset:17920
    ds_read_b64 v[102:103], v13 offset:17920
    s_waitcnt lgkmcnt(8)
    v_mfma_f32_16x16x32_bf16 v[60:63], v[108:111], v[16:19], 0
    ds_read_b64 v[104:105], v4 offset:18560
    ds_read_b64 v[106:107], v13 offset:18560
    s_waitcnt lgkmcnt(8)
    v_mfma_f32_16x16x32_bf16 v[64:67], v[112:115], v[16:19], 0
    ds_read_b64 v[108:109], v4 offset:19200
    ds_read_b64 v[110:111], v13 offset:19200
    s_waitcnt lgkmcnt(8)
    v_mfma_f32_16x16x32_bf16 v[68:71], v[116:119], v[16:19], 0
    ds_read_b64 v[112:113], v4 offset:19840
    ds_read_b64 v[114:115], v13 offset:19840
    s_waitcnt lgkmcnt(8)
    v_mfma_f32_16x16x32_bf16 v[72:75], v[120:123], v[16:19], 0
    ds_read_b64 v[116:117], v4 offset:20480
    ds_read_b64 v[118:119], v13 offset:20480
    s_waitcnt lgkmcnt(8)
    v_mfma_f32_16x16x32_bf16 v[76:79], v[100:103], v[16:19], 0
    ds_read_b64 v[120:121], v4 offset:21120
    ds_read_b64 v[122:123], v13 offset:21120
    s_waitcnt lgkmcnt(8)
    v_mfma_f32_16x16x32_bf16 v[80:83], v[104:107], v[16:19], 0
    s_waitcnt lgkmcnt(6)
    v_mfma_f32_16x16x32_bf16 v[84:87], v[108:111], v[16:19], 0
    s_waitcnt lgkmcnt(4)
    v_mfma_f32_16x16x32_bf16 v[88:91], v[112:115], v[16:19], 0
    s_waitcnt lgkmcnt(2)
    v_mfma_f32_16x16x32_bf16 v[92:95], v[116:119], v[16:19], 0
    s_waitcnt lgkmcnt(0)
    v_mfma_f32_16x16x32_bf16 v[96:99], v[120:123], v[16:19], 0
    ds_read_b128 v[100:103], v2 offset:0
    ds_read_b128 v[104:107], v3 offset:0
    ds_read_b128 v[108:111], v2 offset:1280
    ds_read_b128 v[112:115], v3 offset:1280
    s_cmp_eq_u32 s42, 0
    s_cselect_b64 s[44:45], s[48:49], 0
    v_cndmask_b32 v28, v15, v28, s[44:45]
    s_cselect_b64 s[44:45], s[50:51], 0
    v_cndmask_b32 v29, v15, v29, s[44:45]
    s_cselect_b64 s[44:45], s[52:53], 0
    v_cndmask_b32 v30, v15, v30, s[44:45]
    s_cselect_b64 s[44:45], s[54:55], 0
    v_cndmask_b32 v31, v15, v31, s[44:45]
    s_cselect_b64 s[44:45], -1, s[48:49]
    v_cndmask_b32 v32, v15, v32, s[44:45]
    s_cselect_b64 s[44:45], -1, s[50:51]
    v_cndmask_b32 v33, v15, v33, s[44:45]
    s_cselect_b64 s[44:45], -1, s[52:53]
    v_cndmask_b32 v34, v15, v34, s[44:45]
    s_cselect_b64 s[44:45], -1, s[54:55]
    v_cndmask_b32 v35, v15, v35, s[44:45]
    s_cselect_b64 s[44:45], s[56:57], -1
    v_cndmask_b32 v92, v15, v92, s[44:45]
    s_cselect_b64 s[44:45], s[58:59], -1
    v_cndmask_b32 v93, v15, v93, s[44:45]
    s_cselect_b64 s[44:45], s[60:61], -1
    v_cndmask_b32 v94, v15, v94, s[44:45]
    s_cselect_b64 s[44:45], s[62:63], -1
    v_cndmask_b32 v95, v15, v95, s[44:45]
    s_cselect_b64 s[44:45], 0, s[56:57]
    v_cndmask_b32 v96, v15, v96, s[44:45]
    s_cselect_b64 s[44:45], 0, s[58:59]
    v_cndmask_b32 v97, v15, v97, s[44:45]
    s_cselect_b64 s[44:45], 0, s[60:61]
    v_cndmask_b32 v98, v15, v98, s[44:45]
    s_cselect_b64 s[44:45], 0, s[62:63]
    v_cndmask_b32 v99, v15, v99, s[44:45]
    s_cmp_ge_u32 s37, 256
    s_nop 3
    s_cbranch_scc1 .noneg_8
    s_cmp_le_u32 s47, 0
    s_nop 0
    s_cbranch_scc1 .noneg_8
    v_mov_b32 v28, v15
    v_mov_b32 v29, v15
    v_mov_b32 v30, v15
    v_mov_b32 v31, v15
    s_cmp_le_u32 s47, 1
    s_nop 3
    s_cbranch_scc1 .noneg_8
    v_mov_b32 v32, v15
    v_mov_b32 v33, v15
    v_mov_b32 v34, v15
    v_mov_b32 v35, v15
    s_cmp_le_u32 s47, 2
    s_nop 3
    s_cbranch_scc1 .noneg_8
    v_mov_b32 v36, v15
    v_mov_b32 v37, v15
    v_mov_b32 v38, v15
    v_mov_b32 v39, v15
    s_cmp_le_u32 s47, 3
    s_nop 3
    s_cbranch_scc1 .noneg_8
    v_mov_b32 v40, v15
    v_mov_b32 v41, v15
    v_mov_b32 v42, v15
    v_mov_b32 v43, v15
    s_cmp_le_u32 s47, 4
    s_nop 3
    s_cbranch_scc1 .noneg_8
    v_mov_b32 v44, v15
    v_mov_b32 v45, v15
    v_mov_b32 v46, v15
    v_mov_b32 v47, v15
    s_cmp_le_u32 s47, 5
    s_nop 3
    s_cbranch_scc1 .noneg_8
    v_mov_b32 v48, v15
    v_mov_b32 v49, v15
    v_mov_b32 v50, v15
    v_mov_b32 v51, v15
    s_cmp_le_u32 s47, 6
    s_nop 3
    s_cbranch_scc1 .noneg_8
    v_mov_b32 v52, v15
    v_mov_b32 v53, v15
    v_mov_b32 v54, v15
    v_mov_b32 v55, v15
    s_cmp_le_u32 s47, 7
    s_nop 3
    s_cbranch_scc1 .noneg_8
    v_mov_b32 v56, v15
    v_mov_b32 v57, v15
    v_mov_b32 v58, v15
    v_mov_b32 v59, v15
    s_cmp_le_u32 s47, 8
    s_nop 3
    s_cbranch_scc1 .noneg_8
    v_mov_b32 v60, v15
    v_mov_b32 v61, v15
    v_mov_b32 v62, v15
    v_mov_b32 v63, v15
    s_cmp_le_u32 s47, 9
    s_nop 3
    s_cbranch_scc1 .noneg_8
    v_mov_b32 v64, v15
    v_mov_b32 v65, v15
    v_mov_b32 v66, v15
    v_mov_b32 v67, v15
    s_cmp_le_u32 s47, 10
    s_nop 3
    s_cbranch_scc1 .noneg_8
    v_mov_b32 v68, v15
    v_mov_b32 v69, v15
    v_mov_b32 v70, v15
    v_mov_b32 v71, v15
    s_cmp_le_u32 s47, 11
    s_nop 3
    s_cbranch_scc1 .noneg_8
    v_mov_b32 v72, v15
    v_mov_b32 v73, v15
    v_mov_b32 v74, v15
    v_mov_b32 v75, v15
    s_cmp_le_u32 s47, 12
    s_nop 3
    s_cbranch_scc1 .noneg_8
    v_mov_b32 v76, v15
    v_mov_b32 v77, v15
    v_mov_b32 v78, v15
    v_mov_b32 v79, v15
    s_cmp_le_u32 s47, 13
    s_nop 3
    s_cbranch_scc1 .noneg_8
    v_mov_b32 v80, v15
    v_mov_b32 v81, v15
    v_mov_b32 v82, v15
    v_mov_b32 v83, v15
    s_cmp_le_u32 s47, 14
    s_nop 3
    s_cbranch_scc1 .noneg_8
    v_mov_b32 v84, v15
    v_mov_b32 v85, v15
    v_mov_b32 v86, v15
    v_mov_b32 v87, v15
    s_cmp_le_u32 s47, 15
    s_nop 3
    s_cbranch_scc1 .noneg_8
    v_mov_b32 v88, v15
    v_mov_b32 v89, v15
    v_mov_b32 v90, v15
    v_mov_b32 v91, v15
    s_nop 4
.noneg_8:
    v_max3_f32 v10, v28, v29, v30
    v_max3_f32 v11, v31, v32, v33
    v_max3_f32 v10, v10, v34, v35
    v_max3_f32 v11, v11, v36, v37
    v_max3_f32 v10, v10, v38, v39
    v_max3_f32 v11, v11, v40, v41
    v_max3_f32 v10, v10, v42, v43
    v_max3_f32 v11, v11, v44, v45
    v_max3_f32 v10, v10, v46, v47
    v_max3_f32 v11, v11, v48, v49
    v_max3_f32 v10, v10, v50, v51
    v_max3_f32 v11, v11, v52, v53
    v_max3_f32 v10, v10, v54, v55
    v_max3_f32 v11, v11, v56, v57
    v_max3_f32 v10, v10, v58, v59
    v_max3_f32 v11, v11, v60, v61
    v_max3_f32 v10, v10, v62, v63
    v_max3_f32 v11, v11, v64, v65
    v_max3_f32 v10, v10, v66, v67
    v_max3_f32 v11, v11, v68, v69
    v_max3_f32 v10, v10, v70, v71
    v_max3_f32 v11, v11, v72, v73
    v_max3_f32 v10, v10, v74, v75
    v_max3_f32 v11, v11, v76, v77
    v_max3_f32 v10, v10, v78, v79
    v_max3_f32 v11, v11, v80, v81
    v_max3_f32 v10, v10, v82, v83
    v_max3_f32 v11, v11, v84, v85
    v_max3_f32 v10, v10, v86, v87
    v_max3_f32 v11, v11, v88, v89
    v_max3_f32 v10, v10, v90, v91
    v_max3_f32 v11, v11, v92, v93
    v_max3_f32 v10, v10, v94, v95
    v_max3_f32 v11, v11, v96, v97
    v_max3_f32 v10, v10, v98, v99
    v_max_f32 v10, v10, v11
    ds_bpermute_b32 v11, v5, v10
    s_waitcnt lgkmcnt(0)
    v_max_f32 v10, v10, v11
    ds_bpermute_b32 v11, v6, v10
    s_waitcnt lgkmcnt(0)
    v_max_f32 v10, v10, v11
    v_mul_f32 v10, s40, v10
    v_sub_f32 v10, 0, v10
    v_mov_b32 v11, v10
    v_mov_b32 v16, s40
    v_mov_b32 v17, s40
    v_fma_f32 v28, v28, v16, v10
    v_fma_f32 v29, v29, v16, v10
    v_fma_f32 v30, v30, v16, v10
    v_fma_f32 v31, v31, v16, v10
    v_exp_f32 v28, v28
    v_exp_f32 v29, v29
    v_exp_f32 v30, v30
    v_exp_f32 v31, v31
    v_fma_f32 v32, v32, v16, v10
    v_fma_f32 v33, v33, v16, v10
    v_fma_f32 v34, v34, v16, v10
    v_fma_f32 v35, v35, v16, v10
    v_exp_f32 v32, v32
    v_exp_f32 v33, v33
    v_exp_f32 v34, v34
    v_exp_f32 v35, v35
    v_cvt_pk_bf16_f32 v28, v28, v29
    v_cvt_pk_bf16_f32 v29, v30, v31
    v_cvt_pk_bf16_f32 v30, v32, v33
    v_cvt_pk_bf16_f32 v31, v34, v35
    v_fma_f32 v36, v36, v16, v10
    v_fma_f32 v37, v37, v16, v10
    v_fma_f32 v38, v38, v16, v10
    v_fma_f32 v39, v39, v16, v10
    v_exp_f32 v36, v36
    v_exp_f32 v37, v37
    v_exp_f32 v38, v38
    v_exp_f32 v39, v39
    v_fma_f32 v40, v40, v16, v10
    v_fma_f32 v41, v41, v16, v10
    v_fma_f32 v42, v42, v16, v10
    v_fma_f32 v43, v43, v16, v10
    v_exp_f32 v40, v40
    v_exp_f32 v41, v41
    v_exp_f32 v42, v42
    v_exp_f32 v43, v43
    v_cvt_pk_bf16_f32 v36, v36, v37
    v_cvt_pk_bf16_f32 v37, v38, v39
    v_cvt_pk_bf16_f32 v38, v40, v41
    v_cvt_pk_bf16_f32 v39, v42, v43
    v_fma_f32 v44, v44, v16, v10
    v_fma_f32 v45, v45, v16, v10
    v_fma_f32 v46, v46, v16, v10
    v_fma_f32 v47, v47, v16, v10
    v_exp_f32 v44, v44
    v_exp_f32 v45, v45
    v_exp_f32 v46, v46
    v_exp_f32 v47, v47
    v_fma_f32 v48, v48, v16, v10
    v_fma_f32 v49, v49, v16, v10
    v_fma_f32 v50, v50, v16, v10
    v_fma_f32 v51, v51, v16, v10
    v_exp_f32 v48, v48
    v_exp_f32 v49, v49
    v_exp_f32 v50, v50
    v_exp_f32 v51, v51
    v_cvt_pk_bf16_f32 v44, v44, v45
    v_cvt_pk_bf16_f32 v45, v46, v47
    v_cvt_pk_bf16_f32 v46, v48, v49
    v_cvt_pk_bf16_f32 v47, v50, v51
    v_fma_f32 v52, v52, v16, v10
    v_fma_f32 v53, v53, v16, v10
    v_fma_f32 v54, v54, v16, v10
    v_fma_f32 v55, v55, v16, v10
    v_exp_f32 v52, v52
    v_exp_f32 v53, v53
    v_exp_f32 v54, v54
    v_exp_f32 v55, v55
    v_fma_f32 v56, v56, v16, v10
    v_fma_f32 v57, v57, v16, v10
    v_fma_f32 v58, v58, v16, v10
    v_fma_f32 v59, v59, v16, v10
    v_exp_f32 v56, v56
    v_exp_f32 v57, v57
    v_exp_f32 v58, v58
    v_exp_f32 v59, v59
    v_cvt_pk_bf16_f32 v52, v52, v53
    v_cvt_pk_bf16_f32 v53, v54, v55
    v_cvt_pk_bf16_f32 v54, v56, v57
    v_cvt_pk_bf16_f32 v55, v58, v59
    v_fma_f32 v60, v60, v16, v10
    v_fma_f32 v61, v61, v16, v10
    v_fma_f32 v62, v62, v16, v10
    v_fma_f32 v63, v63, v16, v10
    v_exp_f32 v60, v60
    v_exp_f32 v61, v61
    v_exp_f32 v62, v62
    v_exp_f32 v63, v63
    v_fma_f32 v64, v64, v16, v10
    v_fma_f32 v65, v65, v16, v10
    v_fma_f32 v66, v66, v16, v10
    v_fma_f32 v67, v67, v16, v10
    v_exp_f32 v64, v64
    v_exp_f32 v65, v65
    v_exp_f32 v66, v66
    v_exp_f32 v67, v67
    v_cvt_pk_bf16_f32 v60, v60, v61
    v_cvt_pk_bf16_f32 v61, v62, v63
    v_cvt_pk_bf16_f32 v62, v64, v65
    v_cvt_pk_bf16_f32 v63, v66, v67
    v_fma_f32 v68, v68, v16, v10
    v_fma_f32 v69, v69, v16, v10
    v_fma_f32 v70, v70, v16, v10
    v_fma_f32 v71, v71, v16, v10
    v_exp_f32 v68, v68
    v_exp_f32 v69, v69
    v_exp_f32 v70, v70
    v_exp_f32 v71, v71
    v_fma_f32 v72, v72, v16, v10
    v_fma_f32 v73, v73, v16, v10
    v_fma_f32 v74, v74, v16, v10
    v_fma_f32 v75, v75, v16, v10
    v_exp_f32 v72, v72
    v_exp_f32 v73, v73
    v_exp_f32 v74, v74
    v_exp_f32 v75, v75
    v_cvt_pk_bf16_f32 v68, v68, v69
    v_cvt_pk_bf16_f32 v69, v70, v71
    v_cvt_pk_bf16_f32 v70, v72, v73
    v_cvt_pk_bf16_f32 v71, v74, v75
    v_fma_f32 v76, v76, v16, v10
    v_fma_f32 v77, v77, v16, v10
    v_fma_f32 v78, v78, v16, v10
    v_fma_f32 v79, v79, v16, v10
    v_exp_f32 v76, v76
    v_exp_f32 v77, v77
    v_exp_f32 v78, v78
    v_exp_f32 v79, v79
    v_fma_f32 v80, v80, v16, v10
    v_fma_f32 v81, v81, v16, v10
    v_fma_f32 v82, v82, v16, v10
    v_fma_f32 v83, v83, v16, v10
    v_exp_f32 v80, v80
    v_exp_f32 v81, v81
    v_exp_f32 v82, v82
    v_exp_f32 v83, v83
    v_cvt_pk_bf16_f32 v76, v76, v77
    v_cvt_pk_bf16_f32 v77, v78, v79
    v_cvt_pk_bf16_f32 v78, v80, v81
    v_cvt_pk_bf16_f32 v79, v82, v83
    v_fma_f32 v84, v84, v16, v10
    v_fma_f32 v85, v85, v16, v10
    v_fma_f32 v86, v86, v16, v10
    v_fma_f32 v87, v87, v16, v10
    v_exp_f32 v84, v84
    v_exp_f32 v85, v85
    v_exp_f32 v86, v86
    v_exp_f32 v87, v87
    v_fma_f32 v88, v88, v16, v10
    v_fma_f32 v89, v89, v16, v10
    v_fma_f32 v90, v90, v16, v10
    v_fma_f32 v91, v91, v16, v10
    v_exp_f32 v88, v88
    v_exp_f32 v89, v89
    v_exp_f32 v90, v90
    v_exp_f32 v91, v91
    v_cvt_pk_bf16_f32 v84, v84, v85
    v_cvt_pk_bf16_f32 v85, v86, v87
    v_cvt_pk_bf16_f32 v86, v88, v89
    v_cvt_pk_bf16_f32 v87, v90, v91
    v_fma_f32 v92, v92, v16, v10
    v_fma_f32 v93, v93, v16, v10
    v_fma_f32 v94, v94, v16, v10
    v_fma_f32 v95, v95, v16, v10
    v_exp_f32 v92, v92
    v_exp_f32 v93, v93
    v_exp_f32 v94, v94
    v_exp_f32 v95, v95
    v_fma_f32 v96, v96, v16, v10
    v_fma_f32 v97, v97, v16, v10
    v_fma_f32 v98, v98, v16, v10
    v_fma_f32 v99, v99, v16, v10
    v_exp_f32 v96, v96
    v_exp_f32 v97, v97
    v_exp_f32 v98, v98
    v_exp_f32 v99, v99
    v_cvt_pk_bf16_f32 v92, v92, v93
    v_cvt_pk_bf16_f32 v93, v94, v95
    v_cvt_pk_bf16_f32 v94, v96, v97
    v_cvt_pk_bf16_f32 v95, v98, v99
    v_cndmask_b32 v104, v104, v14, s[66:67]
    v_cndmask_b32 v105, v105, v14, s[66:67]
    v_cndmask_b32 v106, v106, v14, s[66:67]
    v_cndmask_b32 v107, v107, v14, s[66:67]
    v_mfma_f32_16x16x32_bf16 v[20:23], v[100:103], v[28:31], 0
    s_nop 0
    v_mfma_f32_16x16x32_bf16 v[24:27], v[104:107], v[28:31], 0
    ds_read_b128 v[116:119], v2 offset:2560
    ds_read_b128 v[120:123], v3 offset:2560
    v_cndmask_b32 v112, v112, v14, s[66:67]
    v_cndmask_b32 v113, v113, v14, s[66:67]
    v_cndmask_b32 v114, v114, v14, s[66:67]
    v_cndmask_b32 v115, v115, v14, s[66:67]
    v_mfma_f32_16x16x32_bf16 v[20:23], v[108:111], v[36:39], v[20:23]
    s_nop 0
    v_mfma_f32_16x16x32_bf16 v[24:27], v[112:115], v[36:39], v[24:27]
    ds_read_b128 v[100:103], v2 offset:3840
    ds_read_b128 v[104:107], v3 offset:3840
    s_waitcnt lgkmcnt(2)
    v_cndmask_b32 v120, v120, v14, s[66:67]
    v_cndmask_b32 v121, v121, v14, s[66:67]
    v_cndmask_b32 v122, v122, v14, s[66:67]
    v_cndmask_b32 v123, v123, v14, s[66:67]
    v_mfma_f32_16x16x32_bf16 v[20:23], v[116:119], v[44:47], v[20:23]
    s_nop 0
    v_mfma_f32_16x16x32_bf16 v[24:27], v[120:123], v[44:47], v[24:27]
    ds_read_b128 v[108:111], v2 offset:5120
    ds_read_b128 v[112:115], v3 offset:5120
    s_waitcnt lgkmcnt(2)
    v_cndmask_b32 v104, v104, v14, s[66:67]
    v_cndmask_b32 v105, v105, v14, s[66:67]
    v_cndmask_b32 v106, v106, v14, s[66:67]
    v_cndmask_b32 v107, v107, v14, s[66:67]
    v_mfma_f32_16x16x32_bf16 v[20:23], v[100:103], v[52:55], v[20:23]
    s_nop 0
    v_mfma_f32_16x16x32_bf16 v[24:27], v[104:107], v[52:55], v[24:27]
    ds_read_b128 v[116:119], v2 offset:6400
    ds_read_b128 v[120:123], v3 offset:6400
    s_waitcnt lgkmcnt(2)
    v_cndmask_b32 v112, v112, v14, s[66:67]
    v_cndmask_b32 v113, v113, v14, s[66:67]
    v_cndmask_b32 v114, v114, v14, s[66:67]
    v_cndmask_b32 v115, v115, v14, s[66:67]
    v_mfma_f32_16x16x32_bf16 v[20:23], v[108:111], v[60:63], v[20:23]
    s_nop 0
    v_mfma_f32_16x16x32_bf16 v[24:27], v[112:115], v[60:63], v[24:27]
    ds_read_b128 v[100:103], v2 offset:7680
    ds_read_b128 v[104:107], v3 offset:7680
    s_waitcnt lgkmcnt(2)
    v_cndmask_b32 v120, v120, v14, s[66:67]
    v_cndmask_b32 v121, v121, v14, s[66:67]
    v_cndmask_b32 v122, v122, v14, s[66:67]
    v_cndmask_b32 v123, v123, v14, s[66:67]
    v_mfma_f32_16x16x32_bf16 v[20:23], v[116:119], v[68:71], v[20:23]
    s_nop 0
    v_mfma_f32_16x16x32_bf16 v[24:27], v[120:123], v[68:71], v[24:27]
    ds_read_b128 v[108:111], v2 offset:8960
    ds_read_b128 v[112:115], v3 offset:8960
    s_waitcnt lgkmcnt(2)
    v_cndmask_b32 v104, v104, v14, s[66:67]
    v_cndmask_b32 v105, v105, v14, s[66:67]
    v_cndmask_b32 v106, v106, v14, s[66:67]
    v_cndmask_b32 v107, v107, v14, s[66:67]
    v_mfma_f32_16x16x32_bf16 v[20:23], v[100:103], v[76:79], v[20:23]
    s_nop 0
    v_mfma_f32_16x16x32_bf16 v[24:27], v[104:107], v[76:79], v[24:27]
    ds_read_b128 v[116:119], v2 offset:10240
    ds_read_b128 v[120:123], v3 offset:10240
    s_waitcnt lgkmcnt(2)
    v_cndmask_b32 v112, v112, v14, s[66:67]
    v_cndmask_b32 v113, v113, v14, s[66:67]
    v_cndmask_b32 v114, v114, v14, s[66:67]
    v_cndmask_b32 v115, v115, v14, s[66:67]
    v_mfma_f32_16x16x32_bf16 v[20:23], v[108:111], v[84:87], v[20:23]
    s_nop 0
    v_mfma_f32_16x16x32_bf16 v[24:27], v[112:115], v[84:87], v[24:27]
    s_waitcnt lgkmcnt(0)
    v_cndmask_b32 v120, v120, v14, s[66:67]
    v_cndmask_b32 v121, v121, v14, s[66:67]
    v_cndmask_b32 v122, v122, v14, s[66:67]
    v_cndmask_b32 v123, v123, v14, s[66:67]
    v_mfma_f32_16x16x32_bf16 v[20:23], v[116:119], v[92:95], v[20:23]
    s_nop 0
    v_mfma_f32_16x16x32_bf16 v[24:27], v[120:123], v[92:95], v[24:27]
    s_nop 7
    ds_bpermute_b32 v10, v7, v24
    s_waitcnt lgkmcnt(0)
    v_rcp_f32 v10, v10
    s_nop 0
    v_mul_f32 v20, v20, v10
    v_mul_f32 v21, v21, v10
    v_mul_f32 v22, v22, v10
    v_mul_f32 v23, v23, v10
    v_cvt_pk_bf16_f32 v16, v20, v21
    v_cvt_pk_bf16_f32 v17, v22, v23
    buffer_store_dwordx2 v[16:17], v8, s[28:31], s43 offen sc1
    v_mul_f32 v24, v24, v10
    v_mul_f32 v25, v25, v10
    v_mul_f32 v26, v26, v10
    v_mul_f32 v27, v27, v10
    v_cvt_pk_bf16_f32 v24, v24, v25
    v_cvt_pk_bf16_f32 v25, v26, v27
    buffer_store_dwordx2 v[24:25], v9, s[28:31], s43 offen sc1
    s_add_u32 s43, s43, 20480
    s_add_u32 s41, s41, 640
    s_add_u32 s42, s42, 1
    s_cmp_lt_u32 s42, 2
    s_nop 0
    s_cbranch_scc1 .aloop_7
    s_waitcnt vmcnt(0)
    s_barrier
    s_cmp_lg_u32 s36, 0
    s_nop 0
    s_cbranch_scc1 .nopub_9
    s_lshl_b32 s44, s35, 8
    s_add_u32 s44, s44, 26935296
    v_mov_b32 v10, 1
    v_mov_b32 v11, 0
    s_mov_b64 exec, 1
    buffer_atomic_add v10, v11, s[28:31], s44 offen sc1
    s_mov_b64 exec, -1
    s_nop 1
.nopub_9:
    s_waitcnt vmcnt(0)
    s_branch .k2_end
.k2_gemm:
    s_sub_u32 s3, s2, 256
    s_load_dwordx2 s[6:7], s[0:1], 0
    s_load_dwordx2 s[8:9], s[0:1], 56
    s_load_dwordx2 s[10:11], s[0:1], 64
    s_load_dwordx2 s[12:13], s[0:1], 72
    s_and_b32 s32, s3, 7
    s_lshr_b32 s33, s3, 3
    s_and_b32 s34, s32, 3
    s_lshl_b32 s34, s34, 3
    s_and_b32 s35, s33, 7
    s_add_u32 s34, s34, s35
    s_lshr_b32 s35, s32, 2
    s_lshl_b32 s35, s35, 2
    s_lshr_b32 s40, s33, 3
    s_add_u32 s35, s35, s40
    v_lshrrev_b32 v9, 6, v0
    s_nop 0
    v_readfirstlane_b32 s36, v9
    v_and_b32 v0, 63, v0
    v_and_b32 v9, 15, v0
    v_lshrrev_b32 v10, 4, v0
    s_and_b32 s37, s36, 3
    s_lshr_b32 s38, s36, 2
    s_lshl_b32 s39, s34, 6
    s_lshl_b32 s40, s37, 4
    s_add_u32 s39, s39, s40
    v_lshlrev_b32 v1, 4, v0
    s_waitcnt lgkmcnt(0)
    s_mov_b32 s28, s12
    s_and_b32 s29, s13, 0xffff
    s_mov_b32 s30, 0x19b1000
    s_mov_b32 s31, 0x00020000
    s_mov_b32 s20, s6
    s_and_b32 s21, s7, 0xffff
    s_mov_b32 s22, 0x280000
    s_mov_b32 s23, 0x00020000
    s_mov_b32 s24, s8
    s_and_b32 s25, s9, 0xffff
    s_mov_b32 s26, 0x280000
    s_mov_b32 s27, 0x00020000
    s_mov_b32 s16, s10
    s_and_b32 s17, s11, 0xffff
    s_mov_b32 s18, 0x100
    s_mov_b32 s19, 0x00020000
    s_lshr_b32 s40, s39, 4
    s_lshl_b32 s42, s38, 10
    s_mul_i32 s41, s40, 49152
    s_add_u32 s41, s41, s42
    s_add_u32 s41, s41, 12582912
    s_mul_i32 s48, s40, 20480
    s_add_u32 s48, s48, s42
    s_add_u32 s48, s48, 18874368
    s_mul_i32 s44, s36, 2560
    s_mul_i32 s42, s35, 245760
    s_add_u32 s42, s42, s44
    s_add_u32 s42, s42, 24117248
    s_mul_i32 s49, s35, 102400
    s_add_u32 s49, s49, s44
    s_add_u32 s49, s49, 26083328
    v_bfe_u32 v11, v0, 2, 2
    v_lshl_add_u32 v11, v10, 2, v11
    v_mul_u32_u24 v11, 160, v11
    v_and_b32 v12, 3, v0
    v_lshl_add_u32 v11, v12, 3, v11
    s_mul_i32 s43, s38, 5120
    v_add_u32 v2, s43, v11
    v_add_u32 v3, 61440, v2
    s_mov_b32 s53, 0x70000000
    s_add_u32 s54, s41, 49152
    s_mov_b32 s45, s41
    s_mov_b32 s46, s42
    s_mov_b32 s47, 0
    buffer_load_dwordx4 v[96:99], v1, s[28:31], s45 offen offset:0
    buffer_load_dwordx4 v[100:103], v1, s[28:31], s45 offen offset:2048
    s_add_u32 s45, s45, 4096
    s_cmp_eq_u32 s45, s54
    s_cselect_b32 s45, s53, s45
    s_add_u32 m0, s44, 0
    s_nop 0
    buffer_load_dwordx4 v1, s[28:31], s46 offen offset:0 lds
    buffer_load_dwordx4 v1, s[28:31], s46 offen offset:1024 lds
    s_mov_b64 exec, 0xffffffff
    buffer_load_dwordx4 v1, s[28:31], s46 offen offset:2048 lds
    s_mov_b64 exec, -1
    s_add_u32 s46, s46, 20480
    s_add_u32 s47, s47, 1
    s_cmp_eq_u32 s47, 12
    s_cselect_b32 s46, s49, s46
    s_cmp_ge_u32 s47, 17
    s_cselect_b32 s46, s53, s46
    s_barrier
    buffer_load_dwordx4 v[104:107], v1, s[28:31], s45 offen offset:0
    buffer_load_dwordx4 v[108:111], v1, s[28:31], s45 offen offset:2048
    s_add_u32 s45, s45, 4096
    s_cmp_eq_u32 s45, s54
    s_cselect_b32 s45, s53, s45
    s_add_u32 m0, s44, 20480
    s_nop 0
    buffer_load_dwordx4 v1, s[28:31], s46 offen offset:0 lds
    buffer_load_dwordx4 v1, s[28:31], s46 offen offset:1024 lds
    s_mov_b64 exec, 0xffffffff
    buffer_load_dwordx4 v1, s[28:31], s46 offen offset:2048 lds
    s_mov_b64 exec, -1
    s_add_u32 s46, s46, 20480
    s_add_u32 s47, s47, 1
    s_cmp_eq_u32 s47, 12
    s_cselect_b32 s46, s49, s46
    s_cmp_ge_u32 s47, 17
    s_cselect_b32 s46, s53, s46
    v_add_u32 v11, 0, v0
    v_mul_u32_u24 v12, 52429, v11
    v_lshrrev_b32 v12, 19, v12
    v_mul_u32_u24 v13, 10, v12
    v_sub_u32 v13, v11, v13
    v_add_u32 v14, s39, v12
    v_mul_u32_u24 v14, 1280, v14
    v_lshl_add_u32 v14, v13, 4, v14
    s_mul_i32 s50, s35, 160
    v_add_u32 v5, s50, v14
    v_add_u32 v11, 64, v0
    v_mul_u32_u24 v12, 52429, v11
    v_lshrrev_b32 v12, 19, v12
    v_mul_u32_u24 v13, 10, v12
    v_sub_u32 v13, v11, v13
    v_add_u32 v14, s39, v12
    v_mul_u32_u24 v14, 1280, v14
    v_lshl_add_u32 v14, v13, 4, v14
    s_mul_i32 s50, s35, 160
    v_add_u32 v6, s50, v14
    v_add_u32 v11, 128, v0
    v_mul_u32_u24 v12, 52429, v11
    v_lshrrev_b32 v12, 19, v12
    v_mul_u32_u24 v13, 10, v12
    v_sub_u32 v13, v11, v13
    v_add_u32 v14, s39, v12
    v_mul_u32_u24 v14, 1280, v14
    v_lshl_add_u32 v14, v13, 4, v14
    s_mul_i32 s50, s35, 160
    v_add_u32 v7, s50, v14
    v_mov_b32 v14, 0x40000000
    v_cmp_gt_u32 vcc, 32, v0
    s_nop 1
    v_cndmask_b32 v7, v14, v7, vcc
    v_mov_b32 v56, 0
    v_mov_b32 v57, 0
    v_mov_b32 v58, 0
    v_mov_b32 v59, 0
    v_mov_b32 v60, 0
    v_mov_b32 v61, 0
    v_mov_b32 v62, 0
    v_mov_b32 v63, 0
    v_mov_b32 v64, 0
    v_mov_b32 v65, 0
    v_mov_b32 v66, 0
    v_mov_b32 v67, 0
    v_mov_b32 v68, 0
    v_mov_b32 v69, 0
    v_mov_b32 v70, 0
    v_mov_b32 v71, 0
    v_mov_b32 v72, 0
    v_mov_b32 v73, 0
    v_mov_b32 v74, 0
    v_mov_b32 v75, 0
    s_waitcnt vmcnt(5)
    s_barrier
    ds_read_b64_tr_b16 v[16:17], v2 offset:0
    ds_read_b64_tr_b16 v[18:19], v2 offset:2560
    ds_read_b64_tr_b16 v[20:21], v2 offset:32
    ds_read_b64_tr_b16 v[22:23], v2 offset:2592
    ds_read_b64_tr_b16 v[24:25], v2 offset:64
    ds_read_b64_tr_b16 v[26:27], v2 offset:2624
    ds_read_b64_tr_b16 v[28:29], v2 offset:96
    ds_read_b64_tr_b16 v[30:31], v2 offset:2656
    ds_read_b64_tr_b16 v[32:33], v2 offset:128
    ds_read_b64_tr_b16 v[34:35], v2 offset:2688
    s_waitcnt lgkmcnt(6)
    v_mfma_f32_16x16x32_bf16 v[56:59], v[16:19], v[96:99], v[56:59]
    ds_read_b64_tr_b16 v[36:37], v2 offset:10240
    ds_read_b64_tr_b16 v[38:39], v2 offset:12800
    v_mfma_f32_16x16x32_bf16 v[60:63], v[20:23], v[96:99], v[60:63]
    ds_read_b64_tr_b16 v[40:41], v2 offset:10272
    ds_read_b64_tr_b16 v[42:43], v2 offset:12832
    s_waitcnt lgkmcnt(4)
    v_mfma_f32_16x16x32_bf16 v[64:67], v[24:27], v[96:99], v[64:67]
    ds_read_b64_tr_b16 v[44:45], v2 offset:10304
    ds_read_b64_tr_b16 v[46:47], v2 offset:12864
    v_mfma_f32_16x16x32_bf16 v[68:71], v[28:31], v[96:99], v[68:71]
    ds_read_b64_tr_b16 v[48:49], v2 offset:10336
    ds_read_b64_tr_b16 v[50:51], v2 offset:12896
    v_mfma_f32_16x16x32_bf16 v[72:75], v[32:35], v[96:99], v[72:75]
    ds_read_b64_tr_b16 v[52:53], v2 offset:10368
    ds_read_b64_tr_b16 v[54:55], v2 offset:12928
    buffer_load_dwordx4 v[112:115], v1, s[28:31], s45 offen offset:0
    buffer_load_dwordx4 v[116:119], v1, s[28:31], s45 offen offset:2048
    s_add_u32 s45, s45, 4096
    s_cmp_eq_u32 s45, s54
    s_cselect_b32 s45, s53, s45
    s_add_u32 m0, s44, 40960
    s_nop 0
    buffer_load_dwordx4 v1, s[28:31], s46 offen offset:0 lds
    buffer_load_dwordx4 v1, s[28:31], s46 offen offset:1024 lds
    s_mov_b64 exec, 0xffffffff
    buffer_load_dwordx4 v1, s[28:31], s46 offen offset:2048 lds
    s_mov_b64 exec, -1
    s_add_u32 s46, s46, 20480
    s_add_u32 s47, s47, 1
    s_cmp_eq_u32 s47, 12
    s_cselect_b32 s46, s49, s46
    s_cmp_ge_u32 s47, 17
    s_cselect_b32 s46, s53, s46
    s_waitcnt lgkmcnt(0)
    s_waitcnt vmcnt(5)
    s_barrier
    v_mfma_f32_16x16x32_bf16 v[56:59], v[36:39], v[100:103], v[56:59]
    ds_read_b64_tr_b16 v[16:17], v2 offset:20480
    ds_read_b64_tr_b16 v[18:19], v2 offset:23040
    v_mfma_f32_16x16x32_bf16 v[60:63], v[40:43], v[100:103], v[60:63]
    ds_read_b64_tr_b16 v[20:21], v2 offset:20512
    ds_read_b64_tr_b16 v[22:23], v2 offset:23072
    v_mfma_f32_16x16x32_bf16 v[64:67], v[44:47], v[100:103], v[64:67]
    ds_read_b64_tr_b16 v[24:25], v2 offset:20544
    ds_read_b64_tr_b16 v[26:27], v2 offset:23104
    v_mfma_f32_16x16x32_bf16 v[68:71], v[48:51], v[100:103], v[68:71]
    ds_read_b64_tr_b16 v[28:29], v2 offset:20576
    ds_read_b64_tr_b16 v[30:31], v2 offset:23136
    v_mfma_f32_16x16x32_bf16 v[72:75], v[52:55], v[100:103], v[72:75]
    ds_read_b64_tr_b16 v[32:33], v2 offset:20608
    ds_read_b64_tr_b16 v[34:35], v2 offset:23168
    buffer_load_dwordx4 v[120:123], v1, s[28:31], s45 offen offset:0
    buffer_load_dwordx4 v[124:127], v1, s[28:31], s45 offen offset:2048
    s_add_u32 s45, s45, 4096
    s_cmp_eq_u32 s45, s54
    s_cselect_b32 s45, s53, s45
    s_add_u32 m0, s44, 61440
    s_nop 0
    buffer_load_dwordx4 v1, s[28:31], s46 offen offset:0 lds
    buffer_load_dwordx4 v1, s[28:31], s46 offen offset:1024 lds
    s_mov_b64 exec, 0xffffffff
    buffer_load_dwordx4 v1, s[28:31], s46 offen offset:2048 lds
    s_mov_b64 exec, -1
    s_add_u32 s46, s46, 20480
    s_add_u32 s47, s47, 1
    s_cmp_eq_u32 s47, 12
    s_cselect_b32 s46, s49, s46
    s_cmp_ge_u32 s47, 17
    s_cselect_b32 s46, s53, s46
    s_waitcnt lgkmcnt(6)
    v_mfma_f32_16x16x32_bf16 v[56:59], v[16:19], v[104:107], v[56:59]
    ds_read_b64_tr_b16 v[36:37], v2 offset:30720
    ds_read_b64_tr_b16 v[38:39], v2 offset:33280
    v_mfma_f32_16x16x32_bf16 v[60:63], v[20:23], v[104:107], v[60:63]
    ds_read_b64_tr_b16 v[40:41], v2 offset:30752
    ds_read_b64_tr_b16 v[42:43], v2 offset:33312
    s_waitcnt lgkmcnt(4)
    v_mfma_f32_16x16x32_bf16 v[64:67], v[24:27], v[104:107], v[64:67]
    ds_read_b64_tr_b16 v[44:45], v2 offset:30784
    ds_read_b64_tr_b16 v[46:47], v2 offset:33344
    v_mfma_f32_16x16x32_bf16 v[68:71], v[28:31], v[104:107], v[68:71]
    ds_read_b64_tr_b16 v[48:49], v2 offset:30816
    ds_read_b64_tr_b16 v[50:51], v2 offset:33376
    v_mfma_f32_16x16x32_bf16 v[72:75], v[32:35], v[104:107], v[72:75]
    ds_read_b64_tr_b16 v[52:53], v2 offset:30848
    ds_read_b64_tr_b16 v[54:55], v2 offset:33408
    buffer_load_dwordx4 v[96:99], v1, s[28:31], s45 offen offset:0
    buffer_load_dwordx4 v[100:103], v1, s[28:31], s45 offen offset:2048
    s_add_u32 s45, s45, 4096
    s_cmp_eq_u32 s45, s54
    s_cselect_b32 s45, s53, s45
    s_add_u32 m0, s44, 0
    s_nop 0
    buffer_load_dwordx4 v1, s[28:31], s46 offen offset:0 lds
    buffer_load_dwordx4 v1, s[28:31], s46 offen offset:1024 lds
    s_mov_b64 exec, 0xffffffff
    buffer_load_dwordx4 v1, s[28:31], s46 offen offset:2048 lds
    s_mov_b64 exec, -1
    s_add_u32 s46, s46, 20480
    s_add_u32 s47, s47, 1
    s_cmp_eq_u32 s47, 12
    s_cselect_b32 s46, s49, s46
    s_cmp_ge_u32 s47, 17
    s_cselect_b32 s46, s53, s46
    s_waitcnt lgkmcnt(0)
    s_waitcnt vmcnt(10)
    s_barrier
    v_mfma_f32_16x16x32_bf16 v[56:59], v[36:39], v[108:111], v[56:59]
    ds_read_b64_tr_b16 v[16:17], v2 offset:40960
    ds_read_b64_tr_b16 v[18:19], v2 offset:43520
    v_mfma_f32_16x16x32_bf16 v[60:63], v[40:43], v[108:111], v[60:63]
    ds_read_b64_tr_b16 v[20:21], v2 offset:40992
    ds_read_b64_tr_b16 v[22:23], v2 offset:43552
    v_mfma_f32_16x16x32_bf16 v[64:67], v[44:47], v[108:111], v[64:67]
    ds_read_b64_tr_b16 v[24:25], v2 offset:41024
    ds_read_b64_tr_b16 v[26:27], v2 offset:43584
    v_mfma_f32_16x16x32_bf16 v[68:71], v[48:51], v[108:111], v[68:71]
    ds_read_b64_tr_b16 v[28:29], v2 offset:41056
    ds_read_b64_tr_b16 v[30:31], v2 offset:43616
    v_mfma_f32_16x16x32_bf16 v[72:75], v[52:55], v[108:111], v[72:75]
    ds_read_b64_tr_b16 v[32:33], v2 offset:41088
    ds_read_b64_tr_b16 v[34:35], v2 offset:43648
    s_add_u32 m0, s44, 20480
    s_nop 0
    buffer_load_dwordx4 v1, s[28:31], s46 offen offset:0 lds
    buffer_load_dwordx4 v1, s[28:31], s46 offen offset:1024 lds
    s_mov_b64 exec, 0xffffffff
    buffer_load_dwordx4 v1, s[28:31], s46 offen offset:2048 lds
    s_mov_b64 exec, -1
    s_add_u32 s46, s46, 20480
    s_add_u32 s47, s47, 1
    s_cmp_eq_u32 s47, 12
    s_cselect_b32 s46, s49, s46
    s_cmp_ge_u32 s47, 17
    s_cselect_b32 s46, s53, s46
    s_waitcnt lgkmcnt(6)
    v_mfma_f32_16x16x32_bf16 v[56:59], v[16:19], v[112:115], v[56:59]
    ds_read_b64_tr_b16 v[36:37], v2 offset:51200
    ds_read_b64_tr_b16 v[38:39], v2 offset:53760
    v_mfma_f32_16x16x32_bf16 v[60:63], v[20:23], v[112:115], v[60:63]
    ds_read_b64_tr_b16 v[40:41], v2 offset:51232
    ds_read_b64_tr_b16 v[42:43], v2 offset:53792
    s_waitcnt lgkmcnt(4)
    v_mfma_f32_16x16x32_bf16 v[64:67], v[24:27], v[112:115], v[64:67]
    ds_read_b64_tr_b16 v[44:45], v2 offset:51264
    ds_read_b64_tr_b16 v[46:47], v2 offset:53824
    v_mfma_f32_16x16x32_bf16 v[68:71], v[28:31], v[112:115], v[68:71]
    ds_read_b64_tr_b16 v[48:49], v2 offset:51296
    ds_read_b64_tr_b16 v[50:51], v2 offset:53856
    v_mfma_f32_16x16x32_bf16 v[72:75], v[32:35], v[112:115], v[72:75]
    ds_read_b64_tr_b16 v[52:53], v2 offset:51328
    ds_read_b64_tr_b16 v[54:55], v2 offset:53888
    buffer_load_dwordx4 v[104:107], v1, s[28:31], s45 offen offset:0
    buffer_load_dwordx4 v[108:111], v1, s[28:31], s45 offen offset:2048
    s_add_u32 s45, s45, 4096
    s_cmp_eq_u32 s45, s54
    s_cselect_b32 s45, s53, s45
    s_waitcnt lgkmcnt(0)
    s_waitcnt vmcnt(10)
    s_barrier
    v_mfma_f32_16x16x32_bf16 v[56:59], v[36:39], v[116:119], v[56:59]
    ds_read_b64_tr_b16 v[16:17], v3 offset:0
    ds_read_b64_tr_b16 v[18:19], v3 offset:2560
    v_mfma_f32_16x16x32_bf16 v[60:63], v[40:43], v[116:119], v[60:63]
    ds_read_b64_tr_b16 v[20:21], v3 offset:32
    ds_read_b64_tr_b16 v[22:23], v3 offset:2592
    v_mfma_f32_16x16x32_bf16 v[64:67], v[44:47], v[116:119], v[64:67]
    ds_read_b64_tr_b16 v[24:25], v3 offset:64
    ds_read_b64_tr_b16 v[26:27], v3 offset:2624
    v_mfma_f32_16x16x32_bf16 v[68:71], v[48:51], v[116:119], v[68:71]
    ds_read_b64_tr_b16 v[28:29], v3 offset:96
    ds_read_b64_tr_b16 v[30:31], v3 offset:2656
    v_mfma_f32_16x16x32_bf16 v[72:75], v[52:55], v[116:119], v[72:75]
    ds_read_b64_tr_b16 v[32:33], v3 offset:128
    ds_read_b64_tr_b16 v[34:35], v3 offset:2688
    s_add_u32 m0, s44, 40960
    s_nop 0
    buffer_load_dwordx4 v1, s[28:31], s46 offen offset:0 lds
    buffer_load_dwordx4 v1, s[28:31], s46 offen offset:1024 lds
    s_mov_b64 exec, 0xffffffff
    buffer_load_dwordx4 v1, s[28:31], s46 offen offset:2048 lds
    s_mov_b64 exec, -1
    s_add_u32 s46, s46, 20480
    s_add_u32 s47, s47, 1
    s_cmp_eq_u32 s47, 12
    s_cselect_b32 s46, s49, s46
    s_cmp_ge_u32 s47, 17
    s_cselect_b32 s46, s53, s46
    s_waitcnt lgkmcnt(6)
    v_mfma_f32_16x16x32_bf16 v[56:59], v[16:19], v[120:123], v[56:59]
    ds_read_b64_tr_b16 v[36:37], v3 offset:10240
    ds_read_b64_tr_b16 v[38:39], v3 offset:12800
    v_mfma_f32_16x16x32_bf16 v[60:63], v[20:23], v[120:123], v[60:63]
    ds_read_b64_tr_b16 v[40:41], v3 offset:10272
    ds_read_b64_tr_b16 v[42:43], v3 offset:12832
    s_waitcnt lgkmcnt(4)
    v_mfma_f32_16x16x32_bf16 v[64:67], v[24:27], v[120:123], v[64:67]
    ds_read_b64_tr_b16 v[44:45], v3 offset:10304
    ds_read_b64_tr_b16 v[46:47], v3 offset:12864
    v_mfma_f32_16x16x32_bf16 v[68:71], v[28:31], v[120:123], v[68:71]
    ds_read_b64_tr_b16 v[48:49], v3 offset:10336
    ds_read_b64_tr_b16 v[50:51], v3 offset:12896
    v_mfma_f32_16x16x32_bf16 v[72:75], v[32:35], v[120:123], v[72:75]
    ds_read_b64_tr_b16 v[52:53], v3 offset:10368
    ds_read_b64_tr_b16 v[54:55], v3 offset:12928
    buffer_load_dwordx4 v[112:115], v1, s[28:31], s45 offen offset:0
    buffer_load_dwordx4 v[116:119], v1, s[28:31], s45 offen offset:2048
    s_add_u32 s45, s45, 4096
    s_cmp_eq_u32 s45, s54
    s_cselect_b32 s45, s53, s45
    s_waitcnt lgkmcnt(0)
    s_waitcnt vmcnt(10)
    s_barrier
    v_mfma_f32_16x16x32_bf16 v[56:59], v[36:39], v[124:127], v[56:59]
    ds_read_b64_tr_b16 v[16:17], v2 offset:0
    ds_read_b64_tr_b16 v[18:19], v2 offset:2560
    v_mfma_f32_16x16x32_bf16 v[60:63], v[40:43], v[124:127], v[60:63]
    ds_read_b64_tr_b16 v[20:21], v2 offset:32
    ds_read_b64_tr_b16 v[22:23], v2 offset:2592
    v_mfma_f32_16x16x32_bf16 v[64:67], v[44:47], v[124:127], v[64:67]
    ds_read_b64_tr_b16 v[24:25], v2 offset:64
    ds_read_b64_tr_b16 v[26:27], v2 offset:2624
    v_mfma_f32_16x16x32_bf16 v[68:71], v[48:51], v[124:127], v[68:71]
    ds_read_b64_tr_b16 v[28:29], v2 offset:96
    ds_read_b64_tr_b16 v[30:31], v2 offset:2656
    v_mfma_f32_16x16x32_bf16 v[72:75], v[52:55], v[124:127], v[72:75]
    ds_read_b64_tr_b16 v[32:33], v2 offset:128
    ds_read_b64_tr_b16 v[34:35], v2 offset:2688
    s_add_u32 m0, s44, 61440
    s_nop 0
    buffer_load_dwordx4 v1, s[28:31], s46 offen offset:0 lds
    buffer_load_dwordx4 v1, s[28:31], s46 offen offset:1024 lds
    s_mov_b64 exec, 0xffffffff
    buffer_load_dwordx4 v1, s[28:31], s46 offen offset:2048 lds
    s_mov_b64 exec, -1
    s_add_u32 s46, s46, 20480
    s_add_u32 s47, s47, 1
    s_cmp_eq_u32 s47, 12
    s_cselect_b32 s46, s49, s46
    s_cmp_ge_u32 s47, 17
    s_cselect_b32 s46, s53, s46
    s_mov_b32 s52, 1
    s_nop 0
.gloop_10:
    s_waitcnt vmcnt(13)
    s_waitcnt lgkmcnt(6)
    v_mfma_f32_16x16x32_bf16 v[56:59], v[16:19], v[96:99], v[56:59]
    ds_read_b64_tr_b16 v[36:37], v2 offset:10240
    ds_read_b64_tr_b16 v[38:39], v2 offset:12800
    v_mfma_f32_16x16x32_bf16 v[60:63], v[20:23], v[96:99], v[60:63]
    ds_read_b64_tr_b16 v[40:41], v2 offset:10272
    ds_read_b64_tr_b16 v[42:43], v2 offset:12832
    s_waitcnt lgkmcnt(4)
    v_mfma_f32_16x16x32_bf16 v[64:67], v[24:27], v[96:99], v[64:67]
    ds_read_b64_tr_b16 v[44:45], v2 offset:10304
    ds_read_b64_tr_b16 v[46:47], v2 offset:12864
    v_mfma_f32_16x16x32_bf16 v[68:71], v[28:31], v[96:99], v[68:71]
    ds_read_b64_tr_b16 v[48:49], v2 offset:10336
    ds_read_b64_tr_b16 v[50:51], v2 offset:12896
    v_mfma_f32_16x16x32_bf16 v[72:75], v[32:35], v[96:99], v[72:75]
    ds_read_b64_tr_b16 v[52:53], v2 offset:10368
    ds_read_b64_tr_b16 v[54:55], v2 offset:12928
    buffer_load_dwordx4 v[120:123], v1, s[28:31], s45 offen offset:0 sc1
    buffer_load_dwordx4 v[124:127], v1, s[28:31], s45 offen offset:2048 sc1
    s_add_u32 s45, s45, 4096
    s_cmp_eq_u32 s45, s54
    s_cselect_b32 s45, s53, s45
    s_waitcnt lgkmcnt(0)
    s_waitcnt vmcnt(12)
    s_barrier
    v_mfma_f32_16x16x32_bf16 v[56:59], v[36:39], v[100:103], v[56:59]
    ds_read_b64_tr_b16 v[16:17], v2 offset:20480
    ds_read_b64_tr_b16 v[18:19], v2 offset:23040
    v_mfma_f32_16x16x32_bf16 v[60:63], v[40:43], v[100:103], v[60:63]
    ds_read_b64_tr_b16 v[20:21], v2 offset:20512
    ds_read_b64_tr_b16 v[22:23], v2 offset:23072
    v_mfma_f32_16x16x32_bf16 v[64:67], v[44:47], v[100:103], v[64:67]
    ds_read_b64_tr_b16 v[24:25], v2 offset:20544
    ds_read_b64_tr_b16 v[26:27], v2 offset:23104
    v_mfma_f32_16x16x32_bf16 v[68:71], v[48:51], v[100:103], v[68:71]
    ds_read_b64_tr_b16 v[28:29], v2 offset:20576
    ds_read_b64_tr_b16 v[30:31], v2 offset:23136
    v_mfma_f32_16x16x32_bf16 v[72:75], v[52:55], v[100:103], v[72:75]
    ds_read_b64_tr_b16 v[32:33], v2 offset:20608
    ds_read_b64_tr_b16 v[34:35], v2 offset:23168
    s_add_u32 m0, s44, 0
    s_nop 0
    buffer_load_dwordx4 v1, s[28:31], s46 offen offset:0 lds
    buffer_load_dwordx4 v1, s[28:31], s46 offen offset:1024 lds
    s_mov_b64 exec, 0xffffffff
    buffer_load_dwordx4 v1, s[28:31], s46 offen offset:2048 lds
    s_mov_b64 exec, -1
    s_add_u32 s46, s46, 20480
    s_add_u32 s47, s47, 1
    s_cmp_eq_u32 s47, 12
    s_cselect_b32 s46, s49, s46
    s_cmp_ge_u32 s47, 17
    s_cselect_b32 s46, s53, s46
    s_waitcnt vmcnt(13)
    s_waitcnt lgkmcnt(6)
    v_mfma_f32_16x16x32_bf16 v[56:59], v[16:19], v[104:107], v[56:59]
    ds_read_b64_tr_b16 v[36:37], v2 offset:30720
    ds_read_b64_tr_b16 v[38:39], v2 offset:33280
    v_mfma_f32_16x16x32_bf16 v[60:63], v[20:23], v[104:107], v[60:63]
    ds_read_b64_tr_b16 v[40:41], v2 offset:30752
    ds_read_b64_tr_b16 v[42:43], v2 offset:33312
    s_waitcnt lgkmcnt(4)
    v_mfma_f32_16x16x32_bf16 v[64:67], v[24:27], v[104:107], v[64:67]
    ds_read_b64_tr_b16 v[44:45], v2 offset:30784
    ds_read_b64_tr_b16 v[46:47], v2 offset:33344
    v_mfma_f32_16x16x32_bf16 v[68:71], v[28:31], v[104:107], v[68:71]
    ds_read_b64_tr_b16 v[48:49], v2 offset:30816
    ds_read_b64_tr_b16 v[50:51], v2 offset:33376
    v_mfma_f32_16x16x32_bf16 v[72:75], v[32:35], v[104:107], v[72:75]
    ds_read_b64_tr_b16 v[52:53], v2 offset:30848
    ds_read_b64_tr_b16 v[54:55], v2 offset:33408
    buffer_load_dwordx4 v[96:99], v1, s[28:31], s45 offen offset:0 sc1
    buffer_load_dwordx4 v[100:103], v1, s[28:31], s45 offen offset:2048 sc1
    s_add_u32 s45, s45, 4096
    s_cmp_eq_u32 s45, s54
    s_cselect_b32 s45, s53, s45
    s_waitcnt lgkmcnt(0)
    s_waitcnt vmcnt(12)
    s_barrier
    v_mfma_f32_16x16x32_bf16 v[56:59], v[36:39], v[108:111], v[56:59]
    ds_read_b64_tr_b16 v[16:17], v2 offset:40960
    ds_read_b64_tr_b16 v[18:19], v2 offset:43520
    v_mfma_f32_16x16x32_bf16 v[60:63], v[40:43], v[108:111], v[60:63]
    ds_read_b64_tr_b16 v[20:21], v2 offset:40992
    ds_read_b64_tr_b16 v[22:23], v2 offset:43552
    v_mfma_f32_16x16x32_bf16 v[64:67], v[44:47], v[108:111], v[64:67]
    ds_read_b64_tr_b16 v[24:25], v2 offset:41024
    ds_read_b64_tr_b16 v[26:27], v2 offset:43584
    v_mfma_f32_16x16x32_bf16 v[68:71], v[48:51], v[108:111], v[68:71]
    ds_read_b64_tr_b16 v[28:29], v2 offset:41056
    ds_read_b64_tr_b16 v[30:31], v2 offset:43616
    v_mfma_f32_16x16x32_bf16 v[72:75], v[52:55], v[108:111], v[72:75]
    ds_read_b64_tr_b16 v[32:33], v2 offset:41088
    ds_read_b64_tr_b16 v[34:35], v2 offset:43648
    s_add_u32 m0, s44, 20480
    s_nop 0
    buffer_load_dwordx4 v1, s[28:31], s46 offen offset:0 lds
    buffer_load_dwordx4 v1, s[28:31], s46 offen offset:1024 lds
    s_mov_b64 exec, 0xffffffff
    buffer_load_dwordx4 v1, s[28:31], s46 offen offset:2048 lds
    s_mov_b64 exec, -1
    s_add_u32 s46, s46, 20480
    s_add_u32 s47, s47, 1
    s_cmp_eq_u32 s47, 12
    s_cselect_b32 s46, s49, s46
    s_cmp_ge_u32 s47, 17
    s_cselect_b32 s46, s53, s46
    s_waitcnt vmcnt(13)
    s_waitcnt lgkmcnt(6)
    v_mfma_f32_16x16x32_bf16 v[56:59], v[16:19], v[112:115], v[56:59]
    ds_read_b64_tr_b16 v[36:37], v2 offset:51200
    ds_read_b64_tr_b16 v[38:39], v2 offset:53760
    v_mfma_f32_16x16x32_bf16 v[60:63], v[20:23], v[112:115], v[60:63]
    ds_read_b64_tr_b16 v[40:41], v2 offset:51232
    ds_read_b64_tr_b16 v[42:43], v2 offset:53792
    s_waitcnt lgkmcnt(4)
    v_mfma_f32_16x16x32_bf16 v[64:67], v[24:27], v[112:115], v[64:67]
    ds_read_b64_tr_b16 v[44:45], v2 offset:51264
    ds_read_b64_tr_b16 v[46:47], v2 offset:53824
    v_mfma_f32_16x16x32_bf16 v[68:71], v[28:31], v[112:115], v[68:71]
    ds_read_b64_tr_b16 v[48:49], v2 offset:51296
    ds_read_b64_tr_b16 v[50:51], v2 offset:53856
    v_mfma_f32_16x16x32_bf16 v[72:75], v[32:35], v[112:115], v[72:75]
    ds_read_b64_tr_b16 v[52:53], v2 offset:51328
    ds_read_b64_tr_b16 v[54:55], v2 offset:53888
    buffer_load_dwordx4 v[104:107], v1, s[28:31], s45 offen offset:0 sc1
    buffer_load_dwordx4 v[108:111], v1, s[28:31], s45 offen offset:2048 sc1
    s_add_u32 s45, s45, 4096
    s_cmp_eq_u32 s45, s54
    s_cselect_b32 s45, s53, s45
    s_waitcnt lgkmcnt(0)
    s_waitcnt vmcnt(12)
    s_barrier
    v_mfma_f32_16x16x32_bf16 v[56:59], v[36:39], v[116:119], v[56:59]
    ds_read_b64_tr_b16 v[16:17], v3 offset:0
    ds_read_b64_tr_b16 v[18:19], v3 offset:2560
    v_mfma_f32_16x16x32_bf16 v[60:63], v[40:43], v[116:119], v[60:63]
    ds_read_b64_tr_b16 v[20:21], v3 offset:32
    ds_read_b64_tr_b16 v[22:23], v3 offset:2592
    v_mfma_f32_16x16x32_bf16 v[64:67], v[44:47], v[116:119], v[64:67]
    ds_read_b64_tr_b16 v[24:25], v3 offset:64
    ds_read_b64_tr_b16 v[26:27], v3 offset:2624
    v_mfma_f32_16x16x32_bf16 v[68:71], v[48:51], v[116:119], v[68:71]
    ds_read_b64_tr_b16 v[28:29], v3 offset:96
    ds_read_b64_tr_b16 v[30:31], v3 offset:2656
    v_mfma_f32_16x16x32_bf16 v[72:75], v[52:55], v[116:119], v[72:75]
    ds_read_b64_tr_b16 v[32:33], v3 offset:128
    ds_read_b64_tr_b16 v[34:35], v3 offset:2688
    s_add_u32 m0, s44, 40960
    s_nop 0
    buffer_load_dwordx4 v1, s[28:31], s46 offen offset:0 lds
    buffer_load_dwordx4 v1, s[28:31], s46 offen offset:1024 lds
    s_mov_b64 exec, 0xffffffff
    buffer_load_dwordx4 v1, s[28:31], s46 offen offset:2048 lds
    s_mov_b64 exec, -1
    s_add_u32 s46, s46, 20480
    s_add_u32 s47, s47, 1
    s_cmp_eq_u32 s47, 12
    s_cselect_b32 s46, s49, s46
    s_cmp_ge_u32 s47, 17
    s_cselect_b32 s46, s53, s46
    s_waitcnt vmcnt(13)
    s_waitcnt lgkmcnt(6)
    v_mfma_f32_16x16x32_bf16 v[56:59], v[16:19], v[120:123], v[56:59]
    ds_read_b64_tr_b16 v[36:37], v3 offset:10240
    ds_read_b64_tr_b16 v[38:39], v3 offset:12800
    v_mfma_f32_16x16x32_bf16 v[60:63], v[20:23], v[120:123], v[60:63]
    ds_read_b64_tr_b16 v[40:41], v3 offset:10272
    ds_read_b64_tr_b16 v[42:43], v3 offset:12832
    s_waitcnt lgkmcnt(4)
    v_mfma_f32_16x16x32_bf16 v[64:67], v[24:27], v[120:123], v[64:67]
    ds_read_b64_tr_b16 v[44:45], v3 offset:10304
    ds_read_b64_tr_b16 v[46:47], v3 offset:12864
    v_mfma_f32_16x16x32_bf16 v[68:71], v[28:31], v[120:123], v[68:71]
    ds_read_b64_tr_b16 v[48:49], v3 offset:10336
    ds_read_b64_tr_b16 v[50:51], v3 offset:12896
    v_mfma_f32_16x16x32_bf16 v[72:75], v[32:35], v[120:123], v[72:75]
    ds_read_b64_tr_b16 v[52:53], v3 offset:10368
    ds_read_b64_tr_b16 v[54:55], v3 offset:12928
    buffer_load_dwordx4 v[112:115], v1, s[28:31], s45 offen offset:0 sc1
    buffer_load_dwordx4 v[116:119], v1, s[28:31], s45 offen offset:2048 sc1
    s_add_u32 s45, s45, 4096
    s_cmp_eq_u32 s45, s54
    s_cselect_b32 s45, s53, s45
    s_waitcnt lgkmcnt(0)
    s_waitcnt vmcnt(12)
    s_barrier
    v_mfma_f32_16x16x32_bf16 v[56:59], v[36:39], v[124:127], v[56:59]
    ds_read_b64_tr_b16 v[16:17], v2 offset:0
    ds_read_b64_tr_b16 v[18:19], v2 offset:2560
    v_mfma_f32_16x16x32_bf16 v[60:63], v[40:43], v[124:127], v[60:63]
    ds_read_b64_tr_b16 v[20:21], v2 offset:32
    ds_read_b64_tr_b16 v[22:23], v2 offset:2592
    v_mfma_f32_16x16x32_bf16 v[64:67], v[44:47], v[124:127], v[64:67]
    ds_read_b64_tr_b16 v[24:25], v2 offset:64
    ds_read_b64_tr_b16 v[26:27], v2 offset:2624
    v_mfma_f32_16x16x32_bf16 v[68:71], v[48:51], v[124:127], v[68:71]
    ds_read_b64_tr_b16 v[28:29], v2 offset:96
    ds_read_b64_tr_b16 v[30:31], v2 offset:2656
    v_mfma_f32_16x16x32_bf16 v[72:75], v[52:55], v[124:127], v[72:75]
    ds_read_b64_tr_b16 v[32:33], v2 offset:128
    ds_read_b64_tr_b16 v[34:35], v2 offset:2688
    s_add_u32 m0, s44, 61440
    s_nop 0
    buffer_load_dwordx4 v1, s[28:31], s46 offen offset:0 lds
    buffer_load_dwordx4 v1, s[28:31], s46 offen offset:1024 lds
    s_mov_b64 exec, 0xffffffff
    buffer_load_dwordx4 v1, s[28:31], s46 offen offset:2048 lds
    s_mov_b64 exec, -1
    s_add_u32 s46, s46, 20480
    s_add_u32 s47, s47, 1
    s_cmp_eq_u32 s47, 12
    s_cselect_b32 s46, s49, s46
    s_cmp_ge_u32 s47, 17
    s_cselect_b32 s46, s53, s46
    s_add_u32 s52, s52, 1
    s_cmp_lt_u32 s52, 3
    s_nop 0
    s_cbranch_scc1 .gloop_10
    s_cmp_eq_u32 s52, 4
    s_nop 0
    s_cbranch_scc1 .gtail_12
    v_mov_b32 v76, v56
    v_mov_b32 v77, v57
    v_mov_b32 v78, v58
    v_mov_b32 v79, v59
    v_mov_b32 v80, v60
    v_mov_b32 v81, v61
    v_mov_b32 v82, v62
    v_mov_b32 v83, v63
    v_mov_b32 v84, v64
    v_mov_b32 v85, v65
    v_mov_b32 v86, v66
    v_mov_b32 v87, v67
    v_mov_b32 v88, v68
    v_mov_b32 v89, v69
    v_mov_b32 v90, v70
    v_mov_b32 v91, v71
    v_mov_b32 v92, v72
    v_mov_b32 v93, v73
    v_mov_b32 v94, v74
    v_mov_b32 v95, v75
    v_mov_b32 v56, 0
    v_mov_b32 v57, 0
    v_mov_b32 v58, 0
    v_mov_b32 v59, 0
    v_mov_b32 v60, 0
    v_mov_b32 v61, 0
    v_mov_b32 v62, 0
    v_mov_b32 v63, 0
    v_mov_b32 v64, 0
    v_mov_b32 v65, 0
    v_mov_b32 v66, 0
    v_mov_b32 v67, 0
    v_mov_b32 v68, 0
    v_mov_b32 v69, 0
    v_mov_b32 v70, 0
    v_mov_b32 v71, 0
    v_mov_b32 v72, 0
    v_mov_b32 v73, 0
    v_mov_b32 v74, 0
    v_mov_b32 v75, 0
    s_cmp_lg_u32 s36, 0
    s_nop 3
    s_cbranch_scc1 .pollskip_14
    s_lshr_b32 s50, s34, 2
    s_lshl_b32 s50, s50, 8
    s_add_u32 s50, s50, 26935296
    v_mov_b32 v12, 0
    s_mov_b32 s55, 0
    s_nop 3
.poll_13:
    buffer_load_dword v11, v12, s[28:31], s50 offen sc1
    s_waitcnt vmcnt(0)
    v_readfirstlane_b32 s51, v11
    s_cmp_ge_u32 s51, 32
    s_nop 3
    s_cbranch_scc1 .polled_15
    s_sleep 16
    s_add_u32 s55, s55, 1
    s_cmp_lt_u32 s55, 200000
    s_nop 0
    s_cbranch_scc1 .poll_13
.polled_15:
.pollskip_14:
    s_barrier
    s_waitcnt vmcnt(0)
    s_mov_b32 s45, s48
    s_add_u32 s54, s48, 20480
    buffer_load_dwordx4 v[96:99], v1, s[28:31], s45 offen offset:0 sc1
    buffer_load_dwordx4 v[100:103], v1, s[28:31], s45 offen offset:2048 sc1
    s_add_u32 s45, s45, 4096
    s_cmp_eq_u32 s45, s54
    s_cselect_b32 s45, s53, s45
    buffer_load_dwordx4 v[104:107], v1, s[28:31], s45 offen offset:0 sc1
    buffer_load_dwordx4 v[108:111], v1, s[28:31], s45 offen offset:2048 sc1
    s_add_u32 s45, s45, 4096
    s_cmp_eq_u32 s45, s54
    s_cselect_b32 s45, s53, s45
    buffer_load_dwordx4 v[112:115], v1, s[28:31], s45 offen offset:0 sc1
    buffer_load_dwordx4 v[116:119], v1, s[28:31], s45 offen offset:2048 sc1
    s_add_u32 s45, s45, 4096
    s_cmp_eq_u32 s45, s54
    s_cselect_b32 s45, s53, s45
    s_waitcnt vmcnt(0)
    s_branch .gloop_10
.gtail_12:
    s_waitcnt vmcnt(13)
    s_waitcnt lgkmcnt(6)
    v_mfma_f32_16x16x32_bf16 v[56:59], v[16:19], v[96:99], v[56:59]
    ds_read_b64_tr_b16 v[36:37], v2 offset:10240
    ds_read_b64_tr_b16 v[38:39], v2 offset:12800
    v_mfma_f32_16x16x32_bf16 v[60:63], v[20:23], v[96:99], v[60:63]
    ds_read_b64_tr_b16 v[40:41], v2 offset:10272
    ds_read_b64_tr_b16 v[42:43], v2 offset:12832
    s_waitcnt lgkmcnt(4)
    v_mfma_f32_16x16x32_bf16 v[64:67], v[24:27], v[96:99], v[64:67]
    ds_read_b64_tr_b16 v[44:45], v2 offset:10304
    ds_read_b64_tr_b16 v[46:47], v2 offset:12864
    v_mfma_f32_16x16x32_bf16 v[68:71], v[28:31], v[96:99], v[68:71]
    ds_read_b64_tr_b16 v[48:49], v2 offset:10336
    ds_read_b64_tr_b16 v[50:51], v2 offset:12896
    v_mfma_f32_16x16x32_bf16 v[72:75], v[32:35], v[96:99], v[72:75]
    ds_read_b64_tr_b16 v[52:53], v2 offset:10368
    ds_read_b64_tr_b16 v[54:55], v2 offset:12928
    buffer_load_dwordx4 v[112:115], v5, s[20:23], 0 offen
    buffer_load_dwordx4 v[116:119], v6, s[20:23], 0 offen
    buffer_load_dwordx4 v[120:123], v7, s[20:23], 0 offen
    s_waitcnt lgkmcnt(6)
    v_mfma_f32_16x16x32_bf16 v[56:59], v[36:39], v[100:103], v[56:59]
    v_mfma_f32_16x16x32_bf16 v[60:63], v[40:43], v[100:103], v[60:63]
    s_waitcnt lgkmcnt(0)
    v_mfma_f32_16x16x32_bf16 v[64:67], v[44:47], v[100:103], v[64:67]
    v_mfma_f32_16x16x32_bf16 v[68:71], v[48:51], v[100:103], v[68:71]
    v_mfma_f32_16x16x32_bf16 v[72:75], v[52:55], v[100:103], v[72:75]
    s_waitcnt vmcnt(0)
    s_barrier
    s_mul_i32 s45, s37, 10240
    v_add_u32 v4, s45, v1
    s_cmp_eq_u32 s38, 0
    s_nop 3
    s_cbranch_scc1 .g2hi_16
    ds_write_b128 v4, v[56:59] offset:0
    ds_write_b128 v4, v[60:63] offset:1024
    ds_write_b128 v4, v[64:67] offset:2048
    ds_write_b128 v4, v[68:71] offset:3072
    ds_write_b128 v4, v[72:75] offset:4096
    ds_write_b128 v4, v[76:79] offset:5120
    ds_write_b128 v4, v[80:83] offset:6144
    ds_write_b128 v4, v[84:87] offset:7168
    ds_write_b128 v4, v[88:91] offset:8192
    ds_write_b128 v4, v[92:95] offset:9216
    s_waitcnt lgkmcnt(0)
    s_barrier
    s_branch .g2done_17
.g2hi_16:
    s_barrier
    ds_read_b128 v[16:19], v4 offset:0
    ds_read_b128 v[20:23], v4 offset:1024
    ds_read_b128 v[24:27], v4 offset:2048
    ds_read_b128 v[28:31], v4 offset:3072
    ds_read_b128 v[32:35], v4 offset:4096
    ds_read_b128 v[36:39], v4 offset:5120
    ds_read_b128 v[40:43], v4 offset:6144
    ds_read_b128 v[44:47], v4 offset:7168
    ds_read_b128 v[48:51], v4 offset:8192
    ds_read_b128 v[52:55], v4 offset:9216
    s_waitcnt lgkmcnt(0)
    s_mul_i32 s45, s37, 5120
    s_add_u32 s45, s45, 40960
    v_mul_u32_u24 v11, 160, v9
    v_lshl_add_u32 v11, v10, 3, v11
    v_add_u32 v11, s45, v11
    v_add_f32 v56, v56, v16
    v_add_f32 v57, v57, v17
    v_add_f32 v58, v58, v18
    v_add_f32 v59, v59, v19
    v_cvt_pk_bf16_f32 v96, v56, v57
    v_cvt_pk_bf16_f32 v97, v58, v59
    ds_write_b64 v11, v[96:97] offset:2560
    v_add_f32 v60, v60, v20
    v_add_f32 v61, v61, v21
    v_add_f32 v62, v62, v22
    v_add_f32 v63, v63, v23
    v_cvt_pk_bf16_f32 v98, v60, v61
    v_cvt_pk_bf16_f32 v99, v62, v63
    ds_write_b64 v11, v[98:99] offset:2592
    v_add_f32 v64, v64, v24
    v_add_f32 v65, v65, v25
    v_add_f32 v66, v66, v26
    v_add_f32 v67, v67, v27
    v_cvt_pk_bf16_f32 v100, v64, v65
    v_cvt_pk_bf16_f32 v101, v66, v67
    ds_write_b64 v11, v[100:101] offset:2624
    v_add_f32 v68, v68, v28
    v_add_f32 v69, v69, v29
    v_add_f32 v70, v70, v30
    v_add_f32 v71, v71, v31
    v_cvt_pk_bf16_f32 v102, v68, v69
    v_cvt_pk_bf16_f32 v103, v70, v71
    ds_write_b64 v11, v[102:103] offset:2656
    v_add_f32 v72, v72, v32
    v_add_f32 v73, v73, v33
    v_add_f32 v74, v74, v34
    v_add_f32 v75, v75, v35
    v_cvt_pk_bf16_f32 v96, v72, v73
    v_cvt_pk_bf16_f32 v97, v74, v75
    ds_write_b64 v11, v[96:97] offset:2688
    v_add_f32 v76, v76, v36
    v_add_f32 v77, v77, v37
    v_add_f32 v78, v78, v38
    v_add_f32 v79, v79, v39
    v_cvt_pk_bf16_f32 v98, v76, v77
    v_cvt_pk_bf16_f32 v99, v78, v79
    ds_write_b64 v11, v[98:99] offset:0
    v_add_f32 v80, v80, v40
    v_add_f32 v81, v81, v41
    v_add_f32 v82, v82, v42
    v_add_f32 v83, v83, v43
    v_cvt_pk_bf16_f32 v100, v80, v81
    v_cvt_pk_bf16_f32 v101, v82, v83
    ds_write_b64 v11, v[100:101] offset:32
    v_add_f32 v84, v84, v44
    v_add_f32 v85, v85, v45
    v_add_f32 v86, v86, v46
    v_add_f32 v87, v87, v47
    v_cvt_pk_bf16_f32 v102, v84, v85
    v_cvt_pk_bf16_f32 v103, v86, v87
    ds_write_b64 v11, v[102:103] offset:64
    v_add_f32 v88, v88, v48
    v_add_f32 v89, v89, v49
    v_add_f32 v90, v90, v50
    v_add_f32 v91, v91, v51
    v_cvt_pk_bf16_f32 v96, v88, v89
    v_cvt_pk_bf16_f32 v97, v90, v91
    ds_write_b64 v11, v[96:97] offset:96
    v_add_f32 v92, v92, v52
    v_add_f32 v93, v93, v53
    v_add_f32 v94, v94, v54
    v_add_f32 v95, v95, v55
    v_cvt_pk_bf16_f32 v98, v92, v93
    v_cvt_pk_bf16_f32 v99, v94, v95
    ds_write_b64 v11, v[98:99] offset:128
    s_waitcnt lgkmcnt(0)
    v_add_u32 v12, s45, v1
    ds_read_b128 v[16:19], v12 offset:0
    ds_read_b128 v[28:31], v12 offset:2560
    ds_read_b128 v[20:23], v12 offset:1024
    ds_read_b128 v[32:35], v12 offset:3584
    ds_read_b128 v[24:27], v12 offset:2048
    ds_read_b128 v[36:39], v12 offset:4608
    s_waitcnt lgkmcnt(0)
    v_lshlrev_b32 v56, 16, v28
    v_and_b32 v57, 0xffff0000, v28
    v_lshlrev_b32 v58, 16, v112
    v_and_b32 v59, 0xffff0000, v112
    v_add_f32 v56, v56, v58
    v_add_f32 v57, v57, v59
    v_cvt_pk_bf16_f32 v60, v56, v57
    v_lshlrev_b32 v56, 16, v60
    v_and_b32 v57, 0xffff0000, v60
    v_lshlrev_b32 v58, 16, v16
    v_and_b32 v59, 0xffff0000, v16
    v_add_f32 v56, v56, v58
    v_add_f32 v57, v57, v59
    v_cvt_pk_bf16_f32 v28, v56, v57
    v_lshlrev_b32 v64, 16, v29
    v_and_b32 v65, 0xffff0000, v29
    v_lshlrev_b32 v66, 16, v113
    v_and_b32 v67, 0xffff0000, v113
    v_add_f32 v64, v64, v66
    v_add_f32 v65, v65, v67
    v_cvt_pk_bf16_f32 v68, v64, v65
    v_lshlrev_b32 v64, 16, v68
    v_and_b32 v65, 0xffff0000, v68
    v_lshlrev_b32 v66, 16, v17
    v_and_b32 v67, 0xffff0000, v17
    v_add_f32 v64, v64, v66
    v_add_f32 v65, v65, v67
    v_cvt_pk_bf16_f32 v29, v64, v65
    v_lshlrev_b32 v56, 16, v30
    v_and_b32 v57, 0xffff0000, v30
    v_lshlrev_b32 v58, 16, v114
    v_and_b32 v59, 0xffff0000, v114
    v_add_f32 v56, v56, v58
    v_add_f32 v57, v57, v59
    v_cvt_pk_bf16_f32 v60, v56, v57
    v_lshlrev_b32 v56, 16, v60
    v_and_b32 v57, 0xffff0000, v60
    v_lshlrev_b32 v58, 16, v18
    v_and_b32 v59, 0xffff0000, v18
    v_add_f32 v56, v56, v58
    v_add_f32 v57, v57, v59
    v_cvt_pk_bf16_f32 v30, v56, v57
    v_lshlrev_b32 v64, 16, v31
    v_and_b32 v65, 0xffff0000, v31
    v_lshlrev_b32 v66, 16, v115
    v_and_b32 v67, 0xffff0000, v115
    v_add_f32 v64, v64, v66
    v_add_f32 v65, v65, v67
    v_cvt_pk_bf16_f32 v68, v64, v65
    v_lshlrev_b32 v64, 16, v68
    v_and_b32 v65, 0xffff0000, v68
    v_lshlrev_b32 v66, 16, v19
    v_and_b32 v67, 0xffff0000, v19
    v_add_f32 v64, v64, v66
    v_add_f32 v65, v65, v67
    v_cvt_pk_bf16_f32 v31, v64, v65
    buffer_store_dwordx4 v[28:31], v5, s[24:27], 0 offen
    v_lshlrev_b32 v56, 16, v32
    v_and_b32 v57, 0xffff0000, v32
    v_lshlrev_b32 v58, 16, v116
    v_and_b32 v59, 0xffff0000, v116
    v_add_f32 v56, v56, v58
    v_add_f32 v57, v57, v59
    v_cvt_pk_bf16_f32 v60, v56, v57
    v_lshlrev_b32 v56, 16, v60
    v_and_b32 v57, 0xffff0000, v60
    v_lshlrev_b32 v58, 16, v20
    v_and_b32 v59, 0xffff0000, v20
    v_add_f32 v56, v56, v58
    v_add_f32 v57, v57, v59
    v_cvt_pk_bf16_f32 v32, v56, v57
    v_lshlrev_b32 v64, 16, v33
    v_and_b32 v65, 0xffff0000, v33
    v_lshlrev_b32 v66, 16, v117
    v_and_b32 v67, 0xffff0000, v117
    v_add_f32 v64, v64, v66
    v_add_f32 v65, v65, v67
    v_cvt_pk_bf16_f32 v68, v64, v65
    v_lshlrev_b32 v64, 16, v68
    v_and_b32 v65, 0xffff0000, v68
    v_lshlrev_b32 v66, 16, v21
    v_and_b32 v67, 0xffff0000, v21
    v_add_f32 v64, v64, v66
    v_add_f32 v65, v65, v67
    v_cvt_pk_bf16_f32 v33, v64, v65
    v_lshlrev_b32 v56, 16, v34
    v_and_b32 v57, 0xffff0000, v34
    v_lshlrev_b32 v58, 16, v118
    v_and_b32 v59, 0xffff0000, v118
    v_add_f32 v56, v56, v58
    v_add_f32 v57, v57, v59
    v_cvt_pk_bf16_f32 v60, v56, v57
    v_lshlrev_b32 v56, 16, v60
    v_and_b32 v57, 0xffff0000, v60
    v_lshlrev_b32 v58, 16, v22
    v_and_b32 v59, 0xffff0000, v22
    v_add_f32 v56, v56, v58
    v_add_f32 v57, v57, v59
    v_cvt_pk_bf16_f32 v34, v56, v57
    v_lshlrev_b32 v64, 16, v35
    v_and_b32 v65, 0xffff0000, v35
    v_lshlrev_b32 v66, 16, v119
    v_and_b32 v67, 0xffff0000, v119
    v_add_f32 v64, v64, v66
    v_add_f32 v65, v65, v67
    v_cvt_pk_bf16_f32 v68, v64, v65
    v_lshlrev_b32 v64, 16, v68
    v_and_b32 v65, 0xffff0000, v68
    v_lshlrev_b32 v66, 16, v23
    v_and_b32 v67, 0xffff0000, v23
    v_add_f32 v64, v64, v66
    v_add_f32 v65, v65, v67
    v_cvt_pk_bf16_f32 v35, v64, v65
    buffer_store_dwordx4 v[32:35], v6, s[24:27], 0 offen
    v_lshlrev_b32 v56, 16, v36
    v_and_b32 v57, 0xffff0000, v36
    v_lshlrev_b32 v58, 16, v120
    v_and_b32 v59, 0xffff0000, v120
    v_add_f32 v56, v56, v58
    v_add_f32 v57, v57, v59
    v_cvt_pk_bf16_f32 v60, v56, v57
    v_lshlrev_b32 v56, 16, v60
    v_and_b32 v57, 0xffff0000, v60
    v_lshlrev_b32 v58, 16, v24
    v_and_b32 v59, 0xffff0000, v24
    v_add_f32 v56, v56, v58
    v_add_f32 v57, v57, v59
    v_cvt_pk_bf16_f32 v36, v56, v57
    v_lshlrev_b32 v64, 16, v37
    v_and_b32 v65, 0xffff0000, v37
    v_lshlrev_b32 v66, 16, v121
    v_and_b32 v67, 0xffff0000, v121
    v_add_f32 v64, v64, v66
    v_add_f32 v65, v65, v67
    v_cvt_pk_bf16_f32 v68, v64, v65
    v_lshlrev_b32 v64, 16, v68
    v_and_b32 v65, 0xffff0000, v68
    v_lshlrev_b32 v66, 16, v25
    v_and_b32 v67, 0xffff0000, v25
    v_add_f32 v64, v64, v66
    v_add_f32 v65, v65, v67
    v_cvt_pk_bf16_f32 v37, v64, v65
    v_lshlrev_b32 v56, 16, v38
    v_and_b32 v57, 0xffff0000, v38
    v_lshlrev_b32 v58, 16, v122
    v_and_b32 v59, 0xffff0000, v122
    v_add_f32 v56, v56, v58
    v_add_f32 v57, v57, v59
    v_cvt_pk_bf16_f32 v60, v56, v57
    v_lshlrev_b32 v56, 16, v60
    v_and_b32 v57, 0xffff0000, v60
    v_lshlrev_b32 v58, 16, v26
    v_and_b32 v59, 0xffff0000, v26
    v_add_f32 v56, v56, v58
    v_add_f32 v57, v57, v59
    v_cvt_pk_bf16_f32 v38, v56, v57
    v_lshlrev_b32 v64, 16, v39
    v_and_b32 v65, 0xffff0000, v39
    v_lshlrev_b32 v66, 16, v123
    v_and_b32 v67, 0xffff0000, v123
    v_add_f32 v64, v64, v66
    v_add_f32 v65, v65, v67
    v_cvt_pk_bf16_f32 v68, v64, v65
    v_lshlrev_b32 v64, 16, v68
    v_and_b32 v65, 0xffff0000, v68
    v_lshlrev_b32 v66, 16, v27
    v_and_b32 v67, 0xffff0000, v27
    v_add_f32 v64, v64, v66
    v_add_f32 v65, v65, v67
    v_cvt_pk_bf16_f32 v39, v64, v65
    buffer_store_dwordx4 v[36:39], v7, s[24:27], 0 offen
    s_nop 3
.g2done_17:
    s_waitcnt vmcnt(0)
.k2_end:
    s_endpgm
.section .rodata,"a"
.p2align 6
.amdhsa_kernel k1_kernel
  .amdhsa_next_free_vgpr 256
  .amdhsa_next_free_sgpr 96
  .amdhsa_accum_offset 256
  .amdhsa_group_segment_fixed_size 0
  .amdhsa_kernarg_size 80
  .amdhsa_user_sgpr_count 2
  .amdhsa_user_sgpr_kernarg_segment_ptr 1
  .amdhsa_system_sgpr_workgroup_id_x 1
.end_amdhsa_kernel
.text
.section .rodata,"a"
.p2align 6
.amdhsa_kernel k2_kernel
  .amdhsa_next_free_vgpr 128
  .amdhsa_next_free_sgpr 96
  .amdhsa_accum_offset 128
  .amdhsa_group_segment_fixed_size 0
  .amdhsa_kernarg_size 80
  .amdhsa_user_sgpr_count 2
  .amdhsa_user_sgpr_kernarg_segment_ptr 1
  .amdhsa_system_sgpr_workgroup_id_x 1
.end_amdhsa_kernel
.text
```
